```python
import torch

def _softmax(x, axis=-1):
    return torch.softmax(x, dim=axis)
def _gelu(x):
    return torch.nn.functional.gelu(x, approximate="tanh")
def _silu(x):
    return torch.nn.functional.silu(x)
def _sigmoid(x):
    return torch.sigmoid(x)
def _layernorm(x, axis=-1, eps=1e-5):
    m = x.mean(dim=axis, keepdim=True)
    v = x.var(dim=axis, keepdim=True, unbiased=False)
    return (x - m) / torch.sqrt(v + eps)
def _scatter_add(tgt, idx, src, axis=0):
    return tgt.clone().index_add_(axis, idx, src)
def _segment_sum(src, seg, n):
    out = torch.zeros((n,) + src.shape[1:], dtype=src.dtype)
    return out.index_add_(0, seg, src)
def _pad(x, pw):
    flat = tuple(v for pair in reversed(pw) for v in pair)
    return torch.nn.functional.pad(x, flat)

kernel_name = 'interleave_layers__linear_kernel_hedgehog__sliding_block__prompt'

def setup_inputs():

    _w = (lambda a: (lambda t: t.to(torch.bfloat16) if t.is_floating_point() else t)(torch.as_tensor(a)))
    def _A_setup():
        B, S, D, H = 1, 2048, 448, 16
        Dh = D // H
        return {
            "x": _w((lambda *s: torch.randn(*s, dtype=torch.bfloat16) * 0.05)(B, S, D)),
            "wqkv": _w((lambda *s: torch.randn(*s, dtype=torch.bfloat16) * 0.4)(D, 3 * D)),
            "w_phi": _w((lambda *s: torch.randn(*s, dtype=torch.bfloat16) * 0.4)(H, Dh, Dh) * (Dh ** -0.5)),
            "wo": _w((lambda *s: torch.randn(*s, dtype=torch.bfloat16) * 0.05)(D, D)),
        }
    _A_in = _A_setup()

    def _B_setup():
        B, S, D = 1, 2048, 448
        return {
            "x": _w((lambda *s: torch.randn(*s, dtype=torch.bfloat16) * 0.05)(B, S, D)),
            "wqkv": _w((lambda *s: torch.randn(*s, dtype=torch.bfloat16) * 0.1)(D, 3 * D)),
            "wo": _w((lambda *s: torch.randn(*s, dtype=torch.bfloat16) * 0.05)(D, D)),
        }
    _B_in = _B_setup()

    return {
        "A_x": _A_in["x"],
        "A_wqkv": _A_in["wqkv"],
        "A_w_phi": _A_in["w_phi"],
        "A_wo": _A_in["wo"],
        "B_x": _B_in["x"],
        "B_wqkv": _B_in["wqkv"],
        "B_wo": _B_in["wo"],
    }

def reference(A_x, A_wqkv, A_w_phi, A_wo, B_x, B_wqkv, B_wo):
    def _A_ref(x, wqkv, w_phi, wo):
        B, S, D = x.shape
        H = 16; Dh = D // H
        qkv = (lambda x, *d: x.permute(*d))((x @ wqkv).reshape(B, S, 3, H, Dh), 2, 0, 3, 1, 4)
        q, k, v = qkv[0], qkv[1], qkv[2]
        pq = torch.einsum("bhsd,hdf->bhsf", q, w_phi)
        pk = torch.einsum("bhsd,hdf->bhsf", k, w_phi)
        phi_q = torch.concatenate([_softmax(pq, axis=-1), _softmax(-pq, axis=-1)], axis=-1)
        phi_k = torch.concatenate([_softmax(pk, axis=-1), _softmax(-pk, axis=-1)], axis=-1)
        kv = torch.einsum("bhsf,bhsd->bhfd", phi_k, v)
        z  = torch.einsum("bhsf->bhf", phi_k)
        num = torch.einsum("bhqf,bhfd->bhqd", phi_q, kv)
        den = torch.einsum("bhqf,bhf->bhq", phi_q, z)[..., None] + 1e-6
        o = num / den
        return (lambda x, *d: x.permute(*d))(o, 0, 2, 1, 3).reshape(B, S, D) @ wo

    def _B_ref(x, wqkv, wo):
        B, S, D = x.shape
        H = 16; Dh = D // H; W = 256
        qkv = (lambda x, *d: x.permute(*d))((x @ wqkv).reshape(B, S, 3, H, Dh), 2, 0, 3, 1, 4)
        q, k, v = qkv[0], qkv[1], qkv[2]
        scores = torch.einsum("bhqd,bhkd->bhqk", q, k) * (Dh ** -0.5)
        idx = torch.arange(S)
        mask = (idx[:, None] - idx[None, :] >= 0) & (idx[:, None] - idx[None, :] < W)
        scores = torch.where(mask[None, None], scores, -1e9)
        p = _softmax(scores, axis=-1)
        o = torch.einsum("bhqk,bhkd->bhqd", p, v)
        return (lambda x, *d: x.permute(*d))(o, 0, 2, 1, 3).reshape(B, S, D) @ wo

    x = A_x
    x = x + _A_ref(_layernorm(x, axis=-1), A_wqkv, A_w_phi, A_wo)
    x = x + _B_ref(_layernorm(x, axis=-1), B_wqkv, B_wo)
    x = x + _A_ref(_layernorm(x, axis=-1), A_wqkv, A_w_phi, A_wo)
    x = x + _B_ref(_layernorm(x, axis=-1), B_wqkv, B_wo)
    return x
```

```asm
; @launch grid=(256,1,1) block=(256,1,1) lds=163840
.amdgcn_target "amdgcn-amd-amdhsa--gfx950"
.text
.globl interleave_layers__linear_kernel_hedgehog__sliding_block__prompt_kernel
.p2align 8
.type interleave_layers__linear_kernel_hedgehog__sliding_block__prompt_kernel,@function
interleave_layers__linear_kernel_hedgehog__sliding_block__prompt_kernel:
    s_cmp_ge_u32 s2, 256
    s_cbranch_scc1 L_end
    s_load_dwordx16 s[64:79], s[0:1], 0
    s_load_dwordx4 s[80:83], s[0:1], 64
    s_getpc_b64 s[28:29]
    s_lshr_b32 s30, s2, 3
    s_lshl_b32 s30, s30, 11
    v_lshl_add_u32 v16, v0, 7, s30
    v_min_u32 v16, 0xbb60, v16
    v_cmp_gt_u32 vcc, 16, v0
    s_nop 0
    s_and_saveexec_b64 s[32:33], vcc
    s_cbranch_execz L_nopf
    global_load_dword a252, v16, s[28:29]
L_nopf:
    s_mov_b64 exec, -1
    v_lshrrev_b32 v12, 6, v0
    v_and_b32 v2, 63, v0
    v_readfirstlane_b32 s3, v12
    v_mov_b32 v22, v0
    s_and_b32 s4, s2, 7
    s_lshl_b32 s4, s4, 1
    s_bfe_u32 s28, s2, 0x10003
    s_or_b32 s4, s4, s28
    s_lshr_b32 s5, s2, 4
    s_mul_i32 s28, s28, 3
    s_mul_i32 s32, s5, 1
    s_add_u32 s32, s32, s28
    s_mul_i32 s28, s32, 9363
    s_lshr_b32 s28, s28, 16
    s_mul_i32 s28, s28, 7
    s_sub_u32 s32, s32, s28
    s_lshl_b32 s39, s32, 7
    s_lshl_b32 s28, s4, 2
    s_add_u32 s31, s28, s3
    s_mul_i32 s50, s31, 28672
    s_mul_i32 s29, s3, 43008
    s_mul_i32 s28, s5, 56
    s_min_u32 s28, s28, 832
    s_add_u32 s29, s29, s28
    s_add_u32 s29, s29, 896
    s_lshl_b32 s98, s3, 12
    s_add_u32 s98, s98, 90112
    s_lshl_b32 s99, s3, 11
    v_lshrrev_b32 v16, 3, v2
    v_mul_u32_u24 v18, 896, v16
    v_add_u32 v18, s50, v18
    v_lshrrev_b32 v16, 1, v16
    v_and_b32 v19, 7, v2
    v_xor_b32 v19, v19, v16
    v_lshl_add_u32 v240, v19, 4, v18
    v_xor_b32 v19, 4, v19
    v_lshl_add_u32 v241, v19, 4, v18
    v_add_u32 v241, 6144, v241
    v_add_u32 v242, 12288, v240
    v_add_u32 v243, 12288, v241
    v_lshrrev_b32 v16, 2, v2
    v_mul_u32_u24 v16, 2688, v16
    v_and_b32 v19, 3, v2
    v_lshl_add_u32 v16, v19, 4, v16
    v_add_u32 v96, s29, v16
    v_subrev_u32 v97, 128, v96
    s_mov_b32 s18, 1835008
    s_mov_b32 s19, 0x20000
    s_mov_b32 s22, 1204224
    s_mov_b32 s23, 0x20000
    s_waitcnt lgkmcnt(0)
    s_mov_b64 s[16:17], s[64:65]
    s_mov_b64 s[20:21], s[66:67]
    s_mul_i32 s28, s39, 1344
    s_add_u32 m0, s99, 0
    s_nop 0
    buffer_load_dwordx4 v96, s[20:23], s28 offen offset:0 lds
    buffer_load_dwordx4 v97, s[20:23], s28 offen offset:1024 lds
    s_add_u32 m0, s98, 0
    s_nop 0
    buffer_load_dwordx4 v240, s[16:19], s39 offen offset:0 lds
    buffer_load_dwordx4 v241, s[16:19], s39 offen offset:1024 lds
    buffer_load_dwordx4 v242, s[16:19], s39 offen offset:2048 lds
    buffer_load_dwordx4 v243, s[16:19], s39 offen offset:3072 lds
    s_add_u32 s39, s39, 128
    s_cmp_eq_u32 s39, 896
    s_cselect_b32 s39, 0, s39
    v_lshlrev_b32 v1, 4, v2
    s_and_b32 s93, s2, 7
    s_lshl_b32 s93, s93, 5
    s_mov_b32 s10, 18370560
    s_mov_b32 s11, 0x20000
    s_mov_b32 s14, 256
    s_mov_b32 s15, 0x20000
    s_mov_b64 s[12:13], s[80:81]
    s_mov_b64 s[8:9], s[82:83]
    s_mov_b64 s[82:83], s[78:79]
    v_lshlrev_b32 v8, 3, v2
    s_mov_b32 s60, 0
    s_mov_b32 s44, 0
    s_mov_b32 s45, -1
    s_mov_b32 s46, 0xf0000000
    s_mov_b32 s47, 0xf0000000
    s_mov_b32 s48, 0x10000000
    s_mov_b32 s49, 0x10000000
    s_mov_b32 s61, 0x3fb8aa3b
    s_mov_b32 s100, 57344
    s_mov_b32 s62, 0x3e8b97f6
    s_lshl_b32 s51, s31, 12
    s_add_u32 s56, s3, 0
    s_and_b32 s56, s56, 3
    s_mul_i32 s56, s56, 7168
    v_add_u32 v3, s56, v1
    s_add_u32 s57, s3, 1
    s_and_b32 s57, s57, 3
    s_mul_i32 s57, s57, 7168
    v_add_u32 v4, s57, v1
    s_add_u32 s58, s3, 2
    s_and_b32 s58, s58, 3
    s_mul_i32 s58, s58, 7168
    v_add_u32 v5, s58, v1
    s_add_u32 s59, s3, 3
    s_and_b32 s59, s59, 3
    s_mul_i32 s59, s59, 7168
    v_add_u32 v6, s59, v1
    s_lshr_b32 s28, s5, 2
    s_lshl_b32 s29, s4, 2
    s_add_u32 s28, s28, s29
    s_mul_i32 s52, s28, 28672
    s_lshl_b32 s53, s28, 12
    s_and_b32 s29, s5, 3
    s_lshl_b32 s54, s29, 2
    s_cmp_eq_u32 s29, 3
    s_cselect_b32 s54, 11, s54
    s_add_u32 s54, s54, s3
    s_lshr_b32 s30, s29, 1
    s_add_u32 s30, s30, s3
    s_cmp_eq_u32 s30, 4
    s_cselect_b32 s54, 15, s54
    s_mul_i32 s55, s5, 86016
    s_add_u32 s0, s55, s56
    s_min_u32 s1, s54, 13
    s_mul_i32 s1, s1, 28672
    s_lshl_b32 s85, s54, 11
    s_add_u32 s85, s85, s52
    s_lshl_b32 s86, s54, 8
    s_add_u32 s86, s86, s53
    s_add_u32 s86, s86, 1835008
    s_mul_i32 s87, s29, 7168
    s_add_u32 s87, s87, s52
    s_lshl_b32 s30, s3, 10
    s_add_u32 s87, s87, s30
    s_add_u32 s101, s87, 4096
    s_lshl_b32 s30, s29, 10
    s_add_u32 s30, s30, s53
    s_add_u32 s30, s30, 1835008
    s_cmp_eq_u32 s3, 3
    s_cselect_b32 s101, s30, s101
    s_lshl_b32 s84, s51, 3
    s_lshl_b32 s28, s5, 11
    s_add_u32 s84, s84, s28
    s_lshl_b32 s88, s3, 8
    s_add_u32 s88, s88, 88064
    s_lshl_b32 s89, s5, 16
    s_lshl_b32 s28, s4, 12
    s_add_u32 s90, s89, s28
    s_lshl_b32 s28, s3, 6
    s_add_u32 s90, s90, s28
    s_lshl_b32 s28, s3, 14
    s_add_u32 s89, s89, s28
    s_lshl_b32 s28, s4, 8
    s_add_u32 s89, s89, s28
    v_lshrrev_b32 v16, 4, v2
    v_and_b32 v17, 0xf0, v1
    v_lshl_add_u32 v9, v16, 12, v17
    v_and_b32 v17, 15, v2
    v_lshlrev_b32 v17, 2, v17
    v_lshl_add_u32 v10, v16, 8, v17
    s_lshl_b32 s91, s5, 12
    s_lshl_b32 s28, s4, 8
    s_add_u32 s92, s91, s28
    s_lshl_b32 s28, s3, 6
    s_add_u32 s92, s92, s28
    v_and_b32 v11, 7, v2
    v_lshlrev_b32 v11, 5, v11
    s_mul_i32 s28, s5, 7
    v_lshrrev_b32 v16, 5, v2
    v_add_u32 v16, s28, v16
    v_and_b32 v17, 0x1f0, v1
    v_and_b32 v18, 1, v16
    v_lshl_add_u32 v17, v18, 3, v17
    v_lshrrev_b32 v16, 1, v16
    v_lshl_add_u32 v7, v16, 9, v17
    v_mov_b32 v16, -1
    v_accvgpr_write_b32 a248, v16
    v_accvgpr_write_b32 a249, v16
    v_accvgpr_write_b32 a250, v16
    v_accvgpr_write_b32 a251, v16
    v_and_b32 v16, 31, v2
    v_bfe_u32 v17, v16, 1, 3
    v_lshrrev_b32 v18, 5, v2
    v_xor_b32 v17, v17, v18
    s_lshl_b32 s28, s3, 12
    s_add_u32 s28, s28, 90112
    v_lshl_add_u32 v16, v16, 7, s28
    v_lshlrev_b32 v19, 3, v18
    v_bfe_u32 v20, v2, 2, 2
    v_add_u32 v19, v19, v20
    v_lshlrev_b32 v19, 6, v19
    v_bfe_u32 v20, v2, 4, 1
    v_lshl_add_u32 v19, v20, 5, v19
    v_and_b32 v20, 3, v2
    v_lshl_add_u32 v19, v20, 3, v19
    s_cmp_eq_u32 s5, 15
    s_cselect_b32 s28, 8, 0
    v_add_u32 v19, s28, v19
    s_add_u32 s28, s3, 0
    s_and_b32 s28, s28, 3
    s_lshl_b32 s29, s28, 1
    v_xor_b32 v20, s29, v17
    v_lshl_add_u32 v244, v20, 4, v16
    s_lshl_b32 s29, s28, 11
    v_add_u32 v248, s29, v19
    s_add_u32 s28, s3, 1
    s_and_b32 s28, s28, 3
    s_lshl_b32 s29, s28, 1
    v_xor_b32 v20, s29, v17
    v_lshl_add_u32 v245, v20, 4, v16
    s_lshl_b32 s29, s28, 11
    v_add_u32 v249, s29, v19
    s_add_u32 s28, s3, 2
    s_and_b32 s28, s28, 3
    s_lshl_b32 s29, s28, 1
    v_xor_b32 v20, s29, v17
    v_lshl_add_u32 v246, v20, 4, v16
    s_lshl_b32 s29, s28, 11
    v_add_u32 v250, s29, v19
    s_add_u32 s28, s3, 3
    s_and_b32 s28, s28, 3
    s_lshl_b32 s29, s28, 1
    v_xor_b32 v20, s29, v17
    v_lshl_add_u32 v247, v20, 4, v16
    s_lshl_b32 s29, s28, 11
    v_add_u32 v251, s29, v19
    s_cmp_ge_u32 s31, 56
    s_cselect_b32 s28, 56, 0
    s_sub_u32 s31, s31, s28
    s_cmp_ge_u32 s31, 28
    s_cselect_b32 s28, 28, 0
    s_cselect_b32 s33, 1, 0
    s_sub_u32 s28, s31, s28
    s_lshl_b32 s29, s32, 2
    s_add_u32 s30, s28, 28
    s_sub_u32 s30, s30, s29
    s_cmp_ge_u32 s30, 28
    s_cselect_b32 s29, 28, 0
    s_sub_u32 s30, s30, s29
    s_lshl_b32 s94, s30, 1
    s_add_u32 s94, s94, s33
    s_lshl_b32 s94, s94, 10
    s_lshl_b32 s95, s30, 10
    s_add_u32 s95, s95, 57344
    s_lshl_b32 s97, s28, 10
    s_add_u32 s97, s97, s55
    s_mul_i32 s33, s33, 28672
    s_add_u32 s96, s97, s33
    s_add_u32 s97, s97, 57344
    v_mov_b32 v254, v19
    s_add_u32 s40, s89, 7487488
    buffer_store_dwordx4 a[248:251], v9, s[8:11], s40 offen sc1
    s_add_u32 s40, s89, 8536064
    buffer_store_dwordx4 a[248:251], v9, s[8:11], s40 offen sc1
    s_lshl_b32 s40, s4, 7
    s_lshl_b32 s41, s5, 3
    s_add_u32 s40, s40, s41
    s_add_u32 s40, s40, 18104320
    s_mov_b64 exec, 1
    buffer_store_dwordx2 a[248:249], off, s[8:11], s40 sc1
    s_mov_b64 exec, -1
    s_mov_b64 s[24:25], s[68:69]
    s_mov_b32 s26, 25088
    s_mov_b32 s27, 0x20000
    s_cmp_ge_u32 s3, 2
    s_cbranch_scc1 pd_1
    s_mul_i32 s28, s5, 1568
    s_lshl_b32 s29, s3, 10
    s_add_u32 s28, s28, s29
    s_add_u32 m0, s29, 155648
    s_nop 0
    buffer_load_dwordx4 v1, s[24:27], s28 offen lds
pd_1:
    v_lshrrev_b32 v100, 5, v2
    v_lshlrev_b32 v100, 2, v100
    v_bfe_u32 v101, v2, 2, 2
    v_add_u32 v100, v100, v101
    v_mul_u32_u24 v100, 56, v100
    v_bfe_u32 v101, v2, 4, 1
    v_lshl_add_u32 v100, v101, 5, v100
    v_and_b32 v101, 3, v2
    v_lshl_add_u32 v100, v101, 3, v100
    v_add_u32 v100, 155648, v100
    s_mov_b32 s28, 10836
    s_bitcmp1_b32 s28, s5
    s_cselect_b32 s7, 0, 1
    s_lshl_b32 s29, 1, s5
    s_sub_u32 s29, s29, 1
    s_andn2_b32 s29, s29, s28
    s_bcnt1_i32_b32 s29, s29
    s_lshl_b32 s29, s29, 4
    s_add_u32 s29, s29, s4
    s_cmp_ge_u32 s29, 140
    s_cselect_b32 s7, 0, s7
    s_sub_u32 s30, s29, 84
    s_cmp_lt_u32 s30, 28
    s_cselect_b32 s30, 1, 0
    s_lshl_b32 s7, s7, s30
    s_mov_b32 s27, 0x20000
    s_cmp_ge_u32 s29, 84
    s_cbranch_scc1 L_prep_wo
    s_mov_b64 s[24:25], s[74:75]
    s_mov_b32 s26, 1204224
    s_cmp_ge_u32 s29, 28
    s_cselect_b32 s30, 1, 0
    s_cmp_ge_u32 s29, 56
    s_cselect_b32 s30, 2, s30
    s_mul_i32 s33, s30, 28
    s_sub_u32 s33, s29, s33
    s_lshl_b32 s35, s29, 10
    s_add_u32 s35, s35, 1376256
    s_mov_b32 s36, 86016
    s_add_u32 s28, s30, 1
    s_cmp_eq_u32 s30, 2
    s_cselect_b32 s28, 0, s28
    s_mul_i32 s28, s28, 896
    s_mul_i32 s33, s33, 43008
    s_add_u32 s28, s28, s33
    s_mov_b32 s30, 2688
    s_mov_b32 s34, 56
    s_mov_b32 s37, 16
    s_mov_b32 s38, 0xf0000000
    s_branch L_prep_go
L_prep_wo:
    s_mov_b32 s26, 401408
    s_cmp_ge_u32 s29, 112
    s_cselect_b32 s24, s76, s70
    s_cselect_b32 s25, s77, s71
    s_mov_b32 s33, 84
    s_cselect_b32 s33, 112, s33
    s_mov_b32 s35, 2752512
    s_cselect_b32 s35, 3153920, s35
    s_sub_u32 s33, s29, s33
    s_lshl_b32 s28, s33, 10
    s_add_u32 s35, s35, s28
    s_mov_b32 s36, 28672
    s_mul_i32 s28, s33, 14336
    s_mov_b32 s30, 896
    s_mov_b32 s34, 64
    s_mov_b32 s37, 14
    s_mov_b32 s38, 0
L_prep_go:
    s_lshl_b32 s29, s3, 2
    s_mul_i32 s33, s29, s34
    s_add_u32 s72, s28, s33
    s_lshl_b32 s73, s30, 2
    s_mul_i32 s28, s29, s36
    s_add_u32 s35, s35, s28
    s_sub_u32 s37, s37, s29
    v_lshrrev_b32 v98, 4, v2
    v_mul_lo_u32 v98, v98, s30
    v_and_b32 v16, 0xf0, v1
    v_add_u32 v98, v98, v16
    v_lshrrev_b32 v16, 5, v2
    v_lshlrev_b32 v16, 3, v16
    v_bfe_u32 v17, v2, 2, 2
    v_add_u32 v16, v16, v17
    v_lshlrev_b32 v16, 8, v16
    v_bfe_u32 v17, v2, 4, 1
    v_lshl_add_u32 v16, v17, 5, v16
    v_and_b32 v17, 3, v2
    v_lshl_add_u32 v16, v17, 3, v16
    s_add_u32 s80, s98, 49152
    s_sub_u32 s28, s98, 32768
    s_cmp_eq_u32 s7, 2
    s_cselect_b32 s80, s28, s80
    v_add_u32 v255, s80, v16
    v_lshl_add_u32 v121, v2, 2, s88
    v_lshrrev_b32 v122, 5, v2
    v_lshl_add_u32 v122, v122, 4, s88
    s_lshl_b32 s28, s3, 2
    s_add_u32 s28, s28, 86016
    v_add_u32 v123, s28, v1
    v_add_u32 v124, 86016, v1
    v_mov_b32 v112, 0x3f803f80
    v_mov_b32 v113, 0x3f803f80
    v_mov_b32 v114, 0x3f803f80
    v_mov_b32 v115, 0x3f803f80
    s_lshl_b32 s40, s3, 11
    s_add_u32 s40, s40, 119808
    v_add_u32 v117, s40, v1
    s_mul_i32 s40, s3, 4352
    s_add_u32 s40, s40, 102400
    v_and_b32 v119, 31, v2
    v_mul_u32_u24 v119, 136, v119
    v_lshrrev_b32 v16, 5, v2
    v_lshl_add_u32 v119, v16, 3, v119
    v_add_u32 v119, s40, v119
    v_lshlrev_b32 v125, 4, v16
    v_bfe_u32 v17, v2, 4, 1
    v_lshl_add_u32 v125, v17, 2, v125
    v_bfe_u32 v18, v2, 2, 2
    v_add_u32 v125, v125, v18
    v_mul_u32_u24 v125, 136, v125
    v_and_b32 v18, 3, v2
    v_lshl_add_u32 v125, v18, 3, v125
    s_lshl_b32 s40, s3, 5
    s_add_u32 s40, s40, 102400
    v_add_u32 v125, s40, v125
    v_and_b32 v127, 0xf0, v1
    v_lshl_add_u32 v127, v16, 10, v127
    v_lshl_add_u32 v127, v17, 9, v127
    v_add_u32 v127, 119808, v127
    v_mov_b32 v252, 0
    v_mov_b32 v253, 0
    s_getreg_b32 s63, hwreg(HW_REG_XCC_ID)
    s_and_b32 s63, s63, 7
    s_mul_i32 s63, s63, 6
    s_add_u32 s63, s63, 8
    s_cmp_lg_u32 s7, 2
    s_cbranch_scc1 L_prep_nodma2
    s_add_u32 m0, s80, 0
    s_nop 0
    buffer_load_dwordx4 v98, s[24:27], s72 offen lds
    s_add_u32 s72, s72, s73
    s_add_u32 m0, s80, 1024
    s_nop 0
    buffer_load_dwordx4 v98, s[24:27], s72 offen lds
    s_add_u32 s72, s72, s73
    s_add_u32 m0, s80, 2048
    s_nop 0
    buffer_load_dwordx4 v98, s[24:27], s72 offen lds
    s_add_u32 s72, s72, s73
    s_add_u32 m0, s80, 3072
    s_nop 0
    buffer_load_dwordx4 v98, s[24:27], s72 offen lds
L_prep_nodma2:
    s_mul_i32 s28, s39, 1344
    s_add_u32 m0, s99, 8192
    s_nop 0
    buffer_load_dwordx4 v96, s[20:23], s28 offen offset:0 lds
    buffer_load_dwordx4 v97, s[20:23], s28 offen offset:1024 lds
    s_add_u32 m0, s98, 16384
    s_nop 0
    buffer_load_dwordx4 v240, s[16:19], s39 offen offset:0 lds
    buffer_load_dwordx4 v241, s[16:19], s39 offen offset:1024 lds
    buffer_load_dwordx4 v242, s[16:19], s39 offen offset:2048 lds
    buffer_load_dwordx4 v243, s[16:19], s39 offen offset:3072 lds
    s_add_u32 s39, s39, 128
    s_cmp_eq_u32 s39, 896
    s_cselect_b32 s39, 0, s39
    s_waitcnt vmcnt(9)
    s_barrier
    ds_read_b128 v[128:131], v244 offset:0
    ds_read_b128 v[132:135], v245 offset:0
    ds_read_b128 v[136:139], v246 offset:0
    ds_read_b128 v[140:143], v247 offset:0
    ds_read_b64_tr_b16 a[16:17], v248 offset:0
    ds_read_b64_tr_b16 a[18:19], v248 offset:256
    ds_read_b64_tr_b16 a[20:21], v248 offset:1024
    ds_read_b64_tr_b16 a[22:23], v248 offset:1280
    ds_read_b64_tr_b16 a[24:25], v249 offset:0
    ds_read_b64_tr_b16 a[26:27], v249 offset:256
    ds_read_b64_tr_b16 a[28:29], v249 offset:1024
    ds_read_b64_tr_b16 a[30:31], v249 offset:1280
    s_add_u32 m0, s98, 32768
    s_nop 0
    buffer_load_dwordx4 v240, s[16:19], s39 offen offset:0 lds
    s_add_u32 m0, s98, 32768
    s_nop 0
    buffer_load_dwordx4 v241, s[16:19], s39 offen offset:1024 lds
    s_waitcnt lgkmcnt(7)
    ds_read_b64_tr_b16 a[32:33], v250 offset:0
    ds_read_b64_tr_b16 a[34:35], v250 offset:256
    ds_read_b64_tr_b16 a[36:37], v250 offset:1024
    ds_read_b64_tr_b16 a[38:39], v250 offset:1280
    ds_read_b64_tr_b16 a[40:41], v251 offset:0
    ds_read_b64_tr_b16 a[42:43], v251 offset:256
    ds_read_b64_tr_b16 a[44:45], v251 offset:1024
    ds_read_b64_tr_b16 a[46:47], v251 offset:1280
    s_add_u32 m0, s99, 16384
    s_mul_i32 s40, s39, 1344
    buffer_load_dwordx4 v96, s[20:23], s40 offen offset:0 lds
    s_add_u32 m0, s98, 32768
    s_nop 0
    buffer_load_dwordx4 v242, s[16:19], s39 offen offset:2048 lds
    v_dot2c_f32_bf16 v252, v128, v112
    v_dot2c_f32_bf16 v253, v128, v128
    v_dot2c_f32_bf16 v252, v129, v112
    v_dot2c_f32_bf16 v253, v129, v129
    v_dot2c_f32_bf16 v252, v130, v112
    v_dot2c_f32_bf16 v253, v130, v130
    v_dot2c_f32_bf16 v252, v131, v112
    v_dot2c_f32_bf16 v253, v131, v131
    v_dot2c_f32_bf16 v252, v132, v112
    v_dot2c_f32_bf16 v253, v132, v132
    v_dot2c_f32_bf16 v252, v133, v112
    v_dot2c_f32_bf16 v253, v133, v133
    v_dot2c_f32_bf16 v252, v134, v112
    v_dot2c_f32_bf16 v253, v134, v134
    v_dot2c_f32_bf16 v252, v135, v112
    v_dot2c_f32_bf16 v253, v135, v135
    v_dot2c_f32_bf16 v252, v136, v112
    v_dot2c_f32_bf16 v253, v136, v136
    v_dot2c_f32_bf16 v252, v137, v112
    v_dot2c_f32_bf16 v253, v137, v137
    v_dot2c_f32_bf16 v252, v138, v112
    v_dot2c_f32_bf16 v253, v138, v138
    v_dot2c_f32_bf16 v252, v139, v112
    v_dot2c_f32_bf16 v253, v139, v139
    v_dot2c_f32_bf16 v252, v140, v112
    v_dot2c_f32_bf16 v253, v140, v140
    v_dot2c_f32_bf16 v252, v141, v112
    v_dot2c_f32_bf16 v253, v141, v141
    v_dot2c_f32_bf16 v252, v142, v112
    v_dot2c_f32_bf16 v253, v142, v142
    v_dot2c_f32_bf16 v252, v143, v112
    v_dot2c_f32_bf16 v253, v143, v143
    s_add_u32 m0, s98, 32768
    s_nop 0
    buffer_load_dwordx4 v243, s[16:19], s39 offen offset:3072 lds
    s_add_u32 m0, s99, 16384
    s_mul_i32 s40, s39, 1344
    buffer_load_dwordx4 v97, s[20:23], s40 offen offset:1024 lds
    s_add_u32 s39, s39, 128
    s_cmp_eq_u32 s39, 896
    s_cselect_b32 s39, 0, s39
    s_waitcnt lgkmcnt(0)
    v_mfma_f32_32x32x16_bf16 v[64:79], v[112:115], a[16:19], 0
    s_waitcnt vmcnt(6)
    s_barrier
    ds_read_b128 v[144:147], v244 offset:16384
    ds_read_b128 v[148:151], v245 offset:16384
    ds_read_b128 v[152:155], v246 offset:16384
    v_mfma_f32_32x32x16_bf16 v[80:95], v[112:115], a[20:23], 0
    ds_read_b128 v[156:159], v247 offset:16384
    ds_read_b64_tr_b16 a[48:49], v248 offset:8192
    ds_read_b64_tr_b16 a[50:51], v248 offset:8448
    s_add_u32 m0, s98, 49152
    s_nop 0
    buffer_load_dwordx4 v240, s[16:19], s39 offen offset:0 lds
    v_mfma_f32_32x32x16_bf16 v[16:31], a[16:19], v[128:131], 0
    ds_read_b64_tr_b16 a[52:53], v248 offset:9216
    ds_read_b64_tr_b16 a[54:55], v248 offset:9472
    ds_read_b64_tr_b16 a[56:57], v249 offset:8192
    v_mfma_f32_32x32x16_bf16 v[32:47], v[128:131], a[20:23], 0
    ds_read_b64_tr_b16 a[58:59], v249 offset:8448
    ds_read_b64_tr_b16 a[60:61], v249 offset:9216
    ds_read_b64_tr_b16 a[62:63], v249 offset:9472
    s_add_u32 m0, s98, 49152
    s_nop 0
    buffer_load_dwordx4 v241, s[16:19], s39 offen offset:1024 lds
    v_mfma_f32_32x32x16_bf16 v[16:31], a[24:27], v[132:135], v[16:31]
    s_waitcnt lgkmcnt(10)
    ds_read_b64_tr_b16 a[64:65], v250 offset:8192
    ds_read_b64_tr_b16 a[66:67], v250 offset:8448
    v_mfma_f32_32x32x16_bf16 v[32:47], v[132:135], a[28:31], v[32:47]
    s_waitcnt lgkmcnt(10)
    ds_read_b64_tr_b16 a[68:69], v250 offset:9216
    ds_read_b64_tr_b16 a[70:71], v250 offset:9472
    s_add_u32 m0, s99, 24576
    s_mul_i32 s40, s39, 1344
    buffer_load_dwordx4 v96, s[20:23], s40 offen offset:0 lds
    v_mfma_f32_32x32x16_bf16 v[16:31], a[32:35], v[136:139], v[16:31]
    s_waitcnt lgkmcnt(10)
    ds_read_b64_tr_b16 a[72:73], v251 offset:8192
    ds_read_b64_tr_b16 a[74:75], v251 offset:8448
    v_mfma_f32_32x32x16_bf16 v[32:47], v[136:139], a[36:39], v[32:47]
    s_waitcnt lgkmcnt(10)
    ds_read_b64_tr_b16 a[76:77], v251 offset:9216
    ds_read_b64_tr_b16 a[78:79], v251 offset:9472
    s_add_u32 m0, s98, 49152
    s_nop 0
    buffer_load_dwordx4 v242, s[16:19], s39 offen offset:2048 lds
    v_mfma_f32_32x32x16_bf16 v[16:31], a[40:43], v[140:143], v[16:31]
    s_add_u32 m0, s98, 49152
    s_nop 0
    buffer_load_dwordx4 v243, s[16:19], s39 offen offset:3072 lds
    s_mov_b64 s[28:29], 1
    s_lshl_b64 s[28:29], s[28:29], s63
    s_add_u32 s28, s28, 1
    s_cmp_lg_u32 s3, 0
    s_cbranch_scc1 arr_2
    s_mov_b64 exec, 1
    v_mov_b32 v12, s28
    v_mov_b32 v13, s29
    buffer_atomic_add_x2 v[12:13], off, s[12:15], s93 offset:0 sc1
    s_mov_b64 exec, -1
arr_2:
    v_mfma_f32_32x32x16_bf16 v[32:47], v[140:143], a[44:47], v[32:47]
    s_add_u32 m0, s99, 24576
    s_mul_i32 s40, s39, 1344
    buffer_load_dwordx4 v97, s[20:23], s40 offen offset:1024 lds
    s_add_u32 s39, s39, 128
    s_cmp_eq_u32 s39, 896
    s_cselect_b32 s39, 0, s39
    s_cmp_lg_u32 s7, 2
    s_cbranch_scc1 L_prep_done2
    s_waitcnt vmcnt(12) lgkmcnt(0)
    s_mov_b32 vcc_lo, s38
    s_mov_b32 vcc_hi, s38
    ds_read_b64_tr_b16 v[48:49], v255
    ds_read_b64_tr_b16 v[50:51], v255 offset:1024
    v_add_u32 v255, s34, v255
    ds_read_b64_tr_b16 v[52:53], v255
    ds_read_b64_tr_b16 v[54:55], v255 offset:1024
    v_add_u32 v255, s34, v255
    ds_read_b64_tr_b16 v[56:57], v255
    ds_read_b64_tr_b16 v[58:59], v255 offset:1024
    v_add_u32 v255, s34, v255
    ds_read_b64_tr_b16 v[60:61], v255
    ds_read_b64_tr_b16 v[62:63], v255 offset:1024
    s_waitcnt lgkmcnt(6)
    buffer_store_dwordx4 v[48:51], v1, s[8:11], s35 offen sc1
    s_add_u32 s35, s35, s36
    s_waitcnt lgkmcnt(4)
    buffer_store_dwordx4 v[52:55], v1, s[8:11], s35 offen sc1
    s_add_u32 s35, s35, s36
    s_waitcnt lgkmcnt(2)
    s_cmp_le_u32 s37, 2
    s_cbranch_scc1 L_prep_done2
    buffer_store_dwordx4 v[56:59], v1, s[8:11], s35 offen sc1
    s_add_u32 s35, s35, s36
    s_waitcnt lgkmcnt(0)
    buffer_store_dwordx4 v[60:63], v1, s[8:11], s35 offen sc1
    s_add_u32 s35, s35, s36
    s_nop 1
L_prep_done2:
    s_waitcnt lgkmcnt(0)
    s_waitcnt lgkmcnt(12)
    v_dot2c_f32_bf16 v252, v144, v112
    v_dot2c_f32_bf16 v253, v144, v144
    v_dot2c_f32_bf16 v252, v145, v112
    v_dot2c_f32_bf16 v253, v145, v145
    v_dot2c_f32_bf16 v252, v146, v112
    v_dot2c_f32_bf16 v253, v146, v146
    v_dot2c_f32_bf16 v252, v147, v112
    v_dot2c_f32_bf16 v253, v147, v147
    v_dot2c_f32_bf16 v252, v148, v112
    v_dot2c_f32_bf16 v253, v148, v148
    v_dot2c_f32_bf16 v252, v149, v112
    v_dot2c_f32_bf16 v253, v149, v149
    v_dot2c_f32_bf16 v252, v150, v112
    v_dot2c_f32_bf16 v253, v150, v150
    v_dot2c_f32_bf16 v252, v151, v112
    v_dot2c_f32_bf16 v253, v151, v151
    v_dot2c_f32_bf16 v252, v152, v112
    v_dot2c_f32_bf16 v253, v152, v152
    v_dot2c_f32_bf16 v252, v153, v112
    v_dot2c_f32_bf16 v253, v153, v153
    v_dot2c_f32_bf16 v252, v154, v112
    v_dot2c_f32_bf16 v253, v154, v154
    v_dot2c_f32_bf16 v252, v155, v112
    v_dot2c_f32_bf16 v253, v155, v155
    v_dot2c_f32_bf16 v252, v156, v112
    v_dot2c_f32_bf16 v253, v156, v156
    v_dot2c_f32_bf16 v252, v157, v112
    v_dot2c_f32_bf16 v253, v157, v157
    v_dot2c_f32_bf16 v252, v158, v112
    v_dot2c_f32_bf16 v253, v158, v158
    v_dot2c_f32_bf16 v252, v159, v112
    v_dot2c_f32_bf16 v253, v159, v159
    s_waitcnt lgkmcnt(0)
    v_mfma_f32_32x32x16_bf16 v[64:79], v[112:115], a[48:51], v[64:79]
    s_waitcnt vmcnt(6)
    s_barrier
    ds_read_b128 v[160:163], v244 offset:32768
    ds_read_b128 v[164:167], v245 offset:32768
    ds_read_b128 v[168:171], v246 offset:32768
    v_mfma_f32_32x32x16_bf16 v[80:95], v[112:115], a[52:55], v[80:95]
    ds_read_b128 v[172:175], v247 offset:32768
    ds_read_b64_tr_b16 a[16:17], v248 offset:16384
    ds_read_b64_tr_b16 a[18:19], v248 offset:16640
    s_add_u32 m0, s98, 0
    s_nop 0
    buffer_load_dwordx4 v240, s[16:19], s39 offen offset:0 lds
    v_mfma_f32_32x32x16_bf16 v[16:31], a[48:51], v[144:147], v[16:31]
    ds_read_b64_tr_b16 a[20:21], v248 offset:17408
    ds_read_b64_tr_b16 a[22:23], v248 offset:17664
    ds_read_b64_tr_b16 a[24:25], v249 offset:16384
    v_mfma_f32_32x32x16_bf16 v[32:47], v[144:147], a[52:55], v[32:47]
    ds_read_b64_tr_b16 a[26:27], v249 offset:16640
    ds_read_b64_tr_b16 a[28:29], v249 offset:17408
    ds_read_b64_tr_b16 a[30:31], v249 offset:17664
    s_add_u32 m0, s98, 0
    s_nop 0
    buffer_load_dwordx4 v241, s[16:19], s39 offen offset:1024 lds
    v_mfma_f32_32x32x16_bf16 v[16:31], a[56:59], v[148:151], v[16:31]
    s_waitcnt lgkmcnt(10)
    ds_read_b64_tr_b16 a[32:33], v250 offset:16384
    ds_read_b64_tr_b16 a[34:35], v250 offset:16640
    v_mfma_f32_32x32x16_bf16 v[32:47], v[148:151], a[60:63], v[32:47]
    s_waitcnt lgkmcnt(10)
    ds_read_b64_tr_b16 a[36:37], v250 offset:17408
    ds_read_b64_tr_b16 a[38:39], v250 offset:17664
    s_add_u32 m0, s99, 32768
    s_mul_i32 s40, s39, 1344
    buffer_load_dwordx4 v96, s[20:23], s40 offen offset:0 lds
    v_mfma_f32_32x32x16_bf16 v[16:31], a[64:67], v[152:155], v[16:31]
    s_waitcnt lgkmcnt(10)
    ds_read_b64_tr_b16 a[40:41], v251 offset:16384
    ds_read_b64_tr_b16 a[42:43], v251 offset:16640
    v_mfma_f32_32x32x16_bf16 v[32:47], v[152:155], a[68:71], v[32:47]
    s_waitcnt lgkmcnt(10)
    ds_read_b64_tr_b16 a[44:45], v251 offset:17408
    ds_read_b64_tr_b16 a[46:47], v251 offset:17664
    s_add_u32 m0, s98, 0
    s_nop 0
    buffer_load_dwordx4 v242, s[16:19], s39 offen offset:2048 lds
    v_mfma_f32_32x32x16_bf16 v[16:31], a[72:75], v[156:159], v[16:31]
    s_add_u32 m0, s98, 0
    s_nop 0
    buffer_load_dwordx4 v243, s[16:19], s39 offen offset:3072 lds
    v_mfma_f32_32x32x16_bf16 v[32:47], v[156:159], a[76:79], v[32:47]
    s_add_u32 m0, s99, 32768
    s_mul_i32 s40, s39, 1344
    buffer_load_dwordx4 v97, s[20:23], s40 offen offset:1024 lds
    s_add_u32 s39, s39, 128
    s_cmp_eq_u32 s39, 896
    s_cselect_b32 s39, 0, s39
    s_waitcnt lgkmcnt(12)
    v_dot2c_f32_bf16 v252, v160, v112
    v_dot2c_f32_bf16 v253, v160, v160
    v_dot2c_f32_bf16 v252, v161, v112
    v_dot2c_f32_bf16 v253, v161, v161
    v_dot2c_f32_bf16 v252, v162, v112
    v_dot2c_f32_bf16 v253, v162, v162
    v_dot2c_f32_bf16 v252, v163, v112
    v_dot2c_f32_bf16 v253, v163, v163
    v_dot2c_f32_bf16 v252, v164, v112
    v_dot2c_f32_bf16 v253, v164, v164
    v_dot2c_f32_bf16 v252, v165, v112
    v_dot2c_f32_bf16 v253, v165, v165
    v_dot2c_f32_bf16 v252, v166, v112
    v_dot2c_f32_bf16 v253, v166, v166
    v_dot2c_f32_bf16 v252, v167, v112
    v_dot2c_f32_bf16 v253, v167, v167
    v_dot2c_f32_bf16 v252, v168, v112
    v_dot2c_f32_bf16 v253, v168, v168
    v_dot2c_f32_bf16 v252, v169, v112
    v_dot2c_f32_bf16 v253, v169, v169
    v_dot2c_f32_bf16 v252, v170, v112
    v_dot2c_f32_bf16 v253, v170, v170
    v_dot2c_f32_bf16 v252, v171, v112
    v_dot2c_f32_bf16 v253, v171, v171
    v_dot2c_f32_bf16 v252, v172, v112
    v_dot2c_f32_bf16 v253, v172, v172
    v_dot2c_f32_bf16 v252, v173, v112
    v_dot2c_f32_bf16 v253, v173, v173
    v_dot2c_f32_bf16 v252, v174, v112
    v_dot2c_f32_bf16 v253, v174, v174
    v_dot2c_f32_bf16 v252, v175, v112
    v_dot2c_f32_bf16 v253, v175, v175
    s_waitcnt lgkmcnt(0)
    v_mfma_f32_32x32x16_bf16 v[64:79], v[112:115], a[16:19], v[64:79]
    s_waitcnt vmcnt(6)
    s_barrier
    ds_read_b128 v[176:179], v244 offset:49152
    ds_read_b128 v[180:183], v245 offset:49152
    ds_read_b128 v[184:187], v246 offset:49152
    v_mfma_f32_32x32x16_bf16 v[80:95], v[112:115], a[20:23], v[80:95]
    ds_read_b128 v[188:191], v247 offset:49152
    ds_read_b64_tr_b16 a[48:49], v248 offset:24576
    ds_read_b64_tr_b16 a[50:51], v248 offset:24832
    s_add_u32 m0, s98, 16384
    s_nop 0
    buffer_load_dwordx4 v240, s[16:19], s39 offen offset:0 lds
    v_mfma_f32_32x32x16_bf16 v[16:31], a[16:19], v[160:163], v[16:31]
    ds_read_b64_tr_b16 a[52:53], v248 offset:25600
    ds_read_b64_tr_b16 a[54:55], v248 offset:25856
    ds_read_b64_tr_b16 a[56:57], v249 offset:24576
    v_mfma_f32_32x32x16_bf16 v[32:47], v[160:163], a[20:23], v[32:47]
    ds_read_b64_tr_b16 a[58:59], v249 offset:24832
    ds_read_b64_tr_b16 a[60:61], v249 offset:25600
    ds_read_b64_tr_b16 a[62:63], v249 offset:25856
    s_add_u32 m0, s98, 16384
    s_nop 0
    buffer_load_dwordx4 v241, s[16:19], s39 offen offset:1024 lds
    v_mfma_f32_32x32x16_bf16 v[16:31], a[24:27], v[164:167], v[16:31]
    s_waitcnt lgkmcnt(10)
    ds_read_b64_tr_b16 a[64:65], v250 offset:24576
    ds_read_b64_tr_b16 a[66:67], v250 offset:24832
    v_mfma_f32_32x32x16_bf16 v[32:47], v[164:167], a[28:31], v[32:47]
    s_waitcnt lgkmcnt(10)
    ds_read_b64_tr_b16 a[68:69], v250 offset:25600
    ds_read_b64_tr_b16 a[70:71], v250 offset:25856
    s_add_u32 m0, s99, 40960
    s_mul_i32 s40, s39, 1344
    buffer_load_dwordx4 v96, s[20:23], s40 offen offset:0 lds
    v_mfma_f32_32x32x16_bf16 v[16:31], a[32:35], v[168:171], v[16:31]
    s_waitcnt lgkmcnt(10)
    ds_read_b64_tr_b16 a[72:73], v251 offset:24576
    ds_read_b64_tr_b16 a[74:75], v251 offset:24832
    v_mfma_f32_32x32x16_bf16 v[32:47], v[168:171], a[36:39], v[32:47]
    s_waitcnt lgkmcnt(10)
    ds_read_b64_tr_b16 a[76:77], v251 offset:25600
    ds_read_b64_tr_b16 a[78:79], v251 offset:25856
    s_add_u32 m0, s98, 16384
    s_nop 0
    buffer_load_dwordx4 v242, s[16:19], s39 offen offset:2048 lds
    v_mfma_f32_32x32x16_bf16 v[16:31], a[40:43], v[172:175], v[16:31]
    s_add_u32 m0, s98, 16384
    s_nop 0
    buffer_load_dwordx4 v243, s[16:19], s39 offen offset:3072 lds
    v_mfma_f32_32x32x16_bf16 v[32:47], v[172:175], a[44:47], v[32:47]
    s_add_u32 m0, s99, 40960
    s_mul_i32 s40, s39, 1344
    buffer_load_dwordx4 v97, s[20:23], s40 offen offset:1024 lds
    s_add_u32 s39, s39, 128
    s_cmp_eq_u32 s39, 896
    s_cselect_b32 s39, 0, s39
    s_waitcnt lgkmcnt(12)
    v_dot2c_f32_bf16 v252, v176, v112
    v_dot2c_f32_bf16 v253, v176, v176
    v_dot2c_f32_bf16 v252, v177, v112
    v_dot2c_f32_bf16 v253, v177, v177
    v_dot2c_f32_bf16 v252, v178, v112
    v_dot2c_f32_bf16 v253, v178, v178
    v_dot2c_f32_bf16 v252, v179, v112
    v_dot2c_f32_bf16 v253, v179, v179
    v_dot2c_f32_bf16 v252, v180, v112
    v_dot2c_f32_bf16 v253, v180, v180
    v_dot2c_f32_bf16 v252, v181, v112
    v_dot2c_f32_bf16 v253, v181, v181
    v_dot2c_f32_bf16 v252, v182, v112
    v_dot2c_f32_bf16 v253, v182, v182
    v_dot2c_f32_bf16 v252, v183, v112
    v_dot2c_f32_bf16 v253, v183, v183
    v_dot2c_f32_bf16 v252, v184, v112
    v_dot2c_f32_bf16 v253, v184, v184
    v_dot2c_f32_bf16 v252, v185, v112
    v_dot2c_f32_bf16 v253, v185, v185
    v_dot2c_f32_bf16 v252, v186, v112
    v_dot2c_f32_bf16 v253, v186, v186
    v_dot2c_f32_bf16 v252, v187, v112
    v_dot2c_f32_bf16 v253, v187, v187
    v_dot2c_f32_bf16 v252, v188, v112
    v_dot2c_f32_bf16 v253, v188, v188
    v_dot2c_f32_bf16 v252, v189, v112
    v_dot2c_f32_bf16 v253, v189, v189
    v_dot2c_f32_bf16 v252, v190, v112
    v_dot2c_f32_bf16 v253, v190, v190
    v_dot2c_f32_bf16 v252, v191, v112
    v_dot2c_f32_bf16 v253, v191, v191
    s_waitcnt lgkmcnt(0)
    v_mfma_f32_32x32x16_bf16 v[64:79], v[112:115], a[48:51], v[64:79]
    s_waitcnt vmcnt(6)
    s_barrier
    ds_read_b128 v[192:195], v244 offset:0
    ds_read_b128 v[196:199], v245 offset:0
    ds_read_b128 v[200:203], v246 offset:0
    v_mfma_f32_32x32x16_bf16 v[80:95], v[112:115], a[52:55], v[80:95]
    ds_read_b128 v[204:207], v247 offset:0
    ds_read_b64_tr_b16 a[16:17], v248 offset:32768
    ds_read_b64_tr_b16 a[18:19], v248 offset:33024
    s_add_u32 m0, s98, 32768
    s_nop 0
    buffer_load_dwordx4 v240, s[16:19], s39 offen offset:0 lds
    v_mfma_f32_32x32x16_bf16 v[16:31], a[48:51], v[176:179], v[16:31]
    ds_read_b64_tr_b16 a[20:21], v248 offset:33792
    ds_read_b64_tr_b16 a[22:23], v248 offset:34048
    ds_read_b64_tr_b16 a[24:25], v249 offset:32768
    v_mfma_f32_32x32x16_bf16 v[32:47], v[176:179], a[52:55], v[32:47]
    ds_read_b64_tr_b16 a[26:27], v249 offset:33024
    ds_read_b64_tr_b16 a[28:29], v249 offset:33792
    ds_read_b64_tr_b16 a[30:31], v249 offset:34048
    s_add_u32 m0, s98, 32768
    s_nop 0
    buffer_load_dwordx4 v241, s[16:19], s39 offen offset:1024 lds
    v_mfma_f32_32x32x16_bf16 v[16:31], a[56:59], v[180:183], v[16:31]
    s_waitcnt lgkmcnt(10)
    ds_read_b64_tr_b16 a[32:33], v250 offset:32768
    ds_read_b64_tr_b16 a[34:35], v250 offset:33024
    v_mfma_f32_32x32x16_bf16 v[32:47], v[180:183], a[60:63], v[32:47]
    s_waitcnt lgkmcnt(10)
    ds_read_b64_tr_b16 a[36:37], v250 offset:33792
    ds_read_b64_tr_b16 a[38:39], v250 offset:34048
    s_add_u32 m0, s99, 49152
    s_mul_i32 s40, s39, 1344
    buffer_load_dwordx4 v96, s[20:23], s40 offen offset:0 lds
    v_mfma_f32_32x32x16_bf16 v[16:31], a[64:67], v[184:187], v[16:31]
    s_waitcnt lgkmcnt(10)
    ds_read_b64_tr_b16 a[40:41], v251 offset:32768
    ds_read_b64_tr_b16 a[42:43], v251 offset:33024
    v_mfma_f32_32x32x16_bf16 v[32:47], v[184:187], a[68:71], v[32:47]
    s_waitcnt lgkmcnt(10)
    ds_read_b64_tr_b16 a[44:45], v251 offset:33792
    ds_read_b64_tr_b16 a[46:47], v251 offset:34048
    s_add_u32 m0, s98, 32768
    s_nop 0
    buffer_load_dwordx4 v242, s[16:19], s39 offen offset:2048 lds
    v_mfma_f32_32x32x16_bf16 v[16:31], a[72:75], v[188:191], v[16:31]
    s_add_u32 m0, s98, 32768
    s_nop 0
    buffer_load_dwordx4 v243, s[16:19], s39 offen offset:3072 lds
    s_cmp_lg_u32 s7, 2
    s_cbranch_scc1 L_noarr2
    s_mov_b32 s28, s93
    s_mov_b32 s93, 0
    s_cmp_lg_u32 s3, 0
    s_cbranch_scc1 arr_3
    s_mov_b64 exec, 1
    v_mov_b32 v12, 0x1
    buffer_atomic_add v12, off, s[12:15], s93 offset:8 sc1
    s_mov_b64 exec, -1
arr_3:
    s_mov_b32 s93, s28
L_noarr2:
    v_mfma_f32_32x32x16_bf16 v[32:47], v[188:191], a[76:79], v[32:47]
    s_add_u32 m0, s99, 49152
    s_mul_i32 s40, s39, 1344
    buffer_load_dwordx4 v97, s[20:23], s40 offen offset:1024 lds
    s_add_u32 s39, s39, 128
    s_cmp_eq_u32 s39, 896
    s_cselect_b32 s39, 0, s39
    s_waitcnt lgkmcnt(12)
    v_dot2c_f32_bf16 v252, v192, v112
    v_dot2c_f32_bf16 v253, v192, v192
    v_dot2c_f32_bf16 v252, v193, v112
    v_dot2c_f32_bf16 v253, v193, v193
    v_dot2c_f32_bf16 v252, v194, v112
    v_dot2c_f32_bf16 v253, v194, v194
    v_dot2c_f32_bf16 v252, v195, v112
    v_dot2c_f32_bf16 v253, v195, v195
    v_dot2c_f32_bf16 v252, v196, v112
    v_dot2c_f32_bf16 v253, v196, v196
    v_dot2c_f32_bf16 v252, v197, v112
    v_dot2c_f32_bf16 v253, v197, v197
    v_dot2c_f32_bf16 v252, v198, v112
    v_dot2c_f32_bf16 v253, v198, v198
    v_dot2c_f32_bf16 v252, v199, v112
    v_dot2c_f32_bf16 v253, v199, v199
    v_dot2c_f32_bf16 v252, v200, v112
    v_dot2c_f32_bf16 v253, v200, v200
    v_dot2c_f32_bf16 v252, v201, v112
    v_dot2c_f32_bf16 v253, v201, v201
    v_dot2c_f32_bf16 v252, v202, v112
    v_dot2c_f32_bf16 v253, v202, v202
    v_dot2c_f32_bf16 v252, v203, v112
    v_dot2c_f32_bf16 v253, v203, v203
    v_dot2c_f32_bf16 v252, v204, v112
    v_dot2c_f32_bf16 v253, v204, v204
    v_dot2c_f32_bf16 v252, v205, v112
    v_dot2c_f32_bf16 v253, v205, v205
    v_dot2c_f32_bf16 v252, v206, v112
    v_dot2c_f32_bf16 v253, v206, v206
    v_dot2c_f32_bf16 v252, v207, v112
    v_dot2c_f32_bf16 v253, v207, v207
    s_waitcnt lgkmcnt(0)
    v_mfma_f32_32x32x16_bf16 v[64:79], v[112:115], a[16:19], v[64:79]
    s_waitcnt vmcnt(6)
    s_barrier
    ds_read_b128 v[208:211], v244 offset:16384
    ds_read_b128 v[212:215], v245 offset:16384
    ds_read_b128 v[216:219], v246 offset:16384
    v_mfma_f32_32x32x16_bf16 v[80:95], v[112:115], a[20:23], v[80:95]
    ds_read_b128 v[220:223], v247 offset:16384
    ds_read_b64_tr_b16 a[48:49], v248 offset:40960
    ds_read_b64_tr_b16 a[50:51], v248 offset:41216
    s_cmp_lg_u32 s7, 1
    s_cbranch_scc1 L_prep_nodma1
    s_add_u32 m0, s80, 0
    s_nop 0
    buffer_load_dwordx4 v98, s[24:27], s72 offen lds
    s_add_u32 s72, s72, s73
    s_add_u32 m0, s80, 1024
    s_nop 0
    buffer_load_dwordx4 v98, s[24:27], s72 offen lds
    s_add_u32 s72, s72, s73
    s_add_u32 m0, s80, 2048
    s_nop 0
    buffer_load_dwordx4 v98, s[24:27], s72 offen lds
    s_add_u32 s72, s72, s73
    s_add_u32 m0, s80, 3072
    s_nop 0
    buffer_load_dwordx4 v98, s[24:27], s72 offen lds
L_prep_nodma1:
    v_mfma_f32_32x32x16_bf16 v[16:31], a[16:19], v[192:195], v[16:31]
    ds_read_b64_tr_b16 a[52:53], v248 offset:41984
    ds_read_b64_tr_b16 a[54:55], v248 offset:42240
    ds_read_b64_tr_b16 a[56:57], v249 offset:40960
    v_mfma_f32_32x32x16_bf16 v[32:47], v[192:195], a[20:23], v[32:47]
    ds_read_b64_tr_b16 a[58:59], v249 offset:41216
    ds_read_b64_tr_b16 a[60:61], v249 offset:41984
    ds_read_b64_tr_b16 a[62:63], v249 offset:42240
    v_subrev_u32 v96, 896, v96
    s_lshr_b32 s40, s99, 1
    s_add_u32 m0, s40, 57344
    s_mul_i32 s40, s39, 1344
    buffer_load_dwordx4 v96, s[20:23], s40 offen lds
    s_add_u32 s39, s39, 128
    s_cmp_eq_u32 s39, 896
    s_cselect_b32 s39, 0, s39
    v_mfma_f32_32x32x16_bf16 v[16:31], a[24:27], v[196:199], v[16:31]
    s_waitcnt lgkmcnt(10)
    ds_read_b64_tr_b16 a[64:65], v250 offset:40960
    ds_read_b64_tr_b16 a[66:67], v250 offset:41216
    ds_read_b64_tr_b16 a[68:69], v250 offset:41984
    v_mfma_f32_32x32x16_bf16 v[32:47], v[196:199], a[28:31], v[32:47]
    s_waitcnt lgkmcnt(10)
    ds_read_b64_tr_b16 a[70:71], v250 offset:42240
    ds_read_b64_tr_b16 a[72:73], v251 offset:40960
    ds_read_b64_tr_b16 a[74:75], v251 offset:41216
    s_lshr_b32 s40, s99, 1
    s_add_u32 m0, s40, 61440
    s_mul_i32 s40, s39, 1344
    buffer_load_dwordx4 v96, s[20:23], s40 offen lds
    s_add_u32 s39, s39, 128
    s_cmp_eq_u32 s39, 896
    s_cselect_b32 s39, 0, s39
    v_mfma_f32_32x32x16_bf16 v[16:31], a[32:35], v[200:203], v[16:31]
    s_waitcnt lgkmcnt(10)
    ds_read_b64_tr_b16 a[76:77], v251 offset:41984
    ds_read_b64_tr_b16 a[78:79], v251 offset:42240
    ds_read_b64_tr_b16 v[102:103], v100 offset:0
    v_mfma_f32_32x32x16_bf16 v[32:47], v[200:203], a[36:39], v[32:47]
    s_waitcnt lgkmcnt(10)
    ds_read_b64_tr_b16 v[104:105], v100 offset:448
    ds_read_b64_tr_b16 v[106:107], v100 offset:896
    ds_read_b64_tr_b16 v[108:109], v100 offset:1344
    s_lshr_b32 s40, s99, 1
    s_add_u32 m0, s40, 65536
    s_mul_i32 s40, s39, 1344
    buffer_load_dwordx4 v96, s[20:23], s40 offen lds
    s_add_u32 s39, s39, 128
    s_cmp_eq_u32 s39, 896
    s_cselect_b32 s39, 0, s39
    v_mfma_f32_32x32x16_bf16 v[16:31], a[40:43], v[204:207], v[16:31]
    s_lshr_b32 s40, s99, 1
    s_add_u32 m0, s40, 69632
    s_mul_i32 s40, s39, 1344
    buffer_load_dwordx4 v96, s[20:23], s40 offen lds
    s_add_u32 s39, s39, 128
    s_cmp_eq_u32 s39, 896
    s_cselect_b32 s39, 0, s39
    v_mfma_f32_32x32x16_bf16 v[32:47], v[204:207], a[44:47], v[32:47]
    s_lshr_b32 s40, s99, 1
    s_add_u32 m0, s40, 73728
    s_mul_i32 s40, s39, 1344
    buffer_load_dwordx4 v96, s[20:23], s40 offen lds
    s_add_u32 s39, s39, 128
    s_cmp_eq_u32 s39, 896
    s_cselect_b32 s39, 0, s39
    s_waitcnt lgkmcnt(12)
    v_dot2c_f32_bf16 v252, v208, v112
    v_dot2c_f32_bf16 v253, v208, v208
    v_dot2c_f32_bf16 v252, v209, v112
    v_dot2c_f32_bf16 v253, v209, v209
    v_dot2c_f32_bf16 v252, v210, v112
    v_dot2c_f32_bf16 v253, v210, v210
    v_dot2c_f32_bf16 v252, v211, v112
    v_dot2c_f32_bf16 v253, v211, v211
    v_dot2c_f32_bf16 v252, v212, v112
    v_dot2c_f32_bf16 v253, v212, v212
    v_dot2c_f32_bf16 v252, v213, v112
    v_dot2c_f32_bf16 v253, v213, v213
    v_dot2c_f32_bf16 v252, v214, v112
    v_dot2c_f32_bf16 v253, v214, v214
    v_dot2c_f32_bf16 v252, v215, v112
    v_dot2c_f32_bf16 v253, v215, v215
    v_dot2c_f32_bf16 v252, v216, v112
    v_dot2c_f32_bf16 v253, v216, v216
    v_dot2c_f32_bf16 v252, v217, v112
    v_dot2c_f32_bf16 v253, v217, v217
    v_dot2c_f32_bf16 v252, v218, v112
    v_dot2c_f32_bf16 v253, v218, v218
    v_dot2c_f32_bf16 v252, v219, v112
    v_dot2c_f32_bf16 v253, v219, v219
    v_dot2c_f32_bf16 v252, v220, v112
    v_dot2c_f32_bf16 v253, v220, v220
    v_dot2c_f32_bf16 v252, v221, v112
    v_dot2c_f32_bf16 v253, v221, v221
    v_dot2c_f32_bf16 v252, v222, v112
    v_dot2c_f32_bf16 v253, v222, v222
    v_dot2c_f32_bf16 v252, v223, v112
    v_dot2c_f32_bf16 v253, v223, v223
    s_waitcnt lgkmcnt(0)
    v_mfma_f32_32x32x16_bf16 v[64:79], v[112:115], a[48:51], v[64:79]
    s_waitcnt vmcnt(5)
    s_barrier
    ds_read_b128 v[224:227], v244 offset:32768
    ds_read_b128 v[228:231], v245 offset:32768
    ds_read_b128 v[232:235], v246 offset:32768
    v_cndmask_b32 v102, v102, 0, s[46:47]
    v_accvgpr_write_b32 a232, v102
    v_mfma_f32_32x32x16_bf16 v[80:95], v[112:115], a[52:55], v[80:95]
    ds_read_b128 v[236:239], v247 offset:32768
    ds_read_b64_tr_b16 a[16:17], v248 offset:49152
    ds_read_b64_tr_b16 a[18:19], v248 offset:49408
    s_lshr_b32 s40, s99, 1
    s_add_u32 m0, s40, 77824
    s_mul_i32 s40, s39, 1344
    buffer_load_dwordx4 v96, s[20:23], s40 offen lds
    s_add_u32 s39, s39, 128
    s_cmp_eq_u32 s39, 896
    s_cselect_b32 s39, 0, s39
    v_cndmask_b32 v103, v103, 0, s[46:47]
    v_accvgpr_write_b32 a233, v103
    v_mfma_f32_32x32x16_bf16 v[16:31], a[48:51], v[208:211], v[16:31]
    ds_read_b64_tr_b16 a[20:21], v248 offset:50176
    ds_read_b64_tr_b16 a[22:23], v248 offset:50432
    ds_read_b64_tr_b16 a[24:25], v249 offset:49152
    v_cndmask_b32 v104, v104, 0, s[46:47]
    v_accvgpr_write_b32 a234, v104
    v_mfma_f32_32x32x16_bf16 v[32:47], v[208:211], a[52:55], v[32:47]
    ds_read_b64_tr_b16 a[26:27], v249 offset:49408
    ds_read_b64_tr_b16 a[28:29], v249 offset:50176
    ds_read_b64_tr_b16 a[30:31], v249 offset:50432
    s_lshr_b32 s40, s99, 1
    s_add_u32 m0, s40, 81920
    s_mul_i32 s40, s39, 1344
    buffer_load_dwordx4 v96, s[20:23], s40 offen lds
    s_add_u32 s39, s39, 128
    s_cmp_eq_u32 s39, 896
    s_cselect_b32 s39, 0, s39
    v_cndmask_b32 v105, v105, 0, s[46:47]
    v_accvgpr_write_b32 a235, v105
    v_mfma_f32_32x32x16_bf16 v[16:31], a[56:59], v[212:215], v[16:31]
    s_waitcnt lgkmcnt(10)
    ds_read_b64_tr_b16 a[32:33], v250 offset:49152
    ds_read_b64_tr_b16 a[34:35], v250 offset:49408
    v_cndmask_b32 v106, v106, 0, s[46:47]
    v_accvgpr_write_b32 a236, v106
    v_mfma_f32_32x32x16_bf16 v[32:47], v[212:215], a[60:63], v[32:47]
    s_waitcnt lgkmcnt(10)
    ds_read_b64_tr_b16 a[36:37], v250 offset:50176
    ds_read_b64_tr_b16 a[38:39], v250 offset:50432
    s_getpc_b64 s[40:41]
cr_4:
    s_sub_u32 s40, s40, 0x1974
    s_subb_u32 s41, s41, 0
    s_lshr_b32 s42, s2, 3
    s_lshl_b32 s42, s42, 2
    s_add_u32 s42, s42, s3
    s_lshl_b32 s42, s42, 9
    v_lshl_add_u32 v7, v2, 7, s42
    v_min_u32 v7, 0xbb60, v7
    s_mov_b64 exec, 0xf
    global_load_dword a252, v7, s[40:41] sc1
    s_mov_b64 exec, -1
    v_cndmask_b32 v107, v107, 0, s[46:47]
    v_accvgpr_write_b32 a237, v107
    v_mfma_f32_32x32x16_bf16 v[16:31], a[64:67], v[216:219], v[16:31]
    s_waitcnt lgkmcnt(10)
    ds_read_b64_tr_b16 a[40:41], v251 offset:49152
    ds_read_b64_tr_b16 a[42:43], v251 offset:49408
    v_cndmask_b32 v108, v108, 0, s[46:47]
    v_cndmask_b32 v108, v108, 0, s[44:45]
    v_mfma_f32_32x32x16_bf16 v[32:47], v[216:219], a[68:71], v[32:47]
    s_waitcnt lgkmcnt(10)
    ds_read_b64_tr_b16 a[44:45], v251 offset:50176
    ds_read_b64_tr_b16 a[46:47], v251 offset:50432
    v_accvgpr_write_b32 a238, v108
    v_cndmask_b32 v109, v109, 0, s[46:47]
    v_mfma_f32_32x32x16_bf16 v[16:31], a[72:75], v[220:223], v[16:31]
    v_cndmask_b32 v109, v109, 0, s[44:45]
    v_accvgpr_write_b32 a239, v109
    v_mfma_f32_32x32x16_bf16 v[32:47], v[220:223], a[76:79], v[32:47]
    s_waitcnt lgkmcnt(12)
    v_dot2c_f32_bf16 v252, v224, v112
    v_dot2c_f32_bf16 v253, v224, v224
    v_dot2c_f32_bf16 v252, v225, v112
    v_dot2c_f32_bf16 v253, v225, v225
    v_dot2c_f32_bf16 v252, v226, v112
    v_dot2c_f32_bf16 v253, v226, v226
    v_dot2c_f32_bf16 v252, v227, v112
    v_dot2c_f32_bf16 v253, v227, v227
    v_dot2c_f32_bf16 v252, v228, v112
    v_dot2c_f32_bf16 v253, v228, v228
    v_dot2c_f32_bf16 v252, v229, v112
    v_dot2c_f32_bf16 v253, v229, v229
    v_dot2c_f32_bf16 v252, v230, v112
    v_dot2c_f32_bf16 v253, v230, v230
    v_dot2c_f32_bf16 v252, v231, v112
    v_dot2c_f32_bf16 v253, v231, v231
    v_dot2c_f32_bf16 v252, v232, v112
    v_dot2c_f32_bf16 v253, v232, v232
    v_dot2c_f32_bf16 v252, v233, v112
    v_dot2c_f32_bf16 v253, v233, v233
    v_dot2c_f32_bf16 v252, v234, v112
    v_dot2c_f32_bf16 v253, v234, v234
    v_dot2c_f32_bf16 v252, v235, v112
    v_dot2c_f32_bf16 v253, v235, v235
    v_dot2c_f32_bf16 v252, v236, v112
    v_dot2c_f32_bf16 v253, v236, v236
    v_dot2c_f32_bf16 v252, v237, v112
    v_dot2c_f32_bf16 v253, v237, v237
    v_dot2c_f32_bf16 v252, v238, v112
    v_dot2c_f32_bf16 v253, v238, v238
    v_dot2c_f32_bf16 v252, v239, v112
    v_dot2c_f32_bf16 v253, v239, v239
    s_waitcnt lgkmcnt(0)
    v_mfma_f32_32x32x16_bf16 v[64:79], v[112:115], a[16:19], v[64:79]
    v_mov_b32 v14, v252
    v_mov_b32 v15, v253
    s_nop 0
    v_permlane32_swap_b32 v252, v14
    v_permlane32_swap_b32 v253, v15
    v_add_f32 v252, v252, v14
    v_add_f32 v253, v253, v15
    v_mul_f32 v252, 0x3b124925, v252
    v_mul_f32 v253, 0x3b124925, v253
    v_fma_f32 v253, -v252, v252, v253
    v_max_f32 v253, 0, v253
    v_add_f32 v253, 0x3727c5ac, v253
    v_rsq_f32 v116, v253
    s_nop 0
    v_mul_f32 v118, -v252, v116
    v_cndmask_b32 v14, v116, v118, s[44:45]
    ds_write_b32 v121, v14
    v_mfma_f32_32x32x16_bf16 v[80:95], v[112:115], a[20:23], v[80:95]
    v_mfma_f32_32x32x16_bf16 v[16:31], a[16:19], v[224:227], v[16:31]
    v_mfma_f32_32x32x16_bf16 v[32:47], v[224:227], a[20:23], v[32:47]
    s_nop 9
    v_cndmask_b32 v12, v64, v80, s[44:45]
    ds_write_b32 v123, v12
    s_waitcnt lgkmcnt(0)
    s_barrier
    ds_read_b128 v[12:15], v124
    ds_read_b128 v[64:67], v122 offset:0
    ds_read_b128 v[80:83], v122 offset:128
    ds_read_b128 v[68:71], v122 offset:32
    ds_read_b128 v[84:87], v122 offset:160
    ds_read_b128 v[72:75], v122 offset:64
    ds_read_b128 v[88:91], v122 offset:192
    ds_read_b128 v[76:79], v122 offset:96
    ds_read_b128 v[92:95], v122 offset:224
    v_mfma_f32_32x32x16_bf16 v[16:31], a[24:27], v[228:231], v[16:31]
    v_mfma_f32_32x32x16_bf16 v[32:47], v[228:231], a[28:31], v[32:47]
    v_mfma_f32_32x32x16_bf16 v[16:31], a[32:35], v[232:235], v[16:31]
    s_waitcnt lgkmcnt(8)
    v_add_f32 v12, v12, v13
    v_add_f32 v14, v14, v15
    v_add_f32 v12, v12, v14
    v_accvgpr_write_b32 a253, v12
    ds_write_b32 v121, v12 offset:1024
    v_mov_b32 v126, v12
    s_nop 1
    v_permlane32_swap_b32 v12, v126
    ds_read_b128 v[48:51], v122 offset:1024
    ds_read_b128 v[52:55], v122 offset:1056
    ds_read_b128 v[56:59], v122 offset:1088
    ds_read_b128 v[60:63], v122 offset:1120
    v_mfma_f32_32x32x16_bf16 v[32:47], v[232:235], a[36:39], v[32:47]
    v_mfma_f32_32x32x16_bf16 v[16:31], a[40:43], v[236:239], v[16:31]
    v_mfma_f32_32x32x16_bf16 v[32:47], v[236:239], a[44:47], v[32:47]
    s_waitcnt lgkmcnt(4)
    v_mul_f32 v80, v80, v126
    v_mul_f32 v81, v81, v126
    v_mul_f32 v82, v82, v126
    v_mul_f32 v83, v83, v126
    v_mul_f32 v84, v84, v126
    v_mul_f32 v85, v85, v126
    v_mul_f32 v86, v86, v126
    v_mul_f32 v87, v87, v126
    v_mul_f32 v88, v88, v126
    v_mul_f32 v89, v89, v126
    v_mul_f32 v90, v90, v126
    v_mul_f32 v91, v91, v126
    v_mul_f32 v92, v92, v126
    v_mul_f32 v93, v93, v126
    v_mul_f32 v94, v94, v126
    v_mul_f32 v95, v95, v126
    s_waitcnt lgkmcnt(0)
    v_pk_mul_f32 v[48:49], v[48:49], v[118:119] op_sel_hi:[1,0]
    v_pk_mul_f32 v[50:51], v[50:51], v[118:119] op_sel_hi:[1,0]
    v_pk_mul_f32 v[52:53], v[52:53], v[118:119] op_sel_hi:[1,0]
    v_pk_mul_f32 v[54:55], v[54:55], v[118:119] op_sel_hi:[1,0]
    v_pk_mul_f32 v[56:57], v[56:57], v[118:119] op_sel_hi:[1,0]
    v_pk_mul_f32 v[58:59], v[58:59], v[118:119] op_sel_hi:[1,0]
    v_pk_mul_f32 v[60:61], v[60:61], v[118:119] op_sel_hi:[1,0]
    v_pk_mul_f32 v[62:63], v[62:63], v[118:119] op_sel_hi:[1,0]
    v_pk_fma_f32 v[16:17], v[16:17], v[116:117], v[48:49] op_sel_hi:[1,0,1]
    v_pk_fma_f32 v[18:19], v[18:19], v[116:117], v[50:51] op_sel_hi:[1,0,1]
    v_pk_fma_f32 v[20:21], v[20:21], v[116:117], v[52:53] op_sel_hi:[1,0,1]
    v_pk_fma_f32 v[22:23], v[22:23], v[116:117], v[54:55] op_sel_hi:[1,0,1]
    v_pk_fma_f32 v[24:25], v[24:25], v[116:117], v[56:57] op_sel_hi:[1,0,1]
    v_pk_fma_f32 v[26:27], v[26:27], v[116:117], v[58:59] op_sel_hi:[1,0,1]
    v_pk_fma_f32 v[28:29], v[28:29], v[116:117], v[60:61] op_sel_hi:[1,0,1]
    v_pk_fma_f32 v[30:31], v[30:31], v[116:117], v[62:63] op_sel_hi:[1,0,1]
    v_cvt_pk_bf16_f32 v96, v16, v17
    v_cvt_pk_bf16_f32 v97, v18, v19
    v_cvt_pk_bf16_f32 v98, v20, v21
    v_cvt_pk_bf16_f32 v99, v22, v23
    v_cvt_pk_bf16_f32 v100, v24, v25
    v_cvt_pk_bf16_f32 v101, v26, v27
    v_cvt_pk_bf16_f32 v102, v28, v29
    v_cvt_pk_bf16_f32 v103, v30, v31
    v_mfma_f32_32x32x16_bf16 v[48:63], a[232:235], v[96:99], 0
    s_nop 0
    v_mfma_f32_32x32x16_bf16 v[48:63], a[236:239], v[100:103], v[48:63]
    s_cmp_lg_u32 s7, 1
    s_cbranch_scc1 L_prep_done1
    s_waitcnt vmcnt(7) lgkmcnt(0)
    s_mov_b32 vcc_lo, s38
    s_mov_b32 vcc_hi, s38
    ds_read_b64_tr_b16 v[16:17], v255
    ds_read_b64_tr_b16 v[18:19], v255 offset:1024
    v_add_u32 v255, s34, v255
    ds_read_b64_tr_b16 v[20:21], v255
    ds_read_b64_tr_b16 v[22:23], v255 offset:1024
    v_add_u32 v255, s34, v255
    ds_read_b64_tr_b16 v[24:25], v255
    ds_read_b64_tr_b16 v[26:27], v255 offset:1024
    v_add_u32 v255, s34, v255
    ds_read_b64_tr_b16 v[28:29], v255
    ds_read_b64_tr_b16 v[30:31], v255 offset:1024
    s_waitcnt lgkmcnt(6)
    v_cndmask_b32 v16, v16, 0, vcc
    v_cndmask_b32 v17, v17, 0, vcc
    v_cndmask_b32 v18, v18, 0, vcc
    v_cndmask_b32 v19, v19, 0, vcc
    buffer_store_dwordx4 v[16:19], v1, s[8:11], s35 offen sc1
    s_add_u32 s35, s35, s36
    s_waitcnt lgkmcnt(4)
    v_cndmask_b32 v20, v20, 0, vcc
    v_cndmask_b32 v21, v21, 0, vcc
    v_cndmask_b32 v22, v22, 0, vcc
    v_cndmask_b32 v23, v23, 0, vcc
    buffer_store_dwordx4 v[20:23], v1, s[8:11], s35 offen sc1
    s_add_u32 s35, s35, s36
    s_waitcnt lgkmcnt(2)
    v_cndmask_b32 v24, v24, 0, vcc
    v_cndmask_b32 v25, v25, 0, vcc
    v_cndmask_b32 v26, v26, 0, vcc
    v_cndmask_b32 v27, v27, 0, vcc
    s_cmp_le_u32 s37, 2
    s_cbranch_scc1 L_prep_done1
    buffer_store_dwordx4 v[24:27], v1, s[8:11], s35 offen sc1
    s_add_u32 s35, s35, s36
    s_waitcnt lgkmcnt(0)
    v_cndmask_b32 v28, v28, 0, vcc
    v_cndmask_b32 v29, v29, 0, vcc
    v_cndmask_b32 v30, v30, 0, vcc
    v_cndmask_b32 v31, v31, 0, vcc
    buffer_store_dwordx4 v[28:31], v1, s[8:11], s35 offen sc1
    s_add_u32 s35, s35, s36
    s_nop 1
L_prep_done1:
    s_waitcnt lgkmcnt(0)
    v_pk_fma_f32 v[32:33], v[32:33], v[64:65], v[80:81]
    v_pk_fma_f32 v[34:35], v[34:35], v[66:67], v[82:83]
    v_pk_fma_f32 v[36:37], v[36:37], v[68:69], v[84:85]
    v_pk_fma_f32 v[38:39], v[38:39], v[70:71], v[86:87]
    v_pk_fma_f32 v[40:41], v[40:41], v[72:73], v[88:89]
    v_pk_fma_f32 v[42:43], v[42:43], v[74:75], v[90:91]
    v_pk_fma_f32 v[44:45], v[44:45], v[76:77], v[92:93]
    v_pk_fma_f32 v[46:47], v[46:47], v[78:79], v[94:95]
    v_cvt_pk_bf16_f32 v72, v32, v33
    v_cvt_pk_bf16_f32 v73, v34, v35
    v_cvt_pk_bf16_f32 v74, v36, v37
    v_cvt_pk_bf16_f32 v75, v38, v39
    v_cvt_pk_bf16_f32 v76, v40, v41
    v_cvt_pk_bf16_f32 v77, v42, v43
    v_cvt_pk_bf16_f32 v78, v44, v45
    v_cvt_pk_bf16_f32 v79, v46, v47
    v_cndmask_b32 v12, 0, v112, s[48:49]
    v_mov_b32 v13, v12
    s_mov_b64 exec, s[46:47]
    v_mov_b64 v[72:73], v[12:13]
    v_mov_b64 v[74:75], v[12:13]
    v_mov_b64 v[76:77], v[12:13]
    v_mov_b64 v[78:79], v[12:13]
    s_mov_b64 exec, -1
    ds_write_b128 v117, v[72:75]
    ds_write_b128 v117, v[76:79] offset:1024
    s_add_u32 s28, s89, 7487488
    v_mov_b32 v92, s61
    buffer_load_dwordx4 v[240:243], v11, s[12:15], 0 offen sc1
    s_add_u32 s40, s92, 9584640
    v_lshrrev_b32 v12, 2, v2
    v_and_b32 v13, 0x30, v1
    v_lshl_add_u32 v12, v12, 16, v13
    s_mov_b64 exec, 0xf
    buffer_store_dwordx4 a[248:251], v12, s[8:11], s40 offen sc1
    s_mov_b64 exec, -1
    v_max_f32 v88, v48, v49
    v_min_f32 v90, v48, v49
    v_max3_f32 v88, v88, v50, v51
    v_min3_f32 v90, v90, v50, v51
    v_max3_f32 v88, v88, v52, v53
    v_min3_f32 v90, v90, v52, v53
    v_max3_f32 v88, v88, v54, v55
    v_min3_f32 v90, v90, v54, v55
    v_max3_f32 v88, v88, v56, v57
    v_min3_f32 v90, v90, v56, v57
    v_max3_f32 v88, v88, v58, v59
    v_min3_f32 v90, v90, v58, v59
    s_mov_b32 exec_hi, 0
    v_max3_f32 v88, v88, v60, v61
    v_min3_f32 v90, v90, v60, v61
    v_max3_f32 v88, v88, v62, v63
    v_min3_f32 v90, v90, v62, v63
    s_mov_b64 exec, -1
    v_mov_b32 v89, v88
    v_mov_b32 v91, v90
    s_add_u32 s40, s92, 9650176
    v_lshrrev_b32 v12, 2, v2
    v_and_b32 v13, 0x30, v1
    v_lshl_add_u32 v12, v12, 16, v13
    s_mov_b64 exec, 0xf
    buffer_store_dwordx4 a[248:251], v12, s[8:11], s40 offen sc1
    s_mov_b64 exec, -1
    v_permlane32_swap_b32 v88, v89
    v_permlane32_swap_b32 v90, v91
    v_max_f32 v88, v88, v89
    v_min_f32 v90, v90, v91
    v_mul_f32 v88, s61, v88
    v_mul_f32 v90, s61, v90
    v_pk_fma_f32 v[16:17], v[48:49], v[92:93], v[90:91] op_sel_hi:[1,0,0] neg_lo:[1,0,0] neg_hi:[1,0,0]
    v_pk_fma_f32 v[48:49], v[48:49], v[92:93], v[88:89] op_sel_hi:[1,0,0] neg_lo:[0,0,1] neg_hi:[0,0,1]
    v_pk_fma_f32 v[18:19], v[50:51], v[92:93], v[90:91] op_sel_hi:[1,0,0] neg_lo:[1,0,0] neg_hi:[1,0,0]
    v_pk_fma_f32 v[50:51], v[50:51], v[92:93], v[88:89] op_sel_hi:[1,0,0] neg_lo:[0,0,1] neg_hi:[0,0,1]
    v_pk_fma_f32 v[20:21], v[52:53], v[92:93], v[90:91] op_sel_hi:[1,0,0] neg_lo:[1,0,0] neg_hi:[1,0,0]
    v_pk_fma_f32 v[52:53], v[52:53], v[92:93], v[88:89] op_sel_hi:[1,0,0] neg_lo:[0,0,1] neg_hi:[0,0,1]
    v_pk_fma_f32 v[22:23], v[54:55], v[92:93], v[90:91] op_sel_hi:[1,0,0] neg_lo:[1,0,0] neg_hi:[1,0,0]
    v_pk_fma_f32 v[54:55], v[54:55], v[92:93], v[88:89] op_sel_hi:[1,0,0] neg_lo:[0,0,1] neg_hi:[0,0,1]
    v_pk_fma_f32 v[24:25], v[56:57], v[92:93], v[90:91] op_sel_hi:[1,0,0] neg_lo:[1,0,0] neg_hi:[1,0,0]
    v_pk_fma_f32 v[56:57], v[56:57], v[92:93], v[88:89] op_sel_hi:[1,0,0] neg_lo:[0,0,1] neg_hi:[0,0,1]
    v_pk_fma_f32 v[26:27], v[58:59], v[92:93], v[90:91] op_sel_hi:[1,0,0] neg_lo:[1,0,0] neg_hi:[1,0,0]
    v_pk_fma_f32 v[58:59], v[58:59], v[92:93], v[88:89] op_sel_hi:[1,0,0] neg_lo:[0,0,1] neg_hi:[0,0,1]
    v_pk_fma_f32 v[28:29], v[60:61], v[92:93], v[90:91] op_sel_hi:[1,0,0] neg_lo:[1,0,0] neg_hi:[1,0,0]
    v_pk_fma_f32 v[60:61], v[60:61], v[92:93], v[88:89] op_sel_hi:[1,0,0] neg_lo:[0,0,1] neg_hi:[0,0,1]
    v_pk_fma_f32 v[30:31], v[62:63], v[92:93], v[90:91] op_sel_hi:[1,0,0] neg_lo:[1,0,0] neg_hi:[1,0,0]
    v_pk_fma_f32 v[62:63], v[62:63], v[92:93], v[88:89] op_sel_hi:[1,0,0] neg_lo:[0,0,1] neg_hi:[0,0,1]
    s_add_u32 s40, s84, 9715712
    buffer_store_dwordx4 a[248:251], v1, s[8:11], s40 offen offset:0 sc1
    v_exp_f32 v48, v48
    v_exp_f32 v16, v16
    v_exp_f32 v49, v49
    v_exp_f32 v17, v17
    v_exp_f32 v50, v50
    v_exp_f32 v18, v18
    v_exp_f32 v51, v51
    v_exp_f32 v19, v19
    s_add_u32 s40, s84, 9715712
    buffer_store_dwordx4 a[248:251], v1, s[8:11], s40 offen offset:1024 sc1
    v_exp_f32 v52, v52
    v_exp_f32 v20, v20
    v_exp_f32 v53, v53
    v_exp_f32 v21, v21
    v_exp_f32 v54, v54
    v_exp_f32 v22, v22
    v_exp_f32 v55, v55
    v_exp_f32 v23, v23
    s_add_u32 s40, s84, 13910016
    buffer_store_dwordx4 a[248:251], v1, s[8:11], s40 offen offset:0 sc1
    v_exp_f32 v56, v56
    v_exp_f32 v24, v24
    v_exp_f32 v57, v57
    v_exp_f32 v25, v25
    v_exp_f32 v58, v58
    v_exp_f32 v26, v26
    v_exp_f32 v59, v59
    v_exp_f32 v27, v27
    s_add_u32 s40, s84, 13910016
    buffer_store_dwordx4 a[248:251], v1, s[8:11], s40 offen offset:1024 sc1
    v_exp_f32 v60, v60
    v_exp_f32 v28, v28
    v_exp_f32 v61, v61
    v_exp_f32 v29, v29
    v_exp_f32 v62, v62
    v_exp_f32 v30, v30
    v_exp_f32 v63, v63
    v_exp_f32 v31, v31
    v_add_u32 v12, s94, v254
    ds_read_b64_tr_b16 v[244:245], v12
    ds_read_b64_tr_b16 v[246:247], v12 offset:256
    s_waitcnt lgkmcnt(0)
    buffer_store_dwordx4 v[244:247], v1, s[8:11], s96 offen sc1
    v_pk_add_f32 v[92:93], v[48:49], v[50:51]
    v_pk_add_f32 v[94:95], v[16:17], v[18:19]
    v_pk_add_f32 v[92:93], v[92:93], v[52:53]
    v_pk_add_f32 v[94:95], v[94:95], v[20:21]
    v_pk_add_f32 v[92:93], v[92:93], v[54:55]
    v_pk_add_f32 v[94:95], v[94:95], v[22:23]
    v_pk_add_f32 v[92:93], v[92:93], v[56:57]
    v_pk_add_f32 v[94:95], v[94:95], v[24:25]
    v_pk_add_f32 v[92:93], v[92:93], v[58:59]
    v_pk_add_f32 v[94:95], v[94:95], v[26:27]
    s_mov_b32 exec_hi, 0
    v_pk_add_f32 v[92:93], v[92:93], v[60:61]
    v_pk_add_f32 v[94:95], v[94:95], v[28:29]
    v_pk_add_f32 v[92:93], v[92:93], v[62:63]
    v_pk_add_f32 v[94:95], v[94:95], v[30:31]
    s_mov_b64 exec, -1
    v_add_f32 v92, v92, v93
    v_add_f32 v94, v94, v95
    v_mov_b32 v93, v92
    v_mov_b32 v95, v94
    s_nop 0
    v_permlane32_swap_b32 v92, v93
    v_permlane32_swap_b32 v94, v95
    v_add_f32 v92, v92, v93
    v_add_f32 v94, v94, v95
    v_rcp_f32 v92, v92
    v_rcp_f32 v94, v94
    v_pk_mul_f32 v[48:49], v[48:49], v[92:93] op_sel_hi:[1,0]
    v_pk_mul_f32 v[50:51], v[50:51], v[92:93] op_sel_hi:[1,0]
    v_pk_mul_f32 v[52:53], v[52:53], v[92:93] op_sel_hi:[1,0]
    v_pk_mul_f32 v[54:55], v[54:55], v[92:93] op_sel_hi:[1,0]
    v_pk_mul_f32 v[56:57], v[56:57], v[92:93] op_sel_hi:[1,0]
    v_pk_mul_f32 v[58:59], v[58:59], v[92:93] op_sel_hi:[1,0]
    v_pk_mul_f32 v[60:61], v[60:61], v[92:93] op_sel_hi:[1,0]
    v_pk_mul_f32 v[62:63], v[62:63], v[92:93] op_sel_hi:[1,0]
    v_cvt_pk_bf16_f32 v96, v48, v49
    v_cvt_pk_bf16_f32 v97, v50, v51
    v_cvt_pk_bf16_f32 v98, v52, v53
    v_cvt_pk_bf16_f32 v99, v54, v55
    v_cvt_pk_bf16_f32 v100, v56, v57
    v_cvt_pk_bf16_f32 v101, v58, v59
    v_cvt_pk_bf16_f32 v102, v60, v61
    v_cvt_pk_bf16_f32 v103, v62, v63
    v_cndmask_b32 v102, v102, 0, s[44:45]
    v_cndmask_b32 v103, v103, 0, s[44:45]
    ds_write_b64 v119, v[96:97] offset:0
    ds_write_b64 v119, v[98:99] offset:16
    ds_write_b64 v119, v[100:101] offset:32
    ds_write_b64 v119, v[102:103] offset:48
    v_pk_mul_f32 v[16:17], v[16:17], v[94:95] op_sel_hi:[1,0]
    v_pk_mul_f32 v[18:19], v[18:19], v[94:95] op_sel_hi:[1,0]
    v_pk_mul_f32 v[20:21], v[20:21], v[94:95] op_sel_hi:[1,0]
    v_pk_mul_f32 v[22:23], v[22:23], v[94:95] op_sel_hi:[1,0]
    v_pk_mul_f32 v[24:25], v[24:25], v[94:95] op_sel_hi:[1,0]
    v_pk_mul_f32 v[26:27], v[26:27], v[94:95] op_sel_hi:[1,0]
    v_pk_mul_f32 v[28:29], v[28:29], v[94:95] op_sel_hi:[1,0]
    v_pk_mul_f32 v[30:31], v[30:31], v[94:95] op_sel_hi:[1,0]
    v_cvt_pk_bf16_f32 v104, v16, v17
    v_cvt_pk_bf16_f32 v105, v18, v19
    v_cvt_pk_bf16_f32 v106, v20, v21
    v_cvt_pk_bf16_f32 v107, v22, v23
    v_cvt_pk_bf16_f32 v108, v24, v25
    v_cvt_pk_bf16_f32 v109, v26, v27
    v_cvt_pk_bf16_f32 v110, v28, v29
    v_cvt_pk_bf16_f32 v111, v30, v31
    v_cndmask_b32 v110, v110, 0, s[44:45]
    v_cndmask_b32 v111, v111, 0, s[44:45]
    ds_write_b64 v119, v[104:105] offset:64
    ds_write_b64 v119, v[106:107] offset:80
    ds_write_b64 v119, v[108:109] offset:96
    ds_write_b64 v119, v[110:111] offset:112
    s_waitcnt vmcnt(5) lgkmcnt(0)
    s_barrier
    ds_read_b64_tr_b16 v[16:17], v125 offset:0
    ds_read_b64_tr_b16 v[18:19], v125 offset:1088
    ds_read_b128 v[32:35], v127 offset:0
    ds_read_b128 v[36:39], v127 offset:256
    ds_read_b64_tr_b16 v[20:21], v125 offset:4352
    ds_read_b64_tr_b16 v[22:23], v125 offset:5440
    ds_read_b128 v[40:43], v127 offset:2048
    ds_read_b128 v[44:47], v127 offset:2304
    ds_read_b64_tr_b16 v[24:25], v125 offset:8704
    ds_read_b64_tr_b16 v[26:27], v125 offset:9792
    ds_read_b128 v[48:51], v127 offset:4096
    ds_read_b128 v[52:55], v127 offset:4352
    ds_read_b64_tr_b16 v[28:29], v125 offset:13056
    ds_read_b64_tr_b16 v[30:31], v125 offset:14144
    ds_read_b128 v[56:59], v127 offset:6144
    s_waitcnt lgkmcnt(12)
    ds_read_b128 v[60:63], v127 offset:6400
    s_waitcnt lgkmcnt(12)
    v_mfma_f32_16x16x32_bf16 v[72:75], v[16:19], v[32:35], 0
    v_mfma_f32_16x16x32_bf16 v[76:79], v[16:19], v[36:39], 0
    s_waitcnt lgkmcnt(8)
    v_mfma_f32_16x16x32_bf16 v[72:75], v[20:23], v[40:43], v[72:75]
    v_mfma_f32_16x16x32_bf16 v[76:79], v[20:23], v[44:47], v[76:79]
    s_waitcnt lgkmcnt(4)
    v_mfma_f32_16x16x32_bf16 v[72:75], v[24:27], v[48:51], v[72:75]
    v_mfma_f32_16x16x32_bf16 v[76:79], v[24:27], v[52:55], v[76:79]
    s_waitcnt lgkmcnt(0)
    v_mfma_f32_16x16x32_bf16 v[72:75], v[28:31], v[56:59], v[72:75]
    v_mfma_f32_16x16x32_bf16 v[76:79], v[28:31], v[60:63], v[76:79]
    s_nop 6
    v_cvt_pk_bf16_f32 v72, v72, v73
    v_cvt_pk_bf16_f32 v73, v74, v75
    v_cvt_pk_bf16_f32 v74, v76, v77
    v_cvt_pk_bf16_f32 v75, v78, v79
    buffer_store_dwordx4 v[72:75], v9, s[8:11], s28 offen sc1
    s_waitcnt vmcnt(8)
    s_branch L_b0_t
L_b0_lp:
    s_sleep 32
    buffer_load_dwordx4 v[240:243], v11, s[12:15], 0 offen sc1
    s_add_u32 s60, s60, 1
    s_cmp_gt_u32 s60, 100000
    s_cbranch_scc1 L_exit
    s_waitcnt vmcnt(0)
L_b0_t:
    v_and_b32 v12, 0xff, v240
    v_readfirstlane_b32 s31, v242
    v_cmp_ne_u32 vcc, 32, v12
    s_lshr_b32 s30, s93, 5
    s_cbranch_vccnz L_b0_lp
    s_cmp_lg_u32 s31, 28
    s_cbranch_scc1 L_b0_lp
    v_readlane_b32 s28, v240, s30
    v_readlane_b32 s29, v241, s30
    s_nop 3
    s_lshr_b64 s[28:29], s[28:29], s63
    s_and_b32 s28, s28, 63
    s_cmp_eq_u32 s28, 32
    s_cselect_b32 s6, 1, 0
    s_cmp_ge_u32 s4, 7
    s_cbranch_scc1 dq_5
    v_add_u32 v12, s95, v254
    ds_read_b64_tr_b16 v[244:245], v12
    ds_read_b64_tr_b16 v[246:247], v12 offset:256
    s_waitcnt lgkmcnt(0)
    buffer_store_dwordx4 v[244:247], v1, s[8:11], s97 offen sc1
dq_5:
    s_add_u32 s32, s90, 7487488
    s_add_u32 s40, s1, 2752512
    buffer_load_dwordx4 a[0:3], v3, s[8:11], s40 offen sc1
    s_add_u32 s40, s1, 2753536
    buffer_load_dwordx4 a[4:7], v3, s[8:11], s40 offen sc1
    s_add_u32 s40, s1, 2754560
    buffer_load_dwordx4 a[8:11], v3, s[8:11], s40 offen sc1
    s_add_u32 s40, s1, 2755584
    buffer_load_dwordx4 a[12:15], v3, s[8:11], s40 offen sc1
    v_sub_u32 v248, v248, v254
    v_lshrrev_b32 v248, 1, v248
    v_add3_u32 v248, v248, v254, s100
    v_sub_u32 v249, v249, v254
    v_lshrrev_b32 v249, 1, v249
    v_add3_u32 v249, v249, v254, s100
    v_sub_u32 v250, v250, v254
    v_lshrrev_b32 v250, 1, v250
    v_add3_u32 v250, v250, v254, s100
    v_sub_u32 v251, v251, v254
    v_lshrrev_b32 v251, 1, v251
    v_add3_u32 v251, v251, v254, s100
    ds_read_b64_tr_b16 v[88:89], v248 offset:0
    ds_read_b64_tr_b16 v[90:91], v248 offset:256
    ds_read_b64_tr_b16 v[92:93], v248 offset:4096
    ds_read_b64_tr_b16 v[94:95], v248 offset:4352
    ds_read_b64_tr_b16 v[96:97], v248 offset:8192
    ds_read_b64_tr_b16 v[98:99], v248 offset:8448
    ds_read_b64_tr_b16 v[100:101], v248 offset:12288
    ds_read_b64_tr_b16 v[102:103], v248 offset:12544
    ds_read_b64_tr_b16 v[104:105], v248 offset:16384
    ds_read_b64_tr_b16 v[106:107], v248 offset:16640
    s_waitcnt lgkmcnt(8)
    v_mfma_f32_32x32x16_bf16 v[48:63], v[88:91], v[128:131], 0
    v_mfma_f32_32x32x16_bf16 v[32:47], v[112:115], v[88:91], 0
    s_add_u32 s40, s87, 5652480
    s_add_u32 s41, s101, 5652480
    s_cmp_eq_u32 s3, 3
    s_cselect_b32 s41, s40, s41
    s_cmp_eq_u32 s6, 0
    s_cbranch_scc1 ls_6
    buffer_store_dwordx4 a[248:251], v1, s[8:11], s40 offen
    buffer_store_dwordx4 a[248:251], v1, s[8:11], s41 offen
le_7:
    ds_read_b64_tr_b16 v[108:109], v248 offset:20480
    ds_read_b64_tr_b16 v[110:111], v248 offset:20736
    s_waitcnt lgkmcnt(8)
    v_mfma_f32_32x32x16_bf16 v[48:63], v[92:95], v[144:147], v[48:63]
    v_mfma_f32_32x32x16_bf16 v[32:47], v[112:115], v[92:95], v[32:47]
    s_add_u32 s40, s87, 5652480
    s_add_u32 s41, s101, 5652480
    s_cmp_eq_u32 s3, 3
    s_cselect_b32 s41, s40, s41
    s_mov_b32 exec_lo, 0x01010101
    s_mov_b32 exec_hi, 0x01010101
    buffer_load_dword a252, v1, s[8:11], s40 offen sc1
    buffer_load_dword a252, v1, s[8:11], s41 offen sc1
    s_mov_b64 exec, -1
    ds_read_b64_tr_b16 v[88:89], v248 offset:24576
    ds_read_b64_tr_b16 v[90:91], v248 offset:24832
    s_waitcnt lgkmcnt(8)
    v_mfma_f32_32x32x16_bf16 v[48:63], v[96:99], v[160:163], v[48:63]
    v_mfma_f32_32x32x16_bf16 v[32:47], v[112:115], v[96:99], v[32:47]
    s_add_u32 s40, s87, 3555328
    s_add_u32 s41, s101, 3555328
    s_cmp_eq_u32 s6, 0
    s_cbranch_scc1 ls_8
    buffer_store_dwordx4 a[248:251], v1, s[8:11], s40 offen
    buffer_store_dwordx4 a[248:251], v1, s[8:11], s41 offen
le_9:
    ds_read_b64_tr_b16 v[92:93], v249 offset:0
    ds_read_b64_tr_b16 v[94:95], v249 offset:256
    s_waitcnt lgkmcnt(8)
    v_mfma_f32_32x32x16_bf16 v[48:63], v[100:103], v[176:179], v[48:63]
    v_mfma_f32_32x32x16_bf16 v[32:47], v[112:115], v[100:103], v[32:47]
    s_add_u32 s40, s87, 3555328
    s_add_u32 s41, s101, 3555328
    s_mov_b32 exec_lo, 0x01010101
    s_mov_b32 exec_hi, 0x01010101
    buffer_load_dword a252, v1, s[8:11], s40 offen sc1
    buffer_load_dword a252, v1, s[8:11], s41 offen sc1
    s_mov_b64 exec, -1
    ds_read_b64_tr_b16 v[96:97], v250 offset:0
    ds_read_b64_tr_b16 v[98:99], v250 offset:256
    s_waitcnt lgkmcnt(8)
    v_mfma_f32_32x32x16_bf16 v[48:63], v[104:107], v[192:195], v[48:63]
    v_mfma_f32_32x32x16_bf16 v[32:47], v[112:115], v[104:107], v[32:47]
    ds_read_b64_tr_b16 v[100:101], v251 offset:0
    ds_read_b64_tr_b16 v[102:103], v251 offset:256
    s_waitcnt lgkmcnt(8)
    v_mfma_f32_32x32x16_bf16 v[48:63], v[108:111], v[208:211], v[48:63]
    v_mfma_f32_32x32x16_bf16 v[32:47], v[112:115], v[108:111], v[32:47]
    ds_read_b64_tr_b16 v[104:105], v249 offset:4096
    ds_read_b64_tr_b16 v[106:107], v249 offset:4352
    s_waitcnt lgkmcnt(8)
    v_mfma_f32_32x32x16_bf16 v[48:63], v[88:91], v[224:227], v[48:63]
    v_mfma_f32_32x32x16_bf16 v[32:47], v[112:115], v[88:91], v[32:47]
    ds_read_b64_tr_b16 v[108:109], v250 offset:4096
    ds_read_b64_tr_b16 v[110:111], v250 offset:4352
    s_waitcnt lgkmcnt(8)
    v_mfma_f32_32x32x16_bf16 v[48:63], v[92:95], v[132:135], v[48:63]
    ds_read_b64_tr_b16 v[88:89], v251 offset:4096
    ds_read_b64_tr_b16 v[90:91], v251 offset:4352
    s_waitcnt lgkmcnt(8)
    v_mfma_f32_32x32x16_bf16 v[48:63], v[96:99], v[136:139], v[48:63]
    s_mov_b32 exec_hi, 0
    s_nop 2
    ds_write_b32 v123, v32 offset:1024
    s_mov_b64 exec, -1
    ds_read_b64_tr_b16 v[92:93], v249 offset:8192
    ds_read_b64_tr_b16 v[94:95], v249 offset:8448
    s_waitcnt lgkmcnt(8)
    v_mfma_f32_32x32x16_bf16 v[48:63], v[100:103], v[140:143], v[48:63]
    ds_read_b64_tr_b16 v[96:97], v250 offset:8192
    ds_read_b64_tr_b16 v[98:99], v250 offset:8448
    s_waitcnt lgkmcnt(8)
    v_mfma_f32_32x32x16_bf16 v[48:63], v[104:107], v[148:151], v[48:63]
    ds_read_b64_tr_b16 v[100:101], v251 offset:8192
    ds_read_b64_tr_b16 v[102:103], v251 offset:8448
    s_waitcnt lgkmcnt(8)
    v_mfma_f32_32x32x16_bf16 v[48:63], v[108:111], v[152:155], v[48:63]
    ds_read_b64_tr_b16 v[104:105], v249 offset:12288
    ds_read_b64_tr_b16 v[106:107], v249 offset:12544
    s_waitcnt lgkmcnt(8)
    v_mfma_f32_32x32x16_bf16 v[48:63], v[88:91], v[156:159], v[48:63]
    s_waitcnt lgkmcnt(8)
    s_barrier
    v_and_b32 v12, 0x1ff, v1
    v_add_u32 v12, 87040, v12
    ds_read_b128 v[12:15], v12
    ds_read_b64_tr_b16 v[108:109], v250 offset:12288
    ds_read_b64_tr_b16 v[110:111], v250 offset:12544
    s_waitcnt lgkmcnt(8)
    v_mfma_f32_32x32x16_bf16 v[48:63], v[92:95], v[164:167], v[48:63]
    ds_read_b64_tr_b16 v[88:89], v251 offset:12288
    ds_read_b64_tr_b16 v[90:91], v251 offset:12544
    s_waitcnt lgkmcnt(8)
    v_mfma_f32_32x32x16_bf16 v[48:63], v[96:99], v[168:171], v[48:63]
    buffer_load_dword v64, v10, s[8:11], s32 offen offset:0 sc1
    buffer_load_dword v65, v10, s[8:11], s32 offen offset:1024 sc1
    buffer_load_dword v66, v10, s[8:11], s32 offen offset:2048 sc1
    buffer_load_dword v67, v10, s[8:11], s32 offen offset:3072 sc1
    ds_read_b64_tr_b16 v[92:93], v249 offset:16384
    ds_read_b64_tr_b16 v[94:95], v249 offset:16640
    s_waitcnt lgkmcnt(8)
    v_mfma_f32_32x32x16_bf16 v[48:63], v[100:103], v[172:175], v[48:63]
    s_add_u32 s40, s1, 2756608
    buffer_load_dwordx4 a[16:19], v3, s[8:11], s40 offen sc1
    ds_read_b64_tr_b16 v[96:97], v250 offset:16384
    ds_read_b64_tr_b16 v[98:99], v250 offset:16640
    s_waitcnt lgkmcnt(8)
    v_mfma_f32_32x32x16_bf16 v[48:63], v[104:107], v[180:183], v[48:63]
    ds_read_b64_tr_b16 v[100:101], v251 offset:16384
    ds_read_b64_tr_b16 v[102:103], v251 offset:16640
    s_waitcnt lgkmcnt(8)
    v_mfma_f32_32x32x16_bf16 v[48:63], v[108:111], v[184:187], v[48:63]
    v_add_f32 v12, v12, v13
    v_add_f32 v14, v14, v15
    v_add_f32 v12, v12, v14
    s_mov_b32 exec_hi, 0
    v_accvgpr_write_b32 a255, v12
    s_mov_b64 exec, -1
    ds_write_b32 v121, v12 offset:1024
    ds_read_b128 v[16:19], v122 offset:1024
    ds_read_b128 v[20:23], v122 offset:1056
    ds_read_b128 v[24:27], v122 offset:1088
    ds_read_b128 v[28:31], v122 offset:1120
    ds_read_b64_tr_b16 v[104:105], v249 offset:20480
    ds_read_b64_tr_b16 v[106:107], v249 offset:20736
    s_waitcnt lgkmcnt(8)
    v_mfma_f32_32x32x16_bf16 v[48:63], v[88:91], v[188:191], v[48:63]
    s_add_u32 s40, s1, 2757632
    buffer_load_dwordx4 a[20:23], v3, s[8:11], s40 offen sc1
    ds_read_b64_tr_b16 v[108:109], v250 offset:20480
    ds_read_b64_tr_b16 v[110:111], v250 offset:20736
    s_waitcnt lgkmcnt(8)
    v_mfma_f32_32x32x16_bf16 v[48:63], v[92:95], v[196:199], v[48:63]
    ds_read_b64_tr_b16 v[88:89], v251 offset:20480
    ds_read_b64_tr_b16 v[90:91], v251 offset:20736
    s_waitcnt lgkmcnt(8)
    v_mfma_f32_32x32x16_bf16 v[48:63], v[96:99], v[200:203], v[48:63]
    ds_read_b64_tr_b16 v[92:93], v249 offset:24576
    ds_read_b64_tr_b16 v[94:95], v249 offset:24832
    s_waitcnt lgkmcnt(8)
    v_mfma_f32_32x32x16_bf16 v[48:63], v[100:103], v[204:207], v[48:63]
    s_add_u32 s40, s1, 2758656
    buffer_load_dwordx4 a[24:27], v3, s[8:11], s40 offen sc1
    ds_read_b64_tr_b16 v[96:97], v250 offset:24576
    ds_read_b64_tr_b16 v[98:99], v250 offset:24832
    s_waitcnt lgkmcnt(8)
    v_mfma_f32_32x32x16_bf16 v[48:63], v[104:107], v[212:215], v[48:63]
    ds_read_b64_tr_b16 v[100:101], v251 offset:24576
    ds_read_b64_tr_b16 v[102:103], v251 offset:24832
    s_waitcnt lgkmcnt(8)
    v_mfma_f32_32x32x16_bf16 v[48:63], v[108:111], v[216:219], v[48:63]
    s_waitcnt lgkmcnt(6)
    v_mfma_f32_32x32x16_bf16 v[48:63], v[88:91], v[220:223], v[48:63]
    v_mul_f32 v16, v16, v118
    v_mul_f32 v17, v17, v118
    v_mul_f32 v18, v18, v118
    v_mul_f32 v19, v19, v118
    s_add_u32 s40, s1, 2752512
    buffer_load_dwordx4 a[28:31], v4, s[8:11], s40 offen sc1
    s_waitcnt lgkmcnt(4)
    v_mfma_f32_32x32x16_bf16 v[48:63], v[92:95], v[228:231], v[48:63]
    v_mul_f32 v20, v20, v118
    v_mul_f32 v21, v21, v118
    v_mul_f32 v22, v22, v118
    v_mul_f32 v23, v23, v118
    s_waitcnt lgkmcnt(2)
    v_mfma_f32_32x32x16_bf16 v[48:63], v[96:99], v[232:235], v[48:63]
    v_mul_f32 v24, v24, v118
    v_mul_f32 v25, v25, v118
    v_mul_f32 v26, v26, v118
    v_mul_f32 v27, v27, v118
    s_waitcnt lgkmcnt(0)
    v_mfma_f32_32x32x16_bf16 v[48:63], v[100:103], v[236:239], v[48:63]
    v_mul_f32 v28, v28, v118
    v_mul_f32 v29, v29, v118
    v_mul_f32 v30, v30, v118
    v_mul_f32 v31, v31, v118
    s_add_u32 s40, s1, 2753536
    buffer_load_dwordx4 a[32:35], v4, s[8:11], s40 offen sc1
    s_add_u32 s40, s1, 2754560
    buffer_load_dwordx4 a[36:39], v4, s[8:11], s40 offen sc1
    v_lshrrev_b32 v70, 4, v2
    v_and_b32 v71, 0x3c, v10
    v_lshl_add_u32 v70, v70, 16, v71
    s_branch gk_10
gl_11:
    s_sleep 2
    buffer_load_dword v64, v10, s[8:11], s32 offen offset:0 sc1
    buffer_load_dword v65, v10, s[8:11], s32 offen offset:1024 sc1
    buffer_load_dword v66, v10, s[8:11], s32 offen offset:2048 sc1
    buffer_load_dword v67, v10, s[8:11], s32 offen offset:3072 sc1
    s_add_u32 s60, s60, 1
    s_cmp_gt_u32 s60, 100000
    s_cbranch_scc1 L_exit
    s_waitcnt vmcnt(0)
gk_10:
    s_waitcnt vmcnt(6)
    v_max3_u32 v120, v64, v65, v66
    v_max_u32 v120, v120, v67
    v_cmp_eq_u32 vcc, -1, v120
    s_nop 0
    s_cbranch_vccnz gl_11
    v_lshlrev_b32 v72, 16, v64
    v_and_b32 v73, 0xffff0000, v64
    v_lshlrev_b32 v74, 16, v65
    v_and_b32 v75, 0xffff0000, v65
    v_lshlrev_b32 v76, 16, v66
    v_and_b32 v77, 0xffff0000, v66
    v_lshlrev_b32 v78, 16, v67
    v_and_b32 v79, 0xffff0000, v67
    v_pk_add_f32 v[72:73], v[72:73], v[74:75]
    v_pk_add_f32 v[76:77], v[76:77], v[78:79]
    v_pk_add_f32 v[72:73], v[72:73], v[76:77]
    v_mov_b64 v[74:75], v[72:73]
    s_nop 1
    v_permlane16_swap_b32 v72, v74
    v_permlane16_swap_b32 v73, v75
    v_pk_add_f32 v[72:73], v[72:73], v[74:75]
    v_mov_b64 v[74:75], v[72:73]
    s_nop 1
    v_permlane32_swap_b32 v72, v74
    v_permlane32_swap_b32 v73, v75
    v_pk_add_f32 v[72:73], v[72:73], v[74:75]
    v_cvt_pk_bf16_f32 v72, v72, v73
    s_add_u32 s28, s92, 9584640
    s_mov_b64 exec, 0xffff
    buffer_store_dword v72, v10, s[8:11], s28 offen sc1
    s_mov_b64 exec, -1
    s_barrier
    s_lshl_b32 s34, s4, 7
    s_add_u32 s34, s34, 18104320
    s_lshl_b32 s35, s5, 3
    s_add_u32 s35, s35, s34
    v_and_b32 v242, 0x78, v8
    s_cmp_lg_u32 s3, 0
    s_cbranch_scc1 L_r1_skip
    s_cmp_eq_u32 s6, 0
    s_cbranch_scc1 ls_12
    s_mov_b64 exec, 1
    buffer_store_dword v2, off, s[8:11], s35
    s_mov_b64 exec, -1
le_13:
L_r1_skip:
    v_pk_fma_f32 v[48:49], v[48:49], v[116:117], v[16:17] op_sel_hi:[1,0,1]
    v_pk_fma_f32 v[50:51], v[50:51], v[116:117], v[18:19] op_sel_hi:[1,0,1]
    v_pk_fma_f32 v[52:53], v[52:53], v[116:117], v[20:21] op_sel_hi:[1,0,1]
    v_pk_fma_f32 v[54:55], v[54:55], v[116:117], v[22:23] op_sel_hi:[1,0,1]
    v_pk_fma_f32 v[56:57], v[56:57], v[116:117], v[24:25] op_sel_hi:[1,0,1]
    v_pk_fma_f32 v[58:59], v[58:59], v[116:117], v[26:27] op_sel_hi:[1,0,1]
    v_pk_fma_f32 v[60:61], v[60:61], v[116:117], v[28:29] op_sel_hi:[1,0,1]
    v_pk_fma_f32 v[62:63], v[62:63], v[116:117], v[30:31] op_sel_hi:[1,0,1]
    v_cvt_pk_bf16_f32 v80, v48, v49
    v_cvt_pk_bf16_f32 v81, v50, v51
    v_cvt_pk_bf16_f32 v82, v52, v53
    v_cvt_pk_bf16_f32 v83, v54, v55
    v_cvt_pk_bf16_f32 v84, v56, v57
    v_cvt_pk_bf16_f32 v85, v58, v59
    v_cvt_pk_bf16_f32 v86, v60, v61
    v_cvt_pk_bf16_f32 v87, v62, v63
    v_cndmask_b32 v86, v86, 0, s[44:45]
    v_cndmask_b32 v87, v87, 0, s[44:45]
    v_mfma_f32_32x32x16_bf16 v[16:31], a[232:235], v[80:83], 0
    s_nop 0
    v_mfma_f32_32x32x16_bf16 v[16:31], a[236:239], v[84:87], v[16:31]
    v_mov_b32 v92, s61
    s_add_u32 s40, s1, 2755584
    buffer_load_dwordx4 a[40:43], v4, s[8:11], s40 offen sc1
    s_add_u32 s40, s1, 2756608
    buffer_load_dwordx4 a[44:47], v4, s[8:11], s40 offen sc1
    s_nop 6
    v_max_f32 v88, v16, v17
    v_min_f32 v90, v16, v17
    v_max3_f32 v88, v88, v18, v19
    v_min3_f32 v90, v90, v18, v19
    v_max3_f32 v88, v88, v20, v21
    v_min3_f32 v90, v90, v20, v21
    v_max3_f32 v88, v88, v22, v23
    v_min3_f32 v90, v90, v22, v23
    v_max3_f32 v88, v88, v24, v25
    v_min3_f32 v90, v90, v24, v25
    v_max3_f32 v88, v88, v26, v27
    v_min3_f32 v90, v90, v26, v27
    s_mov_b32 exec_hi, 0
    v_max3_f32 v88, v88, v28, v29
    v_min3_f32 v90, v90, v28, v29
    v_max3_f32 v88, v88, v30, v31
    v_min3_f32 v90, v90, v30, v31
    s_mov_b64 exec, -1
    v_mov_b32 v89, v88
    v_mov_b32 v91, v90
    s_add_u32 s40, s1, 2757632
    buffer_load_dwordx4 a[48:51], v4, s[8:11], s40 offen sc1
    v_permlane32_swap_b32 v88, v89
    v_permlane32_swap_b32 v90, v91
    v_max_f32 v88, v88, v89
    v_min_f32 v90, v90, v91
    v_mul_f32 v88, s61, v88
    v_mul_f32 v90, s61, v90
    v_pk_fma_f32 v[32:33], v[16:17], v[92:93], v[90:91] op_sel_hi:[1,0,0] neg_lo:[1,0,0] neg_hi:[1,0,0]
    v_pk_fma_f32 v[16:17], v[16:17], v[92:93], v[88:89] op_sel_hi:[1,0,0] neg_lo:[0,0,1] neg_hi:[0,0,1]
    v_pk_fma_f32 v[34:35], v[18:19], v[92:93], v[90:91] op_sel_hi:[1,0,0] neg_lo:[1,0,0] neg_hi:[1,0,0]
    v_pk_fma_f32 v[18:19], v[18:19], v[92:93], v[88:89] op_sel_hi:[1,0,0] neg_lo:[0,0,1] neg_hi:[0,0,1]
    v_pk_fma_f32 v[36:37], v[20:21], v[92:93], v[90:91] op_sel_hi:[1,0,0] neg_lo:[1,0,0] neg_hi:[1,0,0]
    v_pk_fma_f32 v[20:21], v[20:21], v[92:93], v[88:89] op_sel_hi:[1,0,0] neg_lo:[0,0,1] neg_hi:[0,0,1]
    v_pk_fma_f32 v[38:39], v[22:23], v[92:93], v[90:91] op_sel_hi:[1,0,0] neg_lo:[1,0,0] neg_hi:[1,0,0]
    v_pk_fma_f32 v[22:23], v[22:23], v[92:93], v[88:89] op_sel_hi:[1,0,0] neg_lo:[0,0,1] neg_hi:[0,0,1]
    v_pk_fma_f32 v[40:41], v[24:25], v[92:93], v[90:91] op_sel_hi:[1,0,0] neg_lo:[1,0,0] neg_hi:[1,0,0]
    v_pk_fma_f32 v[24:25], v[24:25], v[92:93], v[88:89] op_sel_hi:[1,0,0] neg_lo:[0,0,1] neg_hi:[0,0,1]
    v_pk_fma_f32 v[42:43], v[26:27], v[92:93], v[90:91] op_sel_hi:[1,0,0] neg_lo:[1,0,0] neg_hi:[1,0,0]
    v_pk_fma_f32 v[26:27], v[26:27], v[92:93], v[88:89] op_sel_hi:[1,0,0] neg_lo:[0,0,1] neg_hi:[0,0,1]
    v_pk_fma_f32 v[44:45], v[28:29], v[92:93], v[90:91] op_sel_hi:[1,0,0] neg_lo:[1,0,0] neg_hi:[1,0,0]
    v_pk_fma_f32 v[28:29], v[28:29], v[92:93], v[88:89] op_sel_hi:[1,0,0] neg_lo:[0,0,1] neg_hi:[0,0,1]
    v_pk_fma_f32 v[46:47], v[30:31], v[92:93], v[90:91] op_sel_hi:[1,0,0] neg_lo:[1,0,0] neg_hi:[1,0,0]
    v_pk_fma_f32 v[30:31], v[30:31], v[92:93], v[88:89] op_sel_hi:[1,0,0] neg_lo:[0,0,1] neg_hi:[0,0,1]
    s_add_u32 s40, s1, 2758656
    buffer_load_dwordx4 a[52:55], v4, s[8:11], s40 offen sc1
    v_exp_f32 v16, v16
    v_exp_f32 v32, v32
    v_exp_f32 v17, v17
    v_exp_f32 v33, v33
    v_exp_f32 v18, v18
    v_exp_f32 v34, v34
    v_exp_f32 v19, v19
    v_exp_f32 v35, v35
    s_add_u32 s40, s1, 2752512
    buffer_load_dwordx4 a[56:59], v5, s[8:11], s40 offen sc1
    v_exp_f32 v20, v20
    v_exp_f32 v36, v36
    v_exp_f32 v21, v21
    v_exp_f32 v37, v37
    v_exp_f32 v22, v22
    v_exp_f32 v38, v38
    v_exp_f32 v23, v23
    v_exp_f32 v39, v39
    s_add_u32 s40, s1, 2753536
    buffer_load_dwordx4 a[60:63], v5, s[8:11], s40 offen sc1
    v_exp_f32 v24, v24
    v_exp_f32 v40, v40
    v_exp_f32 v25, v25
    v_exp_f32 v41, v41
    v_exp_f32 v26, v26
    v_exp_f32 v42, v42
    v_exp_f32 v27, v27
    v_exp_f32 v43, v43
    s_add_u32 s40, s1, 2754560
    buffer_load_dwordx4 a[64:67], v5, s[8:11], s40 offen sc1
    v_exp_f32 v28, v28
    v_exp_f32 v44, v44
    v_exp_f32 v29, v29
    v_exp_f32 v45, v45
    v_exp_f32 v30, v30
    v_exp_f32 v46, v46
    v_exp_f32 v31, v31
    v_exp_f32 v47, v47
    s_add_u32 s40, s1, 2755584
    buffer_load_dwordx4 a[68:71], v5, s[8:11], s40 offen sc1
    v_pk_add_f32 v[92:93], v[16:17], v[18:19]
    v_pk_add_f32 v[94:95], v[32:33], v[34:35]
    v_pk_add_f32 v[92:93], v[92:93], v[20:21]
    v_pk_add_f32 v[94:95], v[94:95], v[36:37]
    v_pk_add_f32 v[92:93], v[92:93], v[22:23]
    v_pk_add_f32 v[94:95], v[94:95], v[38:39]
    v_pk_add_f32 v[92:93], v[92:93], v[24:25]
    v_pk_add_f32 v[94:95], v[94:95], v[40:41]
    v_pk_add_f32 v[92:93], v[92:93], v[26:27]
    v_pk_add_f32 v[94:95], v[94:95], v[42:43]
    s_mov_b32 exec_hi, 0
    v_pk_add_f32 v[92:93], v[92:93], v[28:29]
    v_pk_add_f32 v[94:95], v[94:95], v[44:45]
    v_pk_add_f32 v[92:93], v[92:93], v[30:31]
    v_pk_add_f32 v[94:95], v[94:95], v[46:47]
    s_mov_b64 exec, -1
    s_add_u32 s40, s1, 2756608
    buffer_load_dwordx4 a[72:75], v5, s[8:11], s40 offen sc1
    v_add_f32 v92, v92, v93
    v_add_f32 v94, v94, v95
    v_mov_b32 v93, v92
    v_mov_b32 v95, v94
    s_add_u32 s40, s1, 2757632
    buffer_load_dwordx4 a[76:79], v5, s[8:11], s40 offen sc1
    v_permlane32_swap_b32 v92, v93
    v_permlane32_swap_b32 v94, v95
    v_add_f32 v92, v92, v93
    v_add_f32 v94, v94, v95
    v_rcp_f32 v92, v92
    v_rcp_f32 v94, v94
    v_pk_mul_f32 v[16:17], v[16:17], v[92:93] op_sel_hi:[1,0]
    v_pk_mul_f32 v[18:19], v[18:19], v[92:93] op_sel_hi:[1,0]
    v_pk_mul_f32 v[20:21], v[20:21], v[92:93] op_sel_hi:[1,0]
    v_pk_mul_f32 v[22:23], v[22:23], v[92:93] op_sel_hi:[1,0]
    v_pk_mul_f32 v[24:25], v[24:25], v[92:93] op_sel_hi:[1,0]
    v_pk_mul_f32 v[26:27], v[26:27], v[92:93] op_sel_hi:[1,0]
    v_pk_mul_f32 v[28:29], v[28:29], v[92:93] op_sel_hi:[1,0]
    v_pk_mul_f32 v[30:31], v[30:31], v[92:93] op_sel_hi:[1,0]
    v_cvt_pk_bf16_f32 v96, v16, v17
    v_cvt_pk_bf16_f32 v97, v18, v19
    v_cvt_pk_bf16_f32 v98, v20, v21
    v_cvt_pk_bf16_f32 v99, v22, v23
    v_cvt_pk_bf16_f32 v100, v24, v25
    v_cvt_pk_bf16_f32 v101, v26, v27
    v_cvt_pk_bf16_f32 v102, v28, v29
    v_cvt_pk_bf16_f32 v103, v30, v31
    v_cndmask_b32 v102, v102, 0, s[44:45]
    v_cndmask_b32 v103, v103, 0, s[44:45]
    s_add_u32 s40, s1, 2758656
    buffer_load_dwordx4 a[80:83], v5, s[8:11], s40 offen sc1
    v_pk_mul_f32 v[32:33], v[32:33], v[94:95] op_sel_hi:[1,0]
    v_pk_mul_f32 v[34:35], v[34:35], v[94:95] op_sel_hi:[1,0]
    v_pk_mul_f32 v[36:37], v[36:37], v[94:95] op_sel_hi:[1,0]
    v_pk_mul_f32 v[38:39], v[38:39], v[94:95] op_sel_hi:[1,0]
    v_pk_mul_f32 v[40:41], v[40:41], v[94:95] op_sel_hi:[1,0]
    v_pk_mul_f32 v[42:43], v[42:43], v[94:95] op_sel_hi:[1,0]
    v_pk_mul_f32 v[44:45], v[44:45], v[94:95] op_sel_hi:[1,0]
    v_pk_mul_f32 v[46:47], v[46:47], v[94:95] op_sel_hi:[1,0]
    v_cvt_pk_bf16_f32 v104, v32, v33
    v_cvt_pk_bf16_f32 v105, v34, v35
    v_cvt_pk_bf16_f32 v106, v36, v37
    v_cvt_pk_bf16_f32 v107, v38, v39
    v_cvt_pk_bf16_f32 v108, v40, v41
    v_cvt_pk_bf16_f32 v109, v42, v43
    v_cvt_pk_bf16_f32 v110, v44, v45
    v_cvt_pk_bf16_f32 v111, v46, v47
    v_cndmask_b32 v110, v110, 0, s[44:45]
    v_cndmask_b32 v111, v111, 0, s[44:45]
    s_add_u32 s40, s1, 2752512
    buffer_load_dwordx4 a[84:87], v6, s[8:11], s40 offen sc1
    s_add_u32 s33, s91, 9584640
    v_and_b32 v68, 0xf0, v1
    v_bfe_u32 v69, v2, 4, 1
    v_lshl_add_u32 v68, v69, 3, v68
    v_lshrrev_b32 v69, 5, v2
    v_lshl_add_u32 v68, v69, 8, v68
    buffer_load_dwordx2 v[48:49], v68, s[8:11], s33 offen offset:0 sc1
    buffer_load_dwordx2 v[50:51], v68, s[8:11], s33 offen offset:512 sc1
    buffer_load_dwordx2 v[52:53], v68, s[8:11], s33 offen offset:1024 sc1
    buffer_load_dwordx2 v[54:55], v68, s[8:11], s33 offen offset:1536 sc1
    buffer_load_dwordx2 v[56:57], v68, s[8:11], s33 offen offset:2048 sc1
    buffer_load_dwordx2 v[58:59], v68, s[8:11], s33 offen offset:2560 sc1
    buffer_load_dwordx2 v[60:61], v68, s[8:11], s33 offen offset:3072 sc1
    buffer_load_dwordx2 v[62:63], v68, s[8:11], s33 offen offset:3584 sc1
    buffer_load_dword v240, v242, s[8:11], s34 offen sc1
    s_add_u32 s40, s1, 2753536
    buffer_load_dwordx4 a[88:91], v6, s[8:11], s40 offen sc1
    s_add_u32 s40, s1, 2754560
    buffer_load_dwordx4 a[92:95], v6, s[8:11], s40 offen sc1
    s_add_u32 s40, s1, 2755584
    buffer_load_dwordx4 a[96:99], v6, s[8:11], s40 offen sc1
    s_add_u32 s40, s1, 2756608
    buffer_load_dwordx4 a[100:103], v6, s[8:11], s40 offen sc1
    s_add_u32 s40, s1, 2757632
    buffer_load_dwordx4 a[104:107], v6, s[8:11], s40 offen sc1
    s_add_u32 s40, s1, 2758656
    buffer_load_dwordx4 a[108:111], v6, s[8:11], s40 offen sc1
    v_and_b32 v12, 31, v2
    v_mul_u32_u24 v12, 896, v12
    v_lshrrev_b32 v13, 5, v2
    v_lshl_add_u32 v12, v13, 4, v12
    s_min_u32 s40, s54, 13
    s_lshl_b32 s40, s40, 6
    s_add_u32 s40, s40, s52
    buffer_load_dwordx4 a[224:227], v12, s[16:19], s40 offen
    buffer_load_dwordx4 a[228:231], v12, s[16:19], s40 offen offset:32
    s_branch gk_14
gl_15:
    s_sleep 2
    buffer_load_dwordx2 v[48:49], v68, s[8:11], s33 offen offset:0 sc1
    buffer_load_dwordx2 v[50:51], v68, s[8:11], s33 offen offset:512 sc1
    buffer_load_dwordx2 v[52:53], v68, s[8:11], s33 offen offset:1024 sc1
    buffer_load_dwordx2 v[54:55], v68, s[8:11], s33 offen offset:1536 sc1
    buffer_load_dwordx2 v[56:57], v68, s[8:11], s33 offen offset:2048 sc1
    buffer_load_dwordx2 v[58:59], v68, s[8:11], s33 offen offset:2560 sc1
    buffer_load_dwordx2 v[60:61], v68, s[8:11], s33 offen offset:3072 sc1
    buffer_load_dwordx2 v[62:63], v68, s[8:11], s33 offen offset:3584 sc1
    s_add_u32 s60, s60, 1
    s_cmp_gt_u32 s60, 100000
    s_cbranch_scc1 L_exit
    s_waitcnt vmcnt(0)
gk_14:
    s_waitcnt vmcnt(9)
    v_max3_u32 v120, v48, v49, v50
    v_max3_u32 v120, v120, v51, v52
    v_max3_u32 v120, v120, v53, v54
    v_max3_u32 v120, v120, v55, v56
    v_max3_u32 v120, v120, v57, v58
    v_max3_u32 v120, v120, v59, v60
    v_max3_u32 v120, v120, v61, v62
    v_max_u32 v120, v120, v63
    v_cmp_eq_u32 vcc, -1, v120
    s_nop 0
    s_cbranch_vccnz gl_15
    v_mfma_f32_32x32x16_bf16 v[16:31], v[48:51], v[96:99], 0
    v_mfma_f32_32x32x16_bf16 v[16:31], v[52:55], v[100:103], v[16:31]
    v_mfma_f32_32x32x16_bf16 v[16:31], v[56:59], v[104:107], v[16:31]
    v_mfma_f32_32x32x16_bf16 v[16:31], v[60:63], v[108:111], v[16:31]
    v_mov_b32 v241, 0
    s_branch gk_16
gl_17:
    s_sleep 1
    buffer_load_dword v240, v242, s[8:11], s34 offen sc1
    s_add_u32 s60, s60, 1
    s_cmp_gt_u32 s60, 100000
    s_cbranch_scc1 L_exit
    s_waitcnt vmcnt(0)
gk_16:
    s_waitcnt vmcnt(8)
    v_max_u32 v243, v240, v241
    v_cmp_eq_u32 vcc, -1, v243
    s_nop 0
    s_cbranch_vccnz gl_17
    s_nop 4
    v_mov_b32 v12, v28
    v_mov_b32 v13, v28
    s_mul_i32 s28, s5, 7
    s_lshr_b32 s28, s28, 1
    s_lshl_b32 s28, s28, 9
    s_add_u32 s28, s28, s50
    s_add_u32 s28, s28, 5652480
    v_permlane32_swap_b32 v12, v13
    v_add_f32 v13, 0x358637bd, v13
    v_rcp_f32 v12, v13
    s_nop 0
    v_pk_mul_f32 v[16:17], v[16:17], v[12:13] op_sel_hi:[1,0]
    v_pk_mul_f32 v[18:19], v[18:19], v[12:13] op_sel_hi:[1,0]
    v_pk_mul_f32 v[20:21], v[20:21], v[12:13] op_sel_hi:[1,0]
    v_pk_mul_f32 v[22:23], v[22:23], v[12:13] op_sel_hi:[1,0]
    v_pk_mul_f32 v[24:25], v[24:25], v[12:13] op_sel_hi:[1,0]
    v_pk_mul_f32 v[26:27], v[26:27], v[12:13] op_sel_hi:[1,0]
    v_pk_mul_f32 v[28:29], v[28:29], v[12:13] op_sel_hi:[1,0]
    v_pk_mul_f32 v[30:31], v[30:31], v[12:13] op_sel_hi:[1,0]
    v_cvt_pk_bf16_f32 v16, v16, v17
    v_cvt_pk_bf16_f32 v17, v18, v19
    v_cvt_pk_bf16_f32 v18, v20, v21
    v_cvt_pk_bf16_f32 v19, v22, v23
    v_cvt_pk_bf16_f32 v20, v24, v25
    v_cvt_pk_bf16_f32 v21, v26, v27
    v_cvt_pk_bf16_f32 v22, v28, v29
    v_cvt_pk_bf16_f32 v23, v30, v31
    v_and_b32 v16, -2, v16
    v_and_b32 v18, -2, v18
    v_and_b32 v20, -2, v20
    v_and_b32 v22, -2, v22
    s_bitcmp1_b32 s5, 0
    s_cbranch_scc1 oo_18
    v_permlane32_swap_b32 v16, v18
    v_permlane32_swap_b32 v17, v19
    v_permlane32_swap_b32 v20, v22
    v_permlane32_swap_b32 v21, v23
    s_cmp_eq_u32 s6, 0
    s_cbranch_scc1 ls_20
    buffer_store_dwordx4 v[16:19], v1, s[8:11], s28 offen
    s_mov_b32 exec_hi, 0
    buffer_store_dwordx4 v[20:23], v1, s[8:11], s28 offen offset:1024
    s_not_b64 exec, exec
    buffer_store_dwordx2 v[20:21], v1, s[8:11], s28 offen offset:1024
    s_mov_b64 exec, -1
le_21:
    s_branch od_19
oo_18:
    s_nop 1
    v_permlane32_swap_b32 v18, v18
    v_permlane32_swap_b32 v19, v19
    v_permlane32_swap_b32 v22, v22
    v_permlane32_swap_b32 v23, v23
    s_cmp_eq_u32 s6, 0
    s_cbranch_scc1 ls_22
    s_mov_b32 exec_lo, 0
    buffer_store_dwordx4 v[16:19], v1, s[8:11], s28 offen
    buffer_store_dwordx4 v[20:23], v1, s[8:11], s28 offen offset:1024
    s_not_b64 exec, exec
    buffer_store_dwordx4 v[18:21], v1, s[8:11], s28 offen offset:1024
    buffer_store_dwordx2 v[16:17], v1, s[8:11], s28 offen offset:8
    s_mov_b64 exec, -1
le_23:
od_19:
    s_nop 1
    s_waitcnt vmcnt(3)
    s_add_u32 s28, s52, s56
    s_add_u32 s28, s28, 5652480
    s_add_u32 s29, s28, 4096
    v_add_u32 v112, 135168, v3
    v_add_u32 v113, 135168, v4
    v_add_u32 v114, 135168, v5
    v_add_u32 v115, 135168, v6
    s_add_u32 s30, s85, 3555328
    s_add_u32 s31, s86, 3555328
    v_mov_b32 v200, 0
    v_mov_b32 v201, 0
    v_mov_b32 v204, 0x3f803f80
    v_accvgpr_read_b32 v192, a224
    v_accvgpr_read_b32 v193, a225
    v_accvgpr_read_b32 v194, a226
    v_accvgpr_read_b32 v195, a227
    v_accvgpr_read_b32 v196, a228
    v_accvgpr_read_b32 v197, a229
    v_accvgpr_read_b32 v198, a230
    v_accvgpr_read_b32 v199, a231
    v_permlane32_swap_b32 v192, v194
    v_permlane32_swap_b32 v193, v195
    v_permlane32_swap_b32 v196, v198
    v_permlane32_swap_b32 v197, v199
    v_lshlrev_b32 v96, 16, v192
    v_and_b32 v97, 0xffff0000, v192
    v_lshlrev_b32 v98, 16, v193
    v_and_b32 v99, 0xffff0000, v193
    v_lshlrev_b32 v100, 16, v194
    v_and_b32 v101, 0xffff0000, v194
    v_lshlrev_b32 v102, 16, v195
    v_and_b32 v103, 0xffff0000, v195
    v_lshlrev_b32 v104, 16, v196
    v_and_b32 v105, 0xffff0000, v196
    v_lshlrev_b32 v106, 16, v197
    v_and_b32 v107, 0xffff0000, v197
    v_lshlrev_b32 v108, 16, v198
    v_and_b32 v109, 0xffff0000, v198
    v_lshlrev_b32 v110, 16, v199
    v_and_b32 v111, 0xffff0000, v199
    buffer_load_dwordx4 v[128:131], v1, s[8:11], s28 offen offset:0 sc1
    buffer_load_dwordx4 v[132:135], v1, s[8:11], s28 offen offset:1024 sc1
    buffer_load_dwordx4 v[136:139], v1, s[8:11], s28 offen offset:2048 sc1
    buffer_load_dwordx4 v[140:143], v1, s[8:11], s28 offen offset:3072 sc1
    buffer_load_dwordx4 v[144:147], v1, s[8:11], s29 offen offset:0 sc1
    buffer_load_dwordx4 v[148:151], v1, s[8:11], s29 offen offset:1024 sc1
    buffer_load_dwordx4 v[152:155], v1, s[8:11], s29 offen offset:2048 sc1
    s_add_u32 s40, s0, 1376256
    s_add_u32 m0, s56, 0
    s_nop 0
    buffer_load_dwordx4 v1, s[8:11], s40 offen sc1 lds
    s_add_u32 s40, s0, 1377280
    s_add_u32 m0, s56, 1024
    s_nop 0
    buffer_load_dwordx4 v1, s[8:11], s40 offen sc1 lds
    s_add_u32 s40, s0, 1378304
    s_add_u32 m0, s56, 2048
    s_nop 0
    buffer_load_dwordx4 v1, s[8:11], s40 offen sc1 lds
    s_add_u32 s40, s0, 1379328
    s_add_u32 m0, s56, 3072
    s_nop 0
    buffer_load_dwordx4 v1, s[8:11], s40 offen sc1 lds
    s_add_u32 s40, s0, 1380352
    s_add_u32 m0, s56, 4096
    s_nop 0
    buffer_load_dwordx4 v1, s[8:11], s40 offen sc1 lds
    s_add_u32 s40, s0, 1381376
    s_add_u32 m0, s56, 5120
    s_nop 0
    buffer_load_dwordx4 v1, s[8:11], s40 offen sc1 lds
    s_add_u32 s40, s0, 1382400
    s_add_u32 m0, s56, 6144
    s_nop 0
    buffer_load_dwordx4 v1, s[8:11], s40 offen sc1 lds
    s_waitcnt vmcnt(13)
    ds_write_b128 v112, v[128:131] offset:0
    v_or3_b32 v120, v128, v128, v130
    s_waitcnt vmcnt(12)
    ds_write_b128 v112, v[132:135] offset:1024
    v_or3_b32 v120, v120, v132, v134
    s_waitcnt vmcnt(11)
    ds_write_b128 v112, v[136:139] offset:2048
    v_or3_b32 v120, v120, v136, v138
    s_waitcnt vmcnt(10)
    ds_write_b128 v112, v[140:143] offset:3072
    v_or3_b32 v120, v120, v140, v142
    s_waitcnt vmcnt(9)
    ds_write_b128 v112, v[144:147] offset:4096
    v_or3_b32 v120, v120, v144, v146
    s_waitcnt vmcnt(8)
    ds_write_b128 v112, v[148:151] offset:5120
    v_or3_b32 v120, v120, v148, v150
    s_waitcnt vmcnt(7)
    ds_write_b128 v112, v[152:155] offset:6144
    v_or3_b32 v120, v120, v152, v154
    v_and_b32 v120, 1, v120
    v_cmp_ne_u32 vcc, 0, v120
    s_nop 0
    s_cbranch_vccz L_woa0_ok
L_woa0_g:
    s_waitcnt lgkmcnt(0)
    buffer_load_dwordx4 v[128:131], v1, s[8:11], s28 offen offset:0 sc1
    buffer_load_dwordx4 v[132:135], v1, s[8:11], s28 offen offset:1024 sc1
    buffer_load_dwordx4 v[136:139], v1, s[8:11], s28 offen offset:2048 sc1
    buffer_load_dwordx4 v[140:143], v1, s[8:11], s28 offen offset:3072 sc1
    buffer_load_dwordx4 v[144:147], v1, s[8:11], s29 offen offset:0 sc1
    buffer_load_dwordx4 v[148:151], v1, s[8:11], s29 offen offset:1024 sc1
    buffer_load_dwordx4 v[152:155], v1, s[8:11], s29 offen offset:2048 sc1
    s_add_u32 s60, s60, 1
    s_cmp_gt_u32 s60, 100000
    s_cbranch_scc1 L_exit
L_woa0_w:
    s_waitcnt vmcnt(6)
    ds_write_b128 v112, v[128:131] offset:0
    v_or3_b32 v120, v128, v128, v130
    s_waitcnt vmcnt(5)
    ds_write_b128 v112, v[132:135] offset:1024
    v_or3_b32 v120, v120, v132, v134
    s_waitcnt vmcnt(4)
    ds_write_b128 v112, v[136:139] offset:2048
    v_or3_b32 v120, v120, v136, v138
    s_waitcnt vmcnt(3)
    ds_write_b128 v112, v[140:143] offset:3072
    v_or3_b32 v120, v120, v140, v142
    s_waitcnt vmcnt(2)
    ds_write_b128 v112, v[144:147] offset:4096
    v_or3_b32 v120, v120, v144, v146
    s_waitcnt vmcnt(1)
    ds_write_b128 v112, v[148:151] offset:5120
    v_or3_b32 v120, v120, v148, v150
    s_waitcnt vmcnt(0)
    ds_write_b128 v112, v[152:155] offset:6144
    v_or3_b32 v120, v120, v152, v154
    v_and_b32 v120, 1, v120
    v_cmp_ne_u32 vcc, 0, v120
    s_nop 0
    s_cbranch_vccnz L_woa0_g
L_woa0_ok:
    v_mfma_f32_32x32x16_bf16 v[96:111], a[0:3], v[128:131], v[96:111]
    s_waitcnt lgkmcnt(0)
    s_barrier
    ds_read_b128 v[188:191], v113 offset:0
    ds_read_b128 v[160:163], v113 offset:1024
    ds_read_b128 v[164:167], v113 offset:2048
    v_mfma_f32_32x32x16_bf16 v[96:111], a[4:7], v[132:135], v[96:111]
    ds_read_b128 v[168:171], v113 offset:3072
    v_mfma_f32_32x32x16_bf16 v[96:111], a[8:11], v[136:139], v[96:111]
    ds_read_b128 v[172:175], v113 offset:4096
    s_add_u32 s40, s0, 1404928
    s_add_u32 m0, s56, 28672
    s_nop 0
    buffer_load_dwordx4 v1, s[8:11], s40 offen sc1 lds
    v_mfma_f32_32x32x16_bf16 v[96:111], a[12:15], v[140:143], v[96:111]
    ds_read_b128 v[176:179], v113 offset:5120
    s_add_u32 s40, s0, 1405952
    s_add_u32 m0, s56, 29696
    s_nop 0
    buffer_load_dwordx4 v1, s[8:11], s40 offen sc1 lds
    v_mfma_f32_32x32x16_bf16 v[96:111], a[16:19], v[144:147], v[96:111]
    ds_read_b128 v[180:183], v113 offset:6144
    s_add_u32 s40, s0, 1406976
    s_add_u32 m0, s56, 30720
    s_nop 0
    buffer_load_dwordx4 v1, s[8:11], s40 offen sc1 lds
    v_mfma_f32_32x32x16_bf16 v[96:111], a[20:23], v[148:151], v[96:111]
    s_add_u32 s40, s0, 1408000
    s_add_u32 m0, s56, 31744
    s_nop 0
    buffer_load_dwordx4 v1, s[8:11], s40 offen sc1 lds
    v_mfma_f32_32x32x16_bf16 v[96:111], a[24:27], v[152:155], v[96:111]
    s_add_u32 s40, s0, 1409024
    s_add_u32 m0, s56, 32768
    s_nop 0
    buffer_load_dwordx4 v1, s[8:11], s40 offen sc1 lds
    s_getpc_b64 s[40:41]
cr_24:
    s_sub_u32 s40, s40, 0x38f8
    s_subb_u32 s41, s41, 0
    s_lshr_b32 s42, s2, 3
    s_lshl_b32 s42, s42, 2
    s_add_u32 s42, s42, s3
    s_lshl_b32 s42, s42, 9
    v_lshl_add_u32 v7, v2, 7, s42
    v_min_u32 v7, 0xbb60, v7
    s_mov_b64 exec, 0xf
    global_load_dword a252, v7, s[40:41] sc1
    s_mov_b64 exec, -1
    ds_read_b128 v[184:187], v114 offset:0
    s_waitcnt lgkmcnt(7)
    v_mfma_f32_32x32x16_bf16 v[96:111], a[28:31], v[188:191], v[96:111]
    s_add_u32 s40, s0, 1410048
    s_add_u32 m0, s56, 33792
    s_nop 0
    buffer_load_dwordx4 v1, s[8:11], s40 offen sc1 lds
    ds_read_b128 v[188:191], v114 offset:1024
    s_waitcnt lgkmcnt(7)
    v_mfma_f32_32x32x16_bf16 v[96:111], a[32:35], v[160:163], v[96:111]
    s_add_u32 s40, s0, 1411072
    s_add_u32 m0, s56, 34816
    s_nop 0
    buffer_load_dwordx4 v1, s[8:11], s40 offen sc1 lds
    ds_read_b128 v[160:163], v114 offset:2048
    s_waitcnt lgkmcnt(7)
    v_mfma_f32_32x32x16_bf16 v[96:111], a[36:39], v[164:167], v[96:111]
    ds_read_b128 v[164:167], v114 offset:3072
    s_waitcnt lgkmcnt(7)
    v_mfma_f32_32x32x16_bf16 v[96:111], a[40:43], v[168:171], v[96:111]
    ds_read_b128 v[168:171], v114 offset:4096
    s_waitcnt lgkmcnt(7)
    v_mfma_f32_32x32x16_bf16 v[96:111], a[44:47], v[172:175], v[96:111]
    ds_read_b128 v[172:175], v114 offset:5120
    s_waitcnt lgkmcnt(7)
    v_mfma_f32_32x32x16_bf16 v[96:111], a[48:51], v[176:179], v[96:111]
    ds_read_b128 v[176:179], v114 offset:6144
    s_waitcnt lgkmcnt(7)
    v_mfma_f32_32x32x16_bf16 v[96:111], a[52:55], v[180:183], v[96:111]
    ds_read_b128 v[180:183], v115 offset:0
    s_waitcnt lgkmcnt(7)
    v_mfma_f32_32x32x16_bf16 v[96:111], a[56:59], v[184:187], v[96:111]
    ds_read_b128 v[184:187], v115 offset:1024
    s_waitcnt lgkmcnt(7)
    v_mfma_f32_32x32x16_bf16 v[96:111], a[60:63], v[188:191], v[96:111]
    ds_read_b128 v[188:191], v115 offset:2048
    s_waitcnt lgkmcnt(7)
    v_mfma_f32_32x32x16_bf16 v[96:111], a[64:67], v[160:163], v[96:111]
    ds_read_b128 v[160:163], v115 offset:3072
    s_waitcnt lgkmcnt(7)
    v_mfma_f32_32x32x16_bf16 v[96:111], a[68:71], v[164:167], v[96:111]
    ds_read_b128 v[164:167], v115 offset:4096
    s_waitcnt lgkmcnt(7)
    v_mfma_f32_32x32x16_bf16 v[96:111], a[72:75], v[168:171], v[96:111]
    ds_read_b128 v[168:171], v115 offset:5120
    s_waitcnt lgkmcnt(7)
    v_mfma_f32_32x32x16_bf16 v[96:111], a[76:79], v[172:175], v[96:111]
    ds_read_b128 v[172:175], v115 offset:6144
    s_waitcnt lgkmcnt(7)
    v_mfma_f32_32x32x16_bf16 v[96:111], a[80:83], v[176:179], v[96:111]
    s_waitcnt lgkmcnt(6)
    v_mfma_f32_32x32x16_bf16 v[96:111], a[84:87], v[180:183], v[96:111]
    s_waitcnt lgkmcnt(5)
    v_mfma_f32_32x32x16_bf16 v[96:111], a[88:91], v[184:187], v[96:111]
    s_waitcnt lgkmcnt(4)
    v_mfma_f32_32x32x16_bf16 v[96:111], a[92:95], v[188:191], v[96:111]
    s_waitcnt lgkmcnt(3)
    v_mfma_f32_32x32x16_bf16 v[96:111], a[96:99], v[160:163], v[96:111]
    s_waitcnt lgkmcnt(2)
    v_mfma_f32_32x32x16_bf16 v[96:111], a[100:103], v[164:167], v[96:111]
    s_waitcnt lgkmcnt(1)
    v_mfma_f32_32x32x16_bf16 v[96:111], a[104:107], v[168:171], v[96:111]
    s_waitcnt lgkmcnt(0)
    v_mfma_f32_32x32x16_bf16 v[96:111], a[108:111], v[172:175], v[96:111]
    s_cmp_ge_u32 s54, 14
    s_cbranch_scc1 L_woa0_idle
    s_nop 9
    v_cvt_pk_bf16_f32 v192, v96, v97
    v_cvt_pk_bf16_f32 v193, v98, v99
    v_cvt_pk_bf16_f32 v194, v100, v101
    v_cvt_pk_bf16_f32 v195, v102, v103
    v_cvt_pk_bf16_f32 v196, v104, v105
    v_cvt_pk_bf16_f32 v197, v106, v107
    v_cvt_pk_bf16_f32 v198, v108, v109
    v_cvt_pk_bf16_f32 v199, v110, v111
    v_permlane32_swap_b32 v192, v194
    v_permlane32_swap_b32 v193, v195
    v_permlane32_swap_b32 v196, v198
    v_permlane32_swap_b32 v197, v199
    v_accvgpr_write_b32 a224, v192
    v_and_b32 v192, -2, v192
    v_accvgpr_write_b32 a228, v196
    v_and_b32 v196, -2, v196
    s_cmp_eq_u32 s6, 0
    s_cbranch_scc1 ls_25
    buffer_store_dwordx4 v[192:195], v1, s[8:11], s30 offen
    buffer_store_dwordx4 v[196:199], v1, s[8:11], s30 offen offset:1024
le_26:
    v_dot2c_f32_bf16 v200, v192, v204
    v_dot2c_f32_bf16 v201, v192, v192
    v_dot2c_f32_bf16 v200, v193, v204
    v_dot2c_f32_bf16 v201, v193, v193
    v_dot2c_f32_bf16 v200, v194, v204
    v_dot2c_f32_bf16 v201, v194, v194
    v_dot2c_f32_bf16 v200, v195, v204
    v_dot2c_f32_bf16 v201, v195, v195
    v_dot2c_f32_bf16 v200, v196, v204
    v_dot2c_f32_bf16 v201, v196, v196
    v_dot2c_f32_bf16 v200, v197, v204
    v_dot2c_f32_bf16 v201, v197, v197
    v_dot2c_f32_bf16 v200, v198, v204
    v_dot2c_f32_bf16 v201, v198, v198
    v_dot2c_f32_bf16 v200, v199, v204
    v_dot2c_f32_bf16 v201, v199, v199
    s_nop 1
    v_mov_b32 v202, v200
    v_mov_b32 v203, v201
    s_nop 0
    v_permlane32_swap_b32 v200, v202
    v_permlane32_swap_b32 v201, v203
    v_pk_add_f32 v[200:201], v[200:201], v[202:203]
    v_and_b32 v200, -2, v200
    v_and_b32 v201, -2, v201
    s_cmp_eq_u32 s6, 0
    s_cbranch_scc1 ls_27
    s_mov_b32 exec_hi, 0
    buffer_store_dwordx2 v[200:201], v8, s[8:11], s31 offen
    s_mov_b64 exec, -1
le_28:
    v_accvgpr_write_b32 a225, v193
    v_accvgpr_write_b32 a226, v194
    v_accvgpr_write_b32 a227, v195
    v_accvgpr_write_b32 a229, v197
    v_accvgpr_write_b32 a230, v198
    v_accvgpr_write_b32 a231, v199
L_woa0_idle:
    v_lshl_add_u32 v121, v2, 2, s88
    v_lshrrev_b32 v122, 5, v2
    v_lshl_add_u32 v122, v122, 4, s88
    s_lshl_b32 s28, s3, 2
    s_add_u32 s28, s28, 86016
    v_add_u32 v123, s28, v1
    v_add_u32 v124, 86016, v1
    v_mov_b32 v112, 0x3f803f80
    v_mov_b32 v113, 0x3f803f80
    v_mov_b32 v114, 0x3f803f80
    v_mov_b32 v115, 0x3f803f80
    s_add_u32 s32, s51, 5390336
    s_add_u32 s33, s50, 3555328
    s_add_u32 s34, s33, s56
    s_add_u32 s35, s33, s57
    s_add_u32 s36, s33, s58
    s_add_u32 s37, s33, s59
    buffer_load_dwordx2 v[240:241], v8, s[8:11], s32 offen offset:0 sc1
    buffer_load_dwordx2 v[242:243], v8, s[8:11], s32 offen offset:512 sc1
    buffer_load_dwordx2 v[244:245], v8, s[8:11], s32 offen offset:1024 sc1
    buffer_load_dwordx2 v[246:247], v8, s[8:11], s32 offen offset:1536 sc1
    buffer_load_dwordx2 v[248:249], v8, s[8:11], s32 offen offset:2048 sc1
    buffer_load_dwordx2 v[250:251], v8, s[8:11], s32 offen offset:2560 sc1
    buffer_load_dwordx2 v[252:253], v8, s[8:11], s32 offen offset:3072 sc1
    buffer_load_dwordx4 v[128:131], v1, s[8:11], s34 offen offset:0 sc1
    buffer_load_dwordx4 v[132:135], v1, s[8:11], s34 offen offset:1024 sc1
    buffer_load_dwordx4 v[136:139], v1, s[8:11], s34 offen offset:2048 sc1
    buffer_load_dwordx4 v[140:143], v1, s[8:11], s34 offen offset:3072 sc1
    s_waitcnt vmcnt(11)
    ds_read_b128 v[160:163], v3 offset:0
    ds_read_b128 v[164:167], v3 offset:28672
    ds_read_b128 v[168:171], v3 offset:1024
    ds_read_b128 v[172:175], v3 offset:29696
    ds_read_b128 v[176:179], v3 offset:2048
    ds_read_b128 v[180:183], v3 offset:30720
    ds_read_b128 v[184:187], v3 offset:3072
    ds_read_b128 v[188:191], v3 offset:31744
    ds_read_b128 v[192:195], v3 offset:4096
    ds_read_b128 v[196:199], v3 offset:32768
    ds_read_b128 v[200:203], v3 offset:5120
    ds_read_b128 v[204:207], v3 offset:33792
    ds_read_b128 v[208:211], v3 offset:6144
    ds_read_b128 v[212:215], v3 offset:34816
    s_waitcnt lgkmcnt(12)
    v_mfma_f32_32x32x16_bf16 v[64:79], v[112:115], v[160:163], 0
    v_mfma_f32_32x32x16_bf16 v[80:95], v[112:115], v[164:167], 0
    s_waitcnt lgkmcnt(10)
    v_mfma_f32_32x32x16_bf16 v[64:79], v[112:115], v[168:171], v[64:79]
    v_mfma_f32_32x32x16_bf16 v[80:95], v[112:115], v[172:175], v[80:95]
    s_waitcnt lgkmcnt(8)
    v_mfma_f32_32x32x16_bf16 v[64:79], v[112:115], v[176:179], v[64:79]
    v_mfma_f32_32x32x16_bf16 v[80:95], v[112:115], v[180:183], v[80:95]
    s_waitcnt lgkmcnt(6)
    v_mfma_f32_32x32x16_bf16 v[64:79], v[112:115], v[184:187], v[64:79]
    v_mfma_f32_32x32x16_bf16 v[80:95], v[112:115], v[188:191], v[80:95]
    s_waitcnt lgkmcnt(4)
    v_mfma_f32_32x32x16_bf16 v[64:79], v[112:115], v[192:195], v[64:79]
    v_mfma_f32_32x32x16_bf16 v[80:95], v[112:115], v[196:199], v[80:95]
    s_waitcnt lgkmcnt(2)
    v_mfma_f32_32x32x16_bf16 v[64:79], v[112:115], v[200:203], v[64:79]
    v_mfma_f32_32x32x16_bf16 v[80:95], v[112:115], v[204:207], v[80:95]
    s_waitcnt lgkmcnt(0)
    v_mfma_f32_32x32x16_bf16 v[64:79], v[112:115], v[208:211], v[64:79]
    v_mfma_f32_32x32x16_bf16 v[80:95], v[112:115], v[212:215], v[80:95]
    s_branch gk_29
gl_30:
    buffer_load_dwordx2 v[240:241], v8, s[8:11], s32 offen offset:0 sc1
    buffer_load_dwordx2 v[242:243], v8, s[8:11], s32 offen offset:512 sc1
    buffer_load_dwordx2 v[244:245], v8, s[8:11], s32 offen offset:1024 sc1
    buffer_load_dwordx2 v[246:247], v8, s[8:11], s32 offen offset:1536 sc1
    buffer_load_dwordx2 v[248:249], v8, s[8:11], s32 offen offset:2048 sc1
    buffer_load_dwordx2 v[250:251], v8, s[8:11], s32 offen offset:2560 sc1
    buffer_load_dwordx2 v[252:253], v8, s[8:11], s32 offen offset:3072 sc1
    buffer_load_dwordx4 v[128:131], v1, s[8:11], s34 offen offset:0 sc1
    buffer_load_dwordx4 v[132:135], v1, s[8:11], s34 offen offset:1024 sc1
    buffer_load_dwordx4 v[136:139], v1, s[8:11], s34 offen offset:2048 sc1
    buffer_load_dwordx4 v[140:143], v1, s[8:11], s34 offen offset:3072 sc1
    s_add_u32 s60, s60, 1
    s_cmp_gt_u32 s60, 100000
    s_cbranch_scc1 L_exit
    s_waitcnt vmcnt(4)
gk_29:
    s_waitcnt vmcnt(4)
    v_or3_b32 v120, v240, v241, v242
    v_or3_b32 v120, v120, v243, v244
    v_or3_b32 v120, v120, v245, v246
    v_or3_b32 v120, v120, v247, v248
    v_or3_b32 v120, v120, v249, v250
    v_or3_b32 v120, v120, v251, v252
    v_or3_b32 v120, v120, v253, v240
    v_and_b32 v120, 1, v120
    v_cmp_ne_u32 vcc, 0, v120
    s_nop 0
    s_cbranch_vccnz gl_30
    s_add_u32 s38, s34, 4096
    buffer_load_dwordx4 v[144:147], v1, s[8:11], s38 offen offset:0 sc1
    buffer_load_dwordx4 v[148:151], v1, s[8:11], s38 offen offset:1024 sc1
    buffer_load_dwordx4 v[152:155], v1, s[8:11], s38 offen offset:2048 sc1
    buffer_load_dwordx4 v[156:159], v1, s[8:11], s35 offen offset:0 sc1
    buffer_load_dwordx4 v[160:163], v1, s[8:11], s35 offen offset:1024 sc1
    buffer_load_dwordx4 v[164:167], v1, s[8:11], s35 offen offset:2048 sc1
    buffer_load_dwordx4 v[168:171], v1, s[8:11], s35 offen offset:3072 sc1
    s_add_u32 s38, s35, 4096
    buffer_load_dwordx4 v[172:175], v1, s[8:11], s38 offen offset:0 sc1
    ds_read_b128 v[96:99], v3 offset:0
    ds_read_b128 v[100:103], v3 offset:28672
    ds_read_b128 v[104:107], v3 offset:1024
    ds_read_b128 v[108:111], v3 offset:29696
    v_pk_add_f32 v[240:241], v[240:241], v[242:243]
    v_pk_add_f32 v[240:241], v[240:241], v[244:245]
    v_pk_add_f32 v[240:241], v[240:241], v[246:247]
    v_pk_add_f32 v[240:241], v[240:241], v[248:249]
    v_pk_add_f32 v[240:241], v[240:241], v[250:251]
    v_pk_add_f32 v[240:241], v[240:241], v[252:253]
    ds_read_b128 v[248:251], v3 offset:2048
    ds_read_b128 v[252:255], v3 offset:30720
    v_mov_b32 v242, v240
    v_mov_b32 v243, v241
    s_nop 0
    v_permlane32_swap_b32 v240, v242
    v_permlane32_swap_b32 v241, v243
    v_add_f32 v240, v240, v242
    v_add_f32 v241, v241, v243
    v_mul_f32 v240, 0x3b124925, v240
    v_mul_f32 v241, 0x3b124925, v241
    v_fma_f32 v241, -v240, v240, v241
    v_max_f32 v241, 0, v241
    v_add_f32 v241, 0x3727c5ac, v241
    v_rsq_f32 v116, v241
    s_nop 0
    v_mul_f32 v118, -v240, v116
    v_cndmask_b32 v242, v116, v118, s[44:45]
    ds_write_b32 v121, v242
    s_waitcnt vmcnt(8)
L_b0_c:
    v_or3_b32 v120, v128, v132, v136
    v_or3_b32 v120, v120, v140, v128
    v_or3_b32 v120, v120, v128, v128
    v_and_b32 v120, 1, v120
    v_cmp_ne_u32 vcc, 0, v120
    s_nop 0
    s_cbranch_vccnz L_b0_r
    v_mov_b32 v120, 0
    v_cndmask_b32 v12, v64, v80, s[44:45]
    ds_write_b32 v123, v12
    ds_read_b128 v[240:243], v3 offset:3072
    ds_read_b128 v[244:247], v3 offset:31744
    s_waitcnt vmcnt(11) lgkmcnt(6)
    v_mfma_f32_32x32x16_bf16 v[16:31], v[96:99], v[128:131], 0
    buffer_load_dwordx4 v[176:179], v1, s[8:11], s38 offen offset:1024 sc1
    v_mfma_f32_32x32x16_bf16 v[32:47], v[128:131], v[100:103], 0
    ds_read_b128 v[96:99], v3 offset:4096
    ds_read_b128 v[100:103], v3 offset:32768
    s_waitcnt vmcnt(11) lgkmcnt(6)
    v_mfma_f32_32x32x16_bf16 v[16:31], v[104:107], v[132:135], v[16:31]
    buffer_load_dwordx4 v[180:183], v1, s[8:11], s38 offen offset:2048 sc1
    v_or3_b32 v120, v120, v132, v128
    v_mfma_f32_32x32x16_bf16 v[32:47], v[132:135], v[108:111], v[32:47]
    ds_read_b128 v[104:107], v3 offset:5120
    ds_read_b128 v[108:111], v3 offset:33792
    s_waitcnt vmcnt(11) lgkmcnt(6)
    v_mfma_f32_32x32x16_bf16 v[16:31], v[248:251], v[136:139], v[16:31]
    buffer_load_dwordx4 v[184:187], v1, s[8:11], s36 offen offset:0 sc1
    v_mfma_f32_32x32x16_bf16 v[32:47], v[136:139], v[252:255], v[32:47]
    ds_read_b128 v[248:251], v3 offset:6144
    ds_read_b128 v[252:255], v3 offset:34816
    s_waitcnt vmcnt(11) lgkmcnt(6)
    v_mfma_f32_32x32x16_bf16 v[16:31], v[240:243], v[140:143], v[16:31]
    buffer_load_dwordx4 v[188:191], v1, s[8:11], s36 offen offset:1024 sc1
    v_or3_b32 v120, v120, v140, v136
    v_mfma_f32_32x32x16_bf16 v[32:47], v[140:143], v[244:247], v[32:47]
    s_barrier
    ds_read_b128 v[240:243], v4 offset:0
    ds_read_b128 v[244:247], v4 offset:28672
    s_waitcnt vmcnt(11) lgkmcnt(6)
    v_mfma_f32_32x32x16_bf16 v[16:31], v[96:99], v[144:147], v[16:31]
    buffer_load_dwordx4 v[192:195], v1, s[8:11], s36 offen offset:2048 sc1
    v_mfma_f32_32x32x16_bf16 v[32:47], v[144:147], v[100:103], v[32:47]
    ds_read_b128 v[96:99], v4 offset:1024
    ds_read_b128 v[100:103], v4 offset:29696
    s_waitcnt vmcnt(11) lgkmcnt(6)
    v_mfma_f32_32x32x16_bf16 v[16:31], v[104:107], v[148:151], v[16:31]
    buffer_load_dwordx4 v[196:199], v1, s[8:11], s36 offen offset:3072 sc1
    v_or3_b32 v120, v120, v148, v144
    v_mfma_f32_32x32x16_bf16 v[32:47], v[148:151], v[108:111], v[32:47]
    ds_read_b128 v[104:107], v4 offset:2048
    ds_read_b128 v[108:111], v4 offset:30720
    s_waitcnt vmcnt(11) lgkmcnt(6)
    v_mfma_f32_32x32x16_bf16 v[16:31], v[248:251], v[152:155], v[16:31]
    s_add_u32 s38, s36, 4096
    buffer_load_dwordx4 v[200:203], v1, s[8:11], s38 offen offset:0 sc1
    v_mfma_f32_32x32x16_bf16 v[32:47], v[152:155], v[252:255], v[32:47]
    ds_read_b128 v[248:251], v4 offset:3072
    ds_read_b128 v[252:255], v4 offset:31744
    s_waitcnt vmcnt(11) lgkmcnt(6)
    v_mfma_f32_32x32x16_bf16 v[16:31], v[240:243], v[156:159], v[16:31]
    buffer_load_dwordx4 v[204:207], v1, s[8:11], s38 offen offset:1024 sc1
    v_or3_b32 v120, v120, v156, v152
    v_mfma_f32_32x32x16_bf16 v[32:47], v[156:159], v[244:247], v[32:47]
    ds_read_b128 v[240:243], v4 offset:4096
    ds_read_b128 v[244:247], v4 offset:32768
    s_waitcnt vmcnt(11) lgkmcnt(6)
    v_mfma_f32_32x32x16_bf16 v[16:31], v[96:99], v[160:163], v[16:31]
    buffer_load_dwordx4 v[208:211], v1, s[8:11], s38 offen offset:2048 sc1
    v_mfma_f32_32x32x16_bf16 v[32:47], v[160:163], v[100:103], v[32:47]
    ds_read_b128 v[96:99], v4 offset:5120
    ds_read_b128 v[100:103], v4 offset:33792
    s_waitcnt vmcnt(11) lgkmcnt(6)
    v_mfma_f32_32x32x16_bf16 v[16:31], v[104:107], v[164:167], v[16:31]
    buffer_load_dwordx4 v[212:215], v1, s[8:11], s37 offen offset:0 sc1
    v_or3_b32 v120, v120, v164, v160
    v_mfma_f32_32x32x16_bf16 v[32:47], v[164:167], v[108:111], v[32:47]
    ds_read_b128 v[64:67], v122 offset:0
    ds_read_b128 v[80:83], v122 offset:128
    ds_read_b128 v[68:71], v122 offset:32
    ds_read_b128 v[84:87], v122 offset:160
    ds_read_b128 v[104:107], v4 offset:6144
    ds_read_b128 v[108:111], v4 offset:34816
    s_waitcnt vmcnt(11) lgkmcnt(6)
    v_mfma_f32_32x32x16_bf16 v[16:31], v[248:251], v[168:171], v[16:31]
    buffer_load_dwordx4 v[216:219], v1, s[8:11], s37 offen offset:1024 sc1
    v_mfma_f32_32x32x16_bf16 v[32:47], v[168:171], v[252:255], v[32:47]
    ds_read_b128 v[72:75], v122 offset:64
    ds_read_b128 v[88:91], v122 offset:192
    ds_read_b128 v[76:79], v122 offset:96
    ds_read_b128 v[92:95], v122 offset:224
    ds_read_b128 v[248:251], v5 offset:0
    ds_read_b128 v[252:255], v5 offset:28672
    s_waitcnt vmcnt(11) lgkmcnt(6)
    v_mfma_f32_32x32x16_bf16 v[16:31], v[240:243], v[172:175], v[16:31]
    buffer_load_dwordx4 v[220:223], v1, s[8:11], s37 offen offset:2048 sc1
    v_or3_b32 v120, v120, v172, v168
    v_mfma_f32_32x32x16_bf16 v[32:47], v[172:175], v[244:247], v[32:47]
    ds_read_b128 v[12:15], v124
    ds_read_b128 v[240:243], v5 offset:1024
    ds_read_b128 v[244:247], v5 offset:29696
    s_waitcnt vmcnt(11) lgkmcnt(6)
    v_mfma_f32_32x32x16_bf16 v[16:31], v[96:99], v[176:179], v[16:31]
    buffer_load_dwordx4 v[224:227], v1, s[8:11], s37 offen offset:3072 sc1
    v_mfma_f32_32x32x16_bf16 v[32:47], v[176:179], v[100:103], v[32:47]
    ds_read_b128 v[96:99], v5 offset:2048
    ds_read_b128 v[100:103], v5 offset:30720
    s_waitcnt vmcnt(11) lgkmcnt(6)
    v_mfma_f32_32x32x16_bf16 v[16:31], v[104:107], v[180:183], v[16:31]
    s_add_u32 s38, s37, 4096
    buffer_load_dwordx4 v[228:231], v1, s[8:11], s38 offen offset:0 sc1
    v_or3_b32 v120, v120, v180, v176
    v_mfma_f32_32x32x16_bf16 v[32:47], v[180:183], v[108:111], v[32:47]
    ds_read_b128 v[104:107], v5 offset:3072
    ds_read_b128 v[108:111], v5 offset:31744
    s_waitcnt vmcnt(11) lgkmcnt(6)
    v_mfma_f32_32x32x16_bf16 v[16:31], v[248:251], v[184:187], v[16:31]
    buffer_load_dwordx4 v[232:235], v1, s[8:11], s38 offen offset:1024 sc1
    v_mfma_f32_32x32x16_bf16 v[32:47], v[184:187], v[252:255], v[32:47]
    v_add_f32 v12, v12, v13
    v_add_f32 v14, v14, v15
    v_add_f32 v12, v12, v14
    v_accvgpr_write_b32 a254, v12
    ds_write_b32 v121, v12 offset:1024
    v_mov_b32 v126, v12
    s_nop 1
    v_permlane32_swap_b32 v12, v126
    ds_read_b128 v[248:251], v5 offset:4096
    ds_read_b128 v[252:255], v5 offset:32768
    s_waitcnt vmcnt(11) lgkmcnt(6)
    v_mfma_f32_32x32x16_bf16 v[16:31], v[240:243], v[188:191], v[16:31]
    buffer_load_dwordx4 v[236:239], v1, s[8:11], s38 offen offset:2048 sc1
    v_or3_b32 v120, v120, v188, v184
    v_mfma_f32_32x32x16_bf16 v[32:47], v[188:191], v[244:247], v[32:47]
    ds_read_b128 v[48:51], v122 offset:1024
    ds_read_b128 v[52:55], v122 offset:1056
    ds_read_b128 v[56:59], v122 offset:1088
    ds_read_b128 v[60:63], v122 offset:1120
    ds_read_b128 v[240:243], v5 offset:5120
    ds_read_b128 v[244:247], v5 offset:33792
    s_waitcnt vmcnt(11) lgkmcnt(6)
    v_mfma_f32_32x32x16_bf16 v[16:31], v[96:99], v[192:195], v[16:31]
    s_add_u32 s40, s0, 1433600
    s_add_u32 m0, s56, 57344
    s_nop 0
    buffer_load_dwordx4 v1, s[8:11], s40 offen sc1 lds
    v_mfma_f32_32x32x16_bf16 v[32:47], v[192:195], v[100:103], v[32:47]
    ds_read_b128 v[96:99], v5 offset:6144
    ds_read_b128 v[100:103], v5 offset:34816
    s_waitcnt vmcnt(11) lgkmcnt(6)
    v_mfma_f32_32x32x16_bf16 v[16:31], v[104:107], v[196:199], v[16:31]
    v_or3_b32 v120, v120, v196, v192
    v_mfma_f32_32x32x16_bf16 v[32:47], v[196:199], v[108:111], v[32:47]
    ds_read_b128 v[104:107], v6 offset:0
    ds_read_b128 v[108:111], v6 offset:28672
    s_waitcnt vmcnt(10) lgkmcnt(6)
    v_mfma_f32_32x32x16_bf16 v[16:31], v[248:251], v[200:203], v[16:31]
    s_add_u32 s40, s0, 1434624
    s_add_u32 m0, s56, 58368
    s_nop 0
    buffer_load_dwordx4 v1, s[8:11], s40 offen sc1 lds
    v_mfma_f32_32x32x16_bf16 v[32:47], v[200:203], v[252:255], v[32:47]
    ds_read_b128 v[248:251], v6 offset:1024
    ds_read_b128 v[252:255], v6 offset:29696
    s_waitcnt vmcnt(10) lgkmcnt(6)
    v_mfma_f32_32x32x16_bf16 v[16:31], v[240:243], v[204:207], v[16:31]
    v_or3_b32 v120, v120, v204, v200
    v_mfma_f32_32x32x16_bf16 v[32:47], v[204:207], v[244:247], v[32:47]
    v_mul_f32 v80, v80, v126
    v_mul_f32 v48, v48, v118
    v_mul_f32 v81, v81, v126
    v_mul_f32 v49, v49, v118
    ds_read_b128 v[240:243], v6 offset:2048
    ds_read_b128 v[244:247], v6 offset:30720
    s_waitcnt vmcnt(9) lgkmcnt(6)
    v_mfma_f32_32x32x16_bf16 v[16:31], v[96:99], v[208:211], v[16:31]
    s_add_u32 s40, s0, 1435648
    s_add_u32 m0, s56, 59392
    s_nop 0
    buffer_load_dwordx4 v1, s[8:11], s40 offen sc1 lds
    v_mfma_f32_32x32x16_bf16 v[32:47], v[208:211], v[100:103], v[32:47]
    v_mul_f32 v82, v82, v126
    v_mul_f32 v50, v50, v118
    v_mul_f32 v83, v83, v126
    v_mul_f32 v51, v51, v118
    ds_read_b128 v[96:99], v6 offset:3072
    ds_read_b128 v[100:103], v6 offset:31744
    s_waitcnt vmcnt(9) lgkmcnt(6)
    v_mfma_f32_32x32x16_bf16 v[16:31], v[104:107], v[212:215], v[16:31]
    v_or3_b32 v120, v120, v212, v208
    v_mfma_f32_32x32x16_bf16 v[32:47], v[212:215], v[108:111], v[32:47]
    v_mul_f32 v84, v84, v126
    v_mul_f32 v52, v52, v118
    v_mul_f32 v85, v85, v126
    v_mul_f32 v53, v53, v118
    ds_read_b128 v[104:107], v6 offset:4096
    ds_read_b128 v[108:111], v6 offset:32768
    s_waitcnt vmcnt(8) lgkmcnt(6)
    v_mfma_f32_32x32x16_bf16 v[16:31], v[248:251], v[216:219], v[16:31]
    s_add_u32 s40, s0, 1436672
    s_add_u32 m0, s56, 60416
    s_nop 0
    buffer_load_dwordx4 v1, s[8:11], s40 offen sc1 lds
    v_mfma_f32_32x32x16_bf16 v[32:47], v[216:219], v[252:255], v[32:47]
    v_mul_f32 v86, v86, v126
    v_mul_f32 v54, v54, v118
    v_mul_f32 v87, v87, v126
    v_mul_f32 v55, v55, v118
    ds_read_b128 v[248:251], v6 offset:5120
    ds_read_b128 v[252:255], v6 offset:33792
    s_waitcnt vmcnt(8) lgkmcnt(6)
    v_mfma_f32_32x32x16_bf16 v[16:31], v[240:243], v[220:223], v[16:31]
    v_or3_b32 v120, v120, v220, v216
    v_mfma_f32_32x32x16_bf16 v[32:47], v[220:223], v[244:247], v[32:47]
    v_mul_f32 v88, v88, v126
    v_mul_f32 v56, v56, v118
    v_mul_f32 v89, v89, v126
    v_mul_f32 v57, v57, v118
    ds_read_b128 v[240:243], v6 offset:6144
    ds_read_b128 v[244:247], v6 offset:34816
    s_waitcnt vmcnt(7) lgkmcnt(6)
    v_mfma_f32_32x32x16_bf16 v[16:31], v[96:99], v[224:227], v[16:31]
    s_add_u32 s40, s0, 1437696
    s_add_u32 m0, s56, 61440
    s_nop 0
    buffer_load_dwordx4 v1, s[8:11], s40 offen sc1 lds
    v_mfma_f32_32x32x16_bf16 v[32:47], v[224:227], v[100:103], v[32:47]
    v_mul_f32 v90, v90, v126
    v_mul_f32 v58, v58, v118
    v_mul_f32 v91, v91, v126
    v_mul_f32 v59, v59, v118
    s_waitcnt vmcnt(7) lgkmcnt(4)
    v_mfma_f32_32x32x16_bf16 v[16:31], v[104:107], v[228:231], v[16:31]
    v_or3_b32 v120, v120, v228, v224
    v_mfma_f32_32x32x16_bf16 v[32:47], v[228:231], v[108:111], v[32:47]
    v_mul_f32 v92, v92, v126
    v_mul_f32 v60, v60, v118
    v_mul_f32 v93, v93, v126
    v_mul_f32 v61, v61, v118
    s_waitcnt vmcnt(6) lgkmcnt(2)
    v_mfma_f32_32x32x16_bf16 v[16:31], v[248:251], v[232:235], v[16:31]
    s_add_u32 s40, s0, 1438720
    s_add_u32 m0, s56, 62464
    s_nop 0
    buffer_load_dwordx4 v1, s[8:11], s40 offen sc1 lds
    v_mfma_f32_32x32x16_bf16 v[32:47], v[232:235], v[252:255], v[32:47]
    v_mul_f32 v94, v94, v126
    v_mul_f32 v62, v62, v118
    v_mul_f32 v95, v95, v126
    v_mul_f32 v63, v63, v118
    s_waitcnt vmcnt(6) lgkmcnt(0)
    v_mfma_f32_32x32x16_bf16 v[16:31], v[240:243], v[236:239], v[16:31]
    s_add_u32 s40, s0, 1439744
    s_add_u32 m0, s56, 63488
    s_nop 0
    buffer_load_dwordx4 v1, s[8:11], s40 offen sc1 lds
    v_or3_b32 v120, v120, v236, v232
    v_and_b32 v120, 1, v120
    v_cmp_ne_u32 vcc, 0, v120
    v_mfma_f32_32x32x16_bf16 v[32:47], v[236:239], v[244:247], v[32:47]
    s_cbranch_vccnz L_b0_slow
L_b0_ok:
    s_add_u32 s30, s84, 9715712
    s_add_u32 s31, s84, 13910016
    s_lshl_b32 s32, s3, 11
    s_add_u32 s32, s32, 86016
    v_add_u32 v11, s32, v1
    v_pk_fma_f32 v[16:17], v[16:17], v[116:117], v[48:49] op_sel_hi:[1,0,1]
    v_pk_fma_f32 v[18:19], v[18:19], v[116:117], v[50:51] op_sel_hi:[1,0,1]
    v_pk_fma_f32 v[20:21], v[20:21], v[116:117], v[52:53] op_sel_hi:[1,0,1]
    v_pk_fma_f32 v[22:23], v[22:23], v[116:117], v[54:55] op_sel_hi:[1,0,1]
    v_pk_fma_f32 v[24:25], v[24:25], v[116:117], v[56:57] op_sel_hi:[1,0,1]
    v_pk_fma_f32 v[26:27], v[26:27], v[116:117], v[58:59] op_sel_hi:[1,0,1]
    v_pk_fma_f32 v[28:29], v[28:29], v[116:117], v[60:61] op_sel_hi:[1,0,1]
    v_pk_fma_f32 v[30:31], v[30:31], v[116:117], v[62:63] op_sel_hi:[1,0,1]
    v_cvt_pk_bf16_f32 v96, v16, v17
    v_cvt_pk_bf16_f32 v97, v18, v19
    v_cvt_pk_bf16_f32 v98, v20, v21
    v_cvt_pk_bf16_f32 v99, v22, v23
    v_cvt_pk_bf16_f32 v100, v24, v25
    v_cvt_pk_bf16_f32 v101, v26, v27
    v_cvt_pk_bf16_f32 v102, v28, v29
    v_cvt_pk_bf16_f32 v103, v30, v31
    buffer_store_dwordx4 v[96:99], v1, s[8:11], s30 offen offset:0 sc1
    buffer_store_dwordx4 v[100:103], v1, s[8:11], s30 offen offset:1024 sc1
    v_pk_fma_f32 v[32:33], v[32:33], v[64:65], v[80:81]
    v_pk_fma_f32 v[34:35], v[34:35], v[66:67], v[82:83]
    v_pk_fma_f32 v[36:37], v[36:37], v[68:69], v[84:85]
    v_pk_fma_f32 v[38:39], v[38:39], v[70:71], v[86:87]
    v_pk_fma_f32 v[40:41], v[40:41], v[72:73], v[88:89]
    v_pk_fma_f32 v[42:43], v[42:43], v[74:75], v[90:91]
    v_pk_fma_f32 v[44:45], v[44:45], v[76:77], v[92:93]
    v_pk_fma_f32 v[46:47], v[46:47], v[78:79], v[94:95]
    v_cvt_pk_bf16_f32 v72, v32, v33
    v_cvt_pk_bf16_f32 v73, v34, v35
    v_cvt_pk_bf16_f32 v74, v36, v37
    v_cvt_pk_bf16_f32 v75, v38, v39
    v_cvt_pk_bf16_f32 v76, v40, v41
    v_cvt_pk_bf16_f32 v77, v42, v43
    v_cvt_pk_bf16_f32 v78, v44, v45
    v_cvt_pk_bf16_f32 v79, v46, v47
    v_cndmask_b32 v12, 0, v112, s[48:49]
    v_mov_b32 v13, v12
    s_mov_b64 exec, s[46:47]
    v_mov_b64 v[72:73], v[12:13]
    v_mov_b64 v[74:75], v[12:13]
    v_mov_b64 v[76:77], v[12:13]
    v_mov_b64 v[78:79], v[12:13]
    s_mov_b64 exec, -1
    buffer_store_dwordx4 v[72:75], v1, s[8:11], s31 offen offset:0 sc1
    buffer_store_dwordx4 v[76:79], v1, s[8:11], s31 offen offset:1024 sc1
    ds_write_b128 v11, v[96:99] offset:40960
    ds_write_b128 v11, v[100:103] offset:41984
    ds_write_b128 v11, v[72:75] offset:16384
    ds_write_b128 v11, v[76:79] offset:17408
    v_mul_f32 v116, s62, v116
    v_mul_f32 v118, s62, v118
    s_cmp_ge_u32 s4, 2
    s_cselect_b32 s28, 262144, 0
    s_sub_u32 s32, s30, s28
    s_sub_u32 s34, s31, s28
    s_cmp_ge_u32 s4, 1
    s_cselect_b32 s28, 131072, 0
    s_sub_u32 s33, s30, s28
    s_sub_u32 s35, s31, s28
    s_waitcnt vmcnt(4)
    s_barrier
    s_getpc_b64 s[40:41]
cr_31:
    s_sub_u32 s40, s40, 0x4848
    s_subb_u32 s41, s41, 0
    s_lshr_b32 s42, s2, 3
    s_lshl_b32 s42, s42, 2
    s_add_u32 s42, s42, s3
    s_lshl_b32 s42, s42, 9
    v_lshl_add_u32 v7, v2, 7, s42
    v_min_u32 v7, 0xbb60, v7
    s_mov_b64 exec, 0xf
    global_load_dword a252, v7, s[40:41] sc1
    s_mov_b64 exec, -1
    ds_read_b128 v[88:91], v3 offset:57344
    ds_read_b128 v[92:95], v3 offset:58368
    ds_read_b128 v[96:99], v3 offset:59392
    ds_read_b128 v[100:103], v3 offset:60416
    ds_read_b128 v[104:107], v3 offset:61440
    ds_read_b128 v[108:111], v3 offset:62464
    s_waitcnt lgkmcnt(5)
    v_mfma_f32_32x32x16_bf16 v[48:63], v[88:91], v[128:131], 0
    v_mfma_f32_32x32x16_bf16 v[32:47], v[112:115], v[88:91], 0
    s_add_u32 s40, s1, 3153920
    buffer_load_dwordx4 a[112:115], v3, s[8:11], s40 offen sc1
    ds_read_b128 v[88:91], v3 offset:63488
    s_waitcnt lgkmcnt(5)
    v_mfma_f32_32x32x16_bf16 v[48:63], v[92:95], v[132:135], v[48:63]
    v_mfma_f32_32x32x16_bf16 v[32:47], v[112:115], v[92:95], v[32:47]
    ds_read_b128 v[92:95], v4 offset:57344
    s_waitcnt lgkmcnt(5)
    v_mfma_f32_32x32x16_bf16 v[48:63], v[96:99], v[136:139], v[48:63]
    v_mfma_f32_32x32x16_bf16 v[32:47], v[112:115], v[96:99], v[32:47]
    s_bfm_b32 s64, 0, 0
    s_bfm_b32 s65, 4, 0
    s_bfm_b32 s66, 1, 0
    ds_read_b128 v[96:99], v4 offset:58368
    s_waitcnt lgkmcnt(5)
    v_mfma_f32_32x32x16_bf16 v[48:63], v[100:103], v[140:143], v[48:63]
    v_mfma_f32_32x32x16_bf16 v[32:47], v[112:115], v[100:103], v[32:47]
    s_bfm_b32 s67, 5, 0
    s_bfm_b32 s68, 2, 0
    s_bfm_b32 s69, 6, 0
    s_add_u32 s40, s1, 3154944
    buffer_load_dwordx4 a[116:119], v3, s[8:11], s40 offen sc1
    ds_read_b128 v[100:103], v4 offset:59392
    s_waitcnt lgkmcnt(5)
    v_mfma_f32_32x32x16_bf16 v[48:63], v[104:107], v[144:147], v[48:63]
    v_mfma_f32_32x32x16_bf16 v[32:47], v[112:115], v[104:107], v[32:47]
    s_bfm_b32 s70, 3, 0
    s_bfm_b32 s71, 7, 0
    s_bfm_b32 s72, 8, 0
    ds_read_b128 v[104:107], v4 offset:60416
    s_waitcnt lgkmcnt(5)
    v_mfma_f32_32x32x16_bf16 v[48:63], v[108:111], v[148:151], v[48:63]
    v_mfma_f32_32x32x16_bf16 v[32:47], v[112:115], v[108:111], v[32:47]
    s_bfm_b32 s73, 12, 0
    s_bfm_b32 s74, 9, 0
    s_bfm_b32 s75, 13, 0
    ds_read_b128 v[108:111], v4 offset:61440
    s_waitcnt lgkmcnt(5)
    v_mfma_f32_32x32x16_bf16 v[48:63], v[88:91], v[152:155], v[48:63]
    v_mfma_f32_32x32x16_bf16 v[32:47], v[112:115], v[88:91], v[32:47]
    s_bfm_b32 s76, 10, 0
    s_bfm_b32 s77, 14, 0
    s_bfm_b32 s78, 11, 0
    s_add_u32 s40, s1, 3155968
    buffer_load_dwordx4 a[120:123], v3, s[8:11], s40 offen sc1
    ds_read_b128 v[88:91], v4 offset:62464
    s_waitcnt lgkmcnt(5)
    v_mfma_f32_32x32x16_bf16 v[48:63], v[92:95], v[156:159], v[48:63]
    s_bfm_b32 s79, 15, 0
    s_bfm_b32 s80, 16, 0
    s_bfm_b32 s81, 20, 0
    ds_read_b128 v[92:95], v4 offset:63488
    s_waitcnt lgkmcnt(5)
    v_mfma_f32_32x32x16_bf16 v[48:63], v[96:99], v[160:163], v[48:63]
    s_bfm_b32 s20, 17, 0
    s_bfm_b32 s21, 21, 0
    s_bfm_b32 s22, 18, 0
    s_mov_b32 exec_hi, 0
    ds_write_b32 v123, v32 offset:1024
    s_mov_b64 exec, -1
    ds_read_b128 v[96:99], v5 offset:57344
    s_waitcnt lgkmcnt(5)
    v_mfma_f32_32x32x16_bf16 v[48:63], v[100:103], v[164:167], v[48:63]
    s_bfm_b32 s23, 22, 0
    s_bfm_b32 s24, 19, 0
    s_bfm_b32 s25, 23, 0
    s_add_u32 s40, s1, 3156992
    buffer_load_dwordx4 a[124:127], v3, s[8:11], s40 offen sc1
    ds_read_b128 v[100:103], v5 offset:58368
    s_waitcnt lgkmcnt(5)
    v_mfma_f32_32x32x16_bf16 v[48:63], v[104:107], v[168:171], v[48:63]
    s_bfm_b32 s26, 24, 0
    s_bfm_b32 s27, 28, 0
    s_bfm_b32 s94, 25, 0
    ds_read_b128 v[104:107], v5 offset:59392
    s_waitcnt lgkmcnt(5)
    v_mfma_f32_32x32x16_bf16 v[48:63], v[108:111], v[172:175], v[48:63]
    s_bfm_b32 s95, 29, 0
    s_bfm_b32 s96, 26, 0
    s_bfm_b32 s97, 30, 0
    ds_read_b128 v[108:111], v5 offset:60416
    s_waitcnt lgkmcnt(5)
    v_mfma_f32_32x32x16_bf16 v[48:63], v[88:91], v[176:179], v[48:63]
    s_bfm_b32 s98, 27, 0
    s_bfm_b32 s99, 31, 0
    v_mov_b32 v64, 0xffff
    s_add_u32 s40, s1, 3158016
    buffer_load_dwordx4 a[128:131], v3, s[8:11], s40 offen sc1
    s_waitcnt lgkmcnt(4)
    s_barrier
    v_and_b32 v12, 0x1ff, v1
    v_add_u32 v12, 87040, v12
    ds_read_b128 v[12:15], v12
    ds_read_b128 v[88:91], v5 offset:61440
    s_waitcnt lgkmcnt(5)
    v_mfma_f32_32x32x16_bf16 v[48:63], v[92:95], v[180:183], v[48:63]
    v_mov_b32 v65, 0xffff0000
    v_cndmask_b32 v66, 0, v64, s[64:65]
    v_cndmask_b32 v67, 0, v65, s[66:67]
    ds_read_b128 v[92:95], v5 offset:62464
    s_waitcnt lgkmcnt(5)
    v_mfma_f32_32x32x16_bf16 v[48:63], v[96:99], v[184:187], v[48:63]
    v_or_b32 v72, v66, v67
    v_accvgpr_write_b32 a240, v72
    v_cndmask_b32 v66, 0, v64, s[68:69]
    s_add_u32 s40, s1, 3159040
    buffer_load_dwordx4 a[132:135], v3, s[8:11], s40 offen sc1
    s_add_u32 s40, s1, 3160064
    buffer_load_dwordx4 a[136:139], v3, s[8:11], s40 offen sc1
    buffer_load_dwordx4 v[240:243], v1, s[8:11], s32 offen offset:0 sc1
    buffer_load_dwordx4 v[244:247], v1, s[8:11], s32 offen offset:1024 sc1
    buffer_load_dwordx4 v[248:251], v1, s[8:11], s33 offen offset:0 sc1
    buffer_load_dwordx4 v[252:255], v1, s[8:11], s33 offen offset:1024 sc1
    ds_read_b128 v[96:99], v5 offset:63488
    s_waitcnt lgkmcnt(5)
    v_mfma_f32_32x32x16_bf16 v[48:63], v[100:103], v[188:191], v[48:63]
    v_cndmask_b32 v67, 0, v65, s[70:71]
    v_or_b32 v73, v66, v67
    v_accvgpr_write_b32 a241, v73
    ds_read_b128 v[100:103], v6 offset:57344
    s_waitcnt lgkmcnt(5)
    v_mfma_f32_32x32x16_bf16 v[48:63], v[104:107], v[192:195], v[48:63]
    v_cndmask_b32 v66, 0, v64, s[72:73]
    v_cndmask_b32 v67, 0, v65, s[74:75]
    v_or_b32 v74, v66, v67
    ds_read_b128 v[104:107], v6 offset:58368
    s_waitcnt lgkmcnt(5)
    v_mfma_f32_32x32x16_bf16 v[48:63], v[108:111], v[196:199], v[48:63]
    v_accvgpr_write_b32 a242, v74
    v_cndmask_b32 v66, 0, v64, s[76:77]
    v_cndmask_b32 v67, 0, v65, s[78:79]
    v_add_f32 v12, v12, v13
    v_add_f32 v14, v14, v15
    v_add_f32 v12, v12, v14
    s_mov_b32 exec_lo, 0
    v_accvgpr_write_b32 a255, v12
    s_mov_b64 exec, -1
    ds_write_b32 v121, v12 offset:1024
    ds_read_b128 v[16:19], v122 offset:1152
    ds_read_b128 v[20:23], v122 offset:1184
    ds_read_b128 v[24:27], v122 offset:1216
    ds_read_b128 v[28:31], v122 offset:1248
    ds_read_b128 v[108:111], v6 offset:59392
    s_waitcnt lgkmcnt(5)
    v_mfma_f32_32x32x16_bf16 v[48:63], v[88:91], v[200:203], v[48:63]
    v_or_b32 v75, v66, v67
    v_accvgpr_write_b32 a243, v75
    v_cndmask_b32 v66, 0, v64, s[80:81]
    ds_read_b128 v[88:91], v6 offset:60416
    s_waitcnt lgkmcnt(5)
    v_mfma_f32_32x32x16_bf16 v[48:63], v[92:95], v[204:207], v[48:63]
    v_cndmask_b32 v67, 0, v65, s[20:21]
    v_or_b32 v76, v66, v67
    v_accvgpr_write_b32 a244, v76
    ds_read_b128 v[92:95], v6 offset:61440
    s_waitcnt lgkmcnt(5)
    v_mfma_f32_32x32x16_bf16 v[48:63], v[96:99], v[208:211], v[48:63]
    v_cndmask_b32 v66, 0, v64, s[22:23]
    v_cndmask_b32 v67, 0, v65, s[24:25]
    v_or_b32 v77, v66, v67
    ds_read_b128 v[96:99], v6 offset:62464
    s_waitcnt lgkmcnt(5)
    v_mfma_f32_32x32x16_bf16 v[48:63], v[100:103], v[212:215], v[48:63]
    v_accvgpr_write_b32 a245, v77
    v_cndmask_b32 v66, 0, v64, s[26:27]
    v_cndmask_b32 v67, 0, v65, s[94:95]
    ds_read_b128 v[100:103], v6 offset:63488
    s_waitcnt lgkmcnt(5)
    v_mfma_f32_32x32x16_bf16 v[48:63], v[104:107], v[216:219], v[48:63]
    v_or_b32 v78, v66, v67
    v_accvgpr_write_b32 a246, v78
    v_cndmask_b32 v66, 0, v64, s[96:97]
    s_waitcnt lgkmcnt(4)
    v_mfma_f32_32x32x16_bf16 v[48:63], v[108:111], v[220:223], v[48:63]
    v_cndmask_b32 v67, 0, v65, s[98:99]
    v_or_b32 v79, v66, v67
    v_accvgpr_write_b32 a247, v79
    s_waitcnt lgkmcnt(3)
    v_mfma_f32_32x32x16_bf16 v[48:63], v[88:91], v[224:227], v[48:63]
    v_mul_f32 v16, v16, v118
    v_mul_f32 v17, v17, v118
    v_mul_f32 v18, v18, v118
    v_mul_f32 v19, v19, v118
    v_mov_b32 v64, 0x3f803f80
    v_cndmask_b32 v64, v64, 0, s[44:45]
    v_mov_b32 v65, 0
    s_waitcnt lgkmcnt(2)
    v_mfma_f32_32x32x16_bf16 v[48:63], v[92:95], v[228:231], v[48:63]
    v_mul_f32 v20, v20, v118
    v_mul_f32 v21, v21, v118
    v_mul_f32 v22, v22, v118
    v_mul_f32 v23, v23, v118
    v_mov_b32 v69, 0
    v_mov_b32 v66, 0
    v_mov_b32 v70, 0
    s_waitcnt lgkmcnt(1)
    v_mfma_f32_32x32x16_bf16 v[48:63], v[96:99], v[232:235], v[48:63]
    v_mul_f32 v24, v24, v118
    v_mul_f32 v25, v25, v118
    v_mul_f32 v26, v26, v118
    v_mul_f32 v27, v27, v118
    v_mov_b32 v67, 0
    v_mov_b32 v71, 0
    s_waitcnt lgkmcnt(0)
    v_mfma_f32_32x32x16_bf16 v[48:63], v[100:103], v[236:239], v[48:63]
    v_mul_f32 v28, v28, v118
    v_mul_f32 v29, v29, v118
    v_mul_f32 v30, v30, v118
    v_mul_f32 v31, v31, v118
    s_add_u32 s40, s1, 3153920
    buffer_load_dwordx4 a[140:143], v4, s[8:11], s40 offen sc1
    s_add_u32 s40, s1, 3154944
    buffer_load_dwordx4 a[144:147], v4, s[8:11], s40 offen sc1
    s_add_u32 s40, s1, 3155968
    buffer_load_dwordx4 a[148:151], v4, s[8:11], s40 offen sc1
    s_add_u32 s40, s1, 3156992
    buffer_load_dwordx4 a[152:155], v4, s[8:11], s40 offen sc1
    s_add_u32 s40, s1, 3158016
    buffer_load_dwordx4 a[156:159], v4, s[8:11], s40 offen sc1
    s_add_u32 s40, s1, 3159040
    buffer_load_dwordx4 a[160:163], v4, s[8:11], s40 offen sc1
    s_add_u32 s40, s1, 3160064
    buffer_load_dwordx4 a[164:167], v4, s[8:11], s40 offen sc1
    s_add_u32 s40, s1, 3153920
    buffer_load_dwordx4 a[168:171], v5, s[8:11], s40 offen sc1
    s_branch gk_32
gl_33:
    s_sleep 2
    buffer_load_dwordx4 v[240:243], v1, s[8:11], s32 offen offset:0 sc1
    buffer_load_dwordx4 v[244:247], v1, s[8:11], s32 offen offset:1024 sc1
    buffer_load_dwordx4 v[248:251], v1, s[8:11], s33 offen offset:0 sc1
    buffer_load_dwordx4 v[252:255], v1, s[8:11], s33 offen offset:1024 sc1
    s_add_u32 s60, s60, 1
    s_cmp_gt_u32 s60, 100000
    s_cbranch_scc1 L_exit
    s_waitcnt vmcnt(0)
gk_32:
    s_waitcnt vmcnt(8)
    v_max3_u32 v12, v240, v241, v242
    v_max3_u32 v12, v12, v243, v244
    v_max3_u32 v12, v12, v245, v246
    v_max3_u32 v12, v12, v247, v248
    v_max3_u32 v12, v12, v249, v250
    v_max3_u32 v12, v12, v251, v252
    v_max3_u32 v12, v12, v253, v254
    v_max_u32 v12, v12, v255
    v_cmp_eq_u32 vcc, -1, v12
    s_nop 0
    s_cbranch_vccnz gl_33
    v_mov_b32 v90, 0xf149
    s_cmp_lt_u32 s4, 2
    s_cselect_b32 s29, -1, 0
    s_mov_b32 s28, 0
    v_cndmask_b32 v246, v246, v90, s[28:29]
    s_cmp_lt_u32 s4, 1
    s_cselect_b32 s29, -1, 0
    s_mov_b32 s28, 0
    v_cndmask_b32 v254, v254, v90, s[28:29]
    ds_write_b128 v11, v[240:243] offset:24576
    ds_write_b128 v11, v[244:247] offset:25600
    ds_write_b128 v11, v[248:251] offset:32768
    ds_write_b128 v11, v[252:255] offset:33792
    v_pk_fma_f32 v[48:49], v[48:49], v[116:117], v[16:17] op_sel_hi:[1,0,1]
    v_pk_fma_f32 v[50:51], v[50:51], v[116:117], v[18:19] op_sel_hi:[1,0,1]
    v_pk_fma_f32 v[52:53], v[52:53], v[116:117], v[20:21] op_sel_hi:[1,0,1]
    v_pk_fma_f32 v[54:55], v[54:55], v[116:117], v[22:23] op_sel_hi:[1,0,1]
    v_pk_fma_f32 v[56:57], v[56:57], v[116:117], v[24:25] op_sel_hi:[1,0,1]
    v_pk_fma_f32 v[58:59], v[58:59], v[116:117], v[26:27] op_sel_hi:[1,0,1]
    v_pk_fma_f32 v[60:61], v[60:61], v[116:117], v[28:29] op_sel_hi:[1,0,1]
    v_pk_fma_f32 v[62:63], v[62:63], v[116:117], v[30:31] op_sel_hi:[1,0,1]
    v_cvt_pk_bf16_f32 v80, v48, v49
    v_cvt_pk_bf16_f32 v81, v50, v51
    v_cvt_pk_bf16_f32 v82, v52, v53
    v_cvt_pk_bf16_f32 v83, v54, v55
    v_cvt_pk_bf16_f32 v84, v56, v57
    v_cvt_pk_bf16_f32 v85, v58, v59
    v_cvt_pk_bf16_f32 v86, v60, v61
    v_cvt_pk_bf16_f32 v87, v62, v63
    v_cndmask_b32 v86, v86, 0, s[44:45]
    v_cndmask_b32 v87, v87, 0, s[44:45]
    v_mov_b32 v89, 0x3f80
    v_cndmask_b32 v86, v86, v89, s[44:45]
    s_waitcnt lgkmcnt(0)
    s_barrier
    ds_read_b128 v[16:19], v11 offset:24576
    ds_read_b128 v[20:23], v11 offset:25600
    ds_read_b128 v[24:27], v11 offset:40960
    ds_read_b128 v[28:31], v11 offset:41984
    ds_read_b128 v[32:35], v11 offset:26624
    ds_read_b128 v[36:39], v11 offset:27648
    ds_read_b128 v[40:43], v11 offset:28672
    ds_read_b128 v[44:47], v11 offset:29696
    s_waitcnt lgkmcnt(6)
    v_mfma_f32_32x32x16_bf16 v[96:111], v[16:19], v[80:83], 0
    v_mfma_f32_32x32x16_bf16 v[96:111], v[20:23], v[84:87], v[96:111]
    ds_read_b128 v[16:19], v11 offset:30720
    ds_read_b128 v[20:23], v11 offset:31744
    s_waitcnt lgkmcnt(6)
    v_mfma_f32_32x32x16_bf16 v[224:239], v[24:27], v[80:83], 0
    v_mfma_f32_32x32x16_bf16 v[224:239], v[28:31], v[84:87], v[224:239]
    ds_read_b128 v[24:27], v11 offset:32768
    ds_read_b128 v[28:31], v11 offset:33792
    s_waitcnt lgkmcnt(6)
    v_mfma_f32_32x32x16_bf16 v[112:127], v[32:35], v[80:83], 0
    v_mfma_f32_32x32x16_bf16 v[112:127], v[36:39], v[84:87], v[112:127]
    buffer_load_dwordx4 v[240:243], v1, s[8:11], s34 offen offset:0 sc1
    buffer_load_dwordx4 v[244:247], v1, s[8:11], s34 offen offset:1024 sc1
    buffer_load_dwordx4 v[248:251], v1, s[8:11], s35 offen offset:0 sc1
    buffer_load_dwordx4 v[252:255], v1, s[8:11], s35 offen offset:1024 sc1
    ds_read_b128 v[32:35], v11 offset:34816
    ds_read_b128 v[36:39], v11 offset:35840
    s_waitcnt lgkmcnt(6)
    v_mfma_f32_32x32x16_bf16 v[128:143], v[40:43], v[80:83], 0
    v_cndmask_b32 v96, v224, v96, s[64:65]
    v_cndmask_b32 v97, v225, v97, s[66:67]
    v_cndmask_b32 v98, v226, v98, s[68:69]
    v_cndmask_b32 v99, v227, v99, s[70:71]
    v_cndmask_b32 v100, v228, v100, s[72:73]
    v_cndmask_b32 v101, v229, v101, s[74:75]
    v_mfma_f32_32x32x16_bf16 v[128:143], v[44:47], v[84:87], v[128:143]
    s_add_u32 s40, s1, 3154944
    buffer_load_dwordx4 a[172:175], v5, s[8:11], s40 offen sc1
    v_cndmask_b32 v102, v230, v102, s[76:77]
    v_cndmask_b32 v103, v231, v103, s[78:79]
    v_cndmask_b32 v104, v232, v104, s[80:81]
    v_cndmask_b32 v105, v233, v105, s[20:21]
    ds_read_b128 v[40:43], v11 offset:36864
    ds_read_b128 v[44:47], v11 offset:37888
    s_waitcnt lgkmcnt(6)
    v_mfma_f32_32x32x16_bf16 v[144:159], v[16:19], v[80:83], 0
    v_cndmask_b32 v106, v234, v106, s[22:23]
    v_cndmask_b32 v107, v235, v107, s[24:25]
    v_cndmask_b32 v108, v236, v108, s[26:27]
    v_cndmask_b32 v109, v237, v109, s[94:95]
    v_cndmask_b32 v110, v238, v110, s[96:97]
    v_cndmask_b32 v111, v239, v111, s[98:99]
    v_mfma_f32_32x32x16_bf16 v[144:159], v[20:23], v[84:87], v[144:159]
    s_add_u32 s40, s1, 3155968
    buffer_load_dwordx4 a[176:179], v5, s[8:11], s40 offen sc1
    v_max_f32 v91, v96, v97
    v_max3_f32 v91, v91, v98, v99
    v_max3_f32 v91, v91, v100, v101
    v_max3_f32 v91, v91, v102, v103
    ds_read_b128 v[16:19], v11 offset:38912
    ds_read_b128 v[20:23], v11 offset:39936
    s_waitcnt lgkmcnt(6)
    v_mfma_f32_32x32x16_bf16 v[160:175], v[24:27], v[80:83], 0
    v_max3_f32 v91, v91, v104, v105
    v_max3_f32 v91, v91, v106, v107
    v_max3_f32 v91, v91, v108, v109
    v_max3_f32 v91, v91, v110, v111
    v_max3_f32 v91, v91, v112, v113
    v_max3_f32 v91, v91, v114, v115
    v_mfma_f32_32x32x16_bf16 v[160:175], v[28:31], v[84:87], v[160:175]
    s_add_u32 s40, s1, 3156992
    buffer_load_dwordx4 a[180:183], v5, s[8:11], s40 offen sc1
    v_max3_f32 v91, v91, v116, v117
    v_max3_f32 v91, v91, v118, v119
    v_max3_f32 v91, v91, v120, v121
    v_max3_f32 v91, v91, v122, v123
    s_waitcnt lgkmcnt(4)
    v_mfma_f32_32x32x16_bf16 v[176:191], v[32:35], v[80:83], 0
    v_max3_f32 v91, v91, v124, v125
    v_max3_f32 v91, v91, v126, v127
    v_max3_f32 v91, v91, v128, v129
    v_max3_f32 v91, v91, v130, v131
    v_max3_f32 v91, v91, v132, v133
    v_max3_f32 v91, v91, v134, v135
    v_mfma_f32_32x32x16_bf16 v[176:191], v[36:39], v[84:87], v[176:191]
    s_add_u32 s40, s1, 3158016
    buffer_load_dwordx4 a[184:187], v5, s[8:11], s40 offen sc1
    v_max3_f32 v91, v91, v136, v137
    v_max3_f32 v91, v91, v138, v139
    v_max3_f32 v91, v91, v140, v141
    v_max3_f32 v91, v91, v142, v143
    s_waitcnt lgkmcnt(2)
    v_mfma_f32_32x32x16_bf16 v[192:207], v[40:43], v[80:83], 0
    v_max3_f32 v91, v91, v144, v145
    v_max3_f32 v91, v91, v146, v147
    v_max3_f32 v91, v91, v148, v149
    v_max3_f32 v91, v91, v150, v151
    v_max3_f32 v91, v91, v152, v153
    v_max3_f32 v91, v91, v154, v155
    v_mfma_f32_32x32x16_bf16 v[192:207], v[44:47], v[84:87], v[192:207]
    s_add_u32 s40, s1, 3159040
    buffer_load_dwordx4 a[188:191], v5, s[8:11], s40 offen sc1
    v_max3_f32 v91, v91, v156, v157
    v_max3_f32 v91, v91, v158, v159
    v_max3_f32 v91, v91, v160, v161
    v_max3_f32 v91, v91, v162, v163
    s_waitcnt lgkmcnt(0)
    v_mfma_f32_32x32x16_bf16 v[208:223], v[16:19], v[80:83], 0
    v_max3_f32 v91, v91, v164, v165
    v_max3_f32 v91, v91, v166, v167
    v_max3_f32 v91, v91, v168, v169
    v_max3_f32 v91, v91, v170, v171
    v_max3_f32 v91, v91, v172, v173
    v_max3_f32 v91, v91, v174, v175
    v_mfma_f32_32x32x16_bf16 v[208:223], v[20:23], v[84:87], v[208:223]
    s_add_u32 s40, s1, 3160064
    buffer_load_dwordx4 a[192:195], v5, s[8:11], s40 offen sc1
    v_max3_f32 v91, v91, v176, v177
    v_max3_f32 v91, v91, v178, v179
    v_max3_f32 v91, v91, v180, v181
    v_max3_f32 v91, v91, v182, v183
    v_max3_f32 v91, v91, v184, v185
    v_max3_f32 v91, v91, v186, v187
    v_max3_f32 v91, v91, v188, v189
    v_max3_f32 v91, v91, v190, v191
    v_max3_f32 v91, v91, v192, v193
    v_max3_f32 v91, v91, v194, v195
    v_max3_f32 v91, v91, v196, v197
    v_max3_f32 v91, v91, v198, v199
    v_max3_f32 v91, v91, v200, v201
    v_max3_f32 v91, v91, v202, v203
    v_max3_f32 v91, v91, v204, v205
    v_max3_f32 v91, v91, v206, v207
    v_max3_f32 v91, v91, v208, v209
    v_max3_f32 v91, v91, v210, v211
    v_max3_f32 v91, v91, v212, v213
    v_max3_f32 v91, v91, v214, v215
    v_max3_f32 v91, v91, v216, v217
    v_max3_f32 v91, v91, v218, v219
    v_max3_f32 v91, v91, v220, v221
    v_max3_f32 v91, v91, v222, v223
    v_mov_b32 v92, v91
    s_nop 1
    v_permlane32_swap_b32 v91, v92
    v_max_f32 v91, v91, v92
    v_and_b32 v92, 0xffff0000, v91
    v_sub_f32 v93, v92, v91
    v_cvt_pk_bf16_f32 v68, -v92, v93
    v_and_b32 v94, 0xffff0000, v68
    v_sub_f32 v94, v94, v92
    v_pk_add_f32 v[96:97], v[96:97], v[94:95] op_sel_hi:[1,0]
    v_pk_add_f32 v[98:99], v[98:99], v[94:95] op_sel_hi:[1,0]
    v_pk_add_f32 v[100:101], v[100:101], v[94:95] op_sel_hi:[1,0]
    v_pk_add_f32 v[102:103], v[102:103], v[94:95] op_sel_hi:[1,0]
    v_pk_add_f32 v[104:105], v[104:105], v[94:95] op_sel_hi:[1,0]
    v_pk_add_f32 v[106:107], v[106:107], v[94:95] op_sel_hi:[1,0]
    v_pk_add_f32 v[108:109], v[108:109], v[94:95] op_sel_hi:[1,0]
    v_pk_add_f32 v[110:111], v[110:111], v[94:95] op_sel_hi:[1,0]
    v_mfma_f32_32x32x16_bf16 v[112:127], v[64:67], v[68:71], v[112:127]
    v_exp_f32 v96, v96
    v_exp_f32 v97, v97
    v_exp_f32 v98, v98
    v_exp_f32 v99, v99
    v_mfma_f32_32x32x16_bf16 v[128:143], v[64:67], v[68:71], v[128:143]
    v_exp_f32 v100, v100
    v_exp_f32 v101, v101
    v_exp_f32 v102, v102
    v_exp_f32 v103, v103
    s_add_u32 s40, s1, 3153920
    buffer_load_dwordx4 a[196:199], v6, s[8:11], s40 offen sc1
    v_exp_f32 v104, v104
    v_cvt_pk_bf16_f32 v96, v96, v97
    v_cvt_pk_bf16_f32 v97, v98, v99
    v_cvt_pk_bf16_f32 v98, v100, v101
    v_cvt_pk_bf16_f32 v99, v102, v103
    v_exp_f32 v105, v105
    v_mfma_f32_32x32x16_bf16 v[144:159], v[64:67], v[68:71], v[144:159]
    v_exp_f32 v106, v106
    v_exp_f32 v107, v107
    v_exp_f32 v108, v108
    v_exp_f32 v109, v109
    v_exp_f32 v110, v110
    v_exp_f32 v111, v111
    s_add_u32 s40, s1, 3154944
    buffer_load_dwordx4 a[200:203], v6, s[8:11], s40 offen sc1
    v_cvt_pk_bf16_f32 v100, v104, v105
    v_cvt_pk_bf16_f32 v101, v106, v107
    v_cvt_pk_bf16_f32 v102, v108, v109
    v_cvt_pk_bf16_f32 v103, v110, v111
    v_bfi_b32 v224, v72, 0, v96
    v_and_b32 v96, v96, v72
    v_bfi_b32 v225, v73, 0, v97
    v_and_b32 v97, v97, v73
    v_bfi_b32 v226, v74, 0, v98
    v_and_b32 v98, v98, v74
    v_bfi_b32 v227, v75, 0, v99
    v_and_b32 v99, v99, v75
    v_bfi_b32 v228, v76, 0, v100
    v_and_b32 v100, v100, v76
    v_bfi_b32 v229, v77, 0, v101
    v_and_b32 v101, v101, v77
    v_bfi_b32 v230, v78, 0, v102
    v_and_b32 v102, v102, v78
    v_bfi_b32 v231, v79, 0, v103
    v_and_b32 v103, v103, v79
    s_add_u32 s40, s1, 3155968
    buffer_load_dwordx4 a[204:207], v6, s[8:11], s40 offen sc1
    v_exp_f32 v112, v112
    v_exp_f32 v113, v113
    v_exp_f32 v114, v114
    v_exp_f32 v115, v115
    v_mfma_f32_32x32x16_bf16 v[160:175], v[64:67], v[68:71], v[160:175]
    v_exp_f32 v116, v116
    v_exp_f32 v117, v117
    v_exp_f32 v118, v118
    v_exp_f32 v119, v119
    s_add_u32 s40, s1, 3156992
    buffer_load_dwordx4 a[208:211], v6, s[8:11], s40 offen sc1
    v_exp_f32 v120, v120
    v_cvt_pk_bf16_f32 v112, v112, v113
    v_cvt_pk_bf16_f32 v113, v114, v115
    v_cvt_pk_bf16_f32 v114, v116, v117
    v_cvt_pk_bf16_f32 v115, v118, v119
    v_exp_f32 v121, v121
    v_mfma_f32_32x32x16_bf16 v[176:191], v[64:67], v[68:71], v[176:191]
    v_exp_f32 v122, v122
    v_exp_f32 v123, v123
    v_exp_f32 v124, v124
    v_exp_f32 v125, v125
    v_exp_f32 v126, v126
    v_exp_f32 v127, v127
    s_add_u32 s40, s1, 3158016
    buffer_load_dwordx4 a[212:215], v6, s[8:11], s40 offen sc1
    v_cvt_pk_bf16_f32 v116, v120, v121
    v_cvt_pk_bf16_f32 v117, v122, v123
    v_cvt_pk_bf16_f32 v118, v124, v125
    v_cvt_pk_bf16_f32 v119, v126, v127
    s_add_u32 s40, s1, 3159040
    buffer_load_dwordx4 a[216:219], v6, s[8:11], s40 offen sc1
    s_branch gk_34
gl_35:
    s_sleep 2
    buffer_load_dwordx4 v[240:243], v1, s[8:11], s34 offen offset:0 sc1
    buffer_load_dwordx4 v[244:247], v1, s[8:11], s34 offen offset:1024 sc1
    buffer_load_dwordx4 v[248:251], v1, s[8:11], s35 offen offset:0 sc1
    buffer_load_dwordx4 v[252:255], v1, s[8:11], s35 offen offset:1024 sc1
    s_add_u32 s60, s60, 1
    s_cmp_gt_u32 s60, 100000
    s_cbranch_scc1 L_exit
    s_waitcnt vmcnt(0)
gk_34:
    s_waitcnt vmcnt(12)
    v_max3_u32 v12, v240, v241, v242
    v_max3_u32 v12, v12, v243, v244
    v_max3_u32 v12, v12, v245, v246
    v_max3_u32 v12, v12, v247, v248
    v_max3_u32 v12, v12, v249, v250
    v_max3_u32 v12, v12, v251, v252
    v_max3_u32 v12, v12, v253, v254
    v_max_u32 v12, v12, v255
    v_cmp_eq_u32 vcc, -1, v12
    s_nop 0
    s_cbranch_vccnz gl_35
    ds_write_b128 v11, v[240:243] offset:0
    ds_write_b128 v11, v[244:247] offset:1024
    ds_write_b128 v11, v[248:251] offset:8192
    ds_write_b128 v11, v[252:255] offset:9216
    s_getpc_b64 s[40:41]
cr_36:
    s_sub_u32 s40, s40, 0x570c
    s_subb_u32 s41, s41, 0
    s_lshr_b32 s42, s2, 3
    s_lshl_b32 s42, s42, 2
    s_add_u32 s42, s42, s3
    s_lshl_b32 s42, s42, 9
    v_lshl_add_u32 v7, v2, 7, s42
    v_min_u32 v7, 0xbb60, v7
    s_mov_b64 exec, 0xf
    global_load_dword a252, v7, s[40:41] sc1
    s_mov_b64 exec, -1
    v_exp_f32 v128, v128
    v_exp_f32 v129, v129
    v_exp_f32 v130, v130
    v_exp_f32 v131, v131
    v_mfma_f32_32x32x16_bf16 v[192:207], v[64:67], v[68:71], v[192:207]
    v_exp_f32 v132, v132
    v_exp_f32 v133, v133
    v_exp_f32 v134, v134
    v_exp_f32 v135, v135
    s_add_u32 s40, s1, 3160064
    buffer_load_dwordx4 a[220:223], v6, s[8:11], s40 offen sc1
    v_exp_f32 v136, v136
    v_cvt_pk_bf16_f32 v128, v128, v129
    v_cvt_pk_bf16_f32 v129, v130, v131
    v_cvt_pk_bf16_f32 v130, v132, v133
    v_cvt_pk_bf16_f32 v131, v134, v135
    v_exp_f32 v137, v137
    v_mfma_f32_32x32x16_bf16 v[208:223], v[64:67], v[68:71], v[208:223]
    v_exp_f32 v138, v138
    v_exp_f32 v139, v139
    v_exp_f32 v140, v140
    v_exp_f32 v141, v141
    v_exp_f32 v142, v142
    v_exp_f32 v143, v143
    s_add_u32 s40, s0, 0
    s_add_u32 m0, s56, 0
    s_nop 0
    buffer_load_dwordx4 v1, s[8:11], s40 offen sc1 lds
    v_cvt_pk_bf16_f32 v132, v136, v137
    v_cvt_pk_bf16_f32 v133, v138, v139
    v_cvt_pk_bf16_f32 v134, v140, v141
    v_cvt_pk_bf16_f32 v135, v142, v143
    s_add_u32 s40, s0, 1024
    s_add_u32 m0, s56, 1024
    s_nop 0
    buffer_load_dwordx4 v1, s[8:11], s40 offen sc1 lds
    s_waitcnt lgkmcnt(0)
    s_barrier
    ds_read_b128 v[16:19], v11 offset:0
    ds_read_b128 v[20:23], v11 offset:1024
    ds_read_b128 v[24:27], v11 offset:16384
    ds_read_b128 v[28:31], v11 offset:17408
    ds_read_b128 v[32:35], v11 offset:2048
    ds_read_b128 v[36:39], v11 offset:3072
    v_exp_f32 v144, v144
    v_exp_f32 v145, v145
    v_exp_f32 v146, v146
    ds_read_b128 v[40:43], v11 offset:4096
    ds_read_b128 v[44:47], v11 offset:5120
    s_waitcnt lgkmcnt(6)
    v_mfma_f32_32x32x16_bf16 v[48:63], v[16:19], v[96:99], 0
    v_exp_f32 v147, v147
    v_exp_f32 v148, v148
    v_exp_f32 v149, v149
    v_mfma_f32_32x32x16_bf16 v[48:63], v[20:23], v[100:103], v[48:63]
    v_exp_f32 v150, v150
    v_exp_f32 v151, v151
    s_add_u32 s40, s0, 2048
    s_add_u32 m0, s56, 2048
    s_nop 0
    buffer_load_dwordx4 v1, s[8:11], s40 offen sc1 lds
    v_exp_f32 v152, v152
    ds_read_b128 v[16:19], v11 offset:6144
    ds_read_b128 v[20:23], v11 offset:7168
    s_waitcnt lgkmcnt(6)
    v_mfma_f32_32x32x16_bf16 v[48:63], v[24:27], v[224:227], v[48:63]
    v_cvt_pk_bf16_f32 v144, v144, v145
    v_cvt_pk_bf16_f32 v145, v146, v147
    v_cvt_pk_bf16_f32 v146, v148, v149
    v_cvt_pk_bf16_f32 v147, v150, v151
    v_exp_f32 v153, v153
    v_exp_f32 v154, v154
    v_exp_f32 v155, v155
    v_mfma_f32_32x32x16_bf16 v[48:63], v[28:31], v[228:231], v[48:63]
    v_exp_f32 v156, v156
    v_exp_f32 v157, v157
    v_exp_f32 v158, v158
    ds_read_b128 v[24:27], v11 offset:8192
    ds_read_b128 v[28:31], v11 offset:9216
    s_waitcnt lgkmcnt(6)
    v_mfma_f32_32x32x16_bf16 v[48:63], v[32:35], v[112:115], v[48:63]
    v_exp_f32 v159, v159
    s_add_u32 s40, s0, 3072
    s_add_u32 m0, s56, 3072
    s_nop 0
    buffer_load_dwordx4 v1, s[8:11], s40 offen sc1 lds
    v_cvt_pk_bf16_f32 v148, v152, v153
    v_cvt_pk_bf16_f32 v149, v154, v155
    v_cvt_pk_bf16_f32 v150, v156, v157
    v_cvt_pk_bf16_f32 v151, v158, v159
    s_add_u32 s40, s0, 4096
    s_add_u32 m0, s56, 4096
    s_nop 0
    buffer_load_dwordx4 v1, s[8:11], s40 offen sc1 lds
    v_exp_f32 v160, v160
    v_exp_f32 v161, v161
    v_exp_f32 v162, v162
    v_mfma_f32_32x32x16_bf16 v[48:63], v[36:39], v[116:119], v[48:63]
    v_exp_f32 v163, v163
    v_exp_f32 v164, v164
    v_exp_f32 v165, v165
    ds_read_b128 v[32:35], v11 offset:10240
    ds_read_b128 v[36:39], v11 offset:11264
    s_waitcnt lgkmcnt(6)
    v_mfma_f32_32x32x16_bf16 v[48:63], v[40:43], v[128:131], v[48:63]
    v_exp_f32 v166, v166
    v_exp_f32 v167, v167
    s_add_u32 s40, s0, 5120
    s_add_u32 m0, s56, 5120
    s_nop 0
    buffer_load_dwordx4 v1, s[8:11], s40 offen sc1 lds
    v_exp_f32 v168, v168
    v_mfma_f32_32x32x16_bf16 v[48:63], v[44:47], v[132:135], v[48:63]
    v_cvt_pk_bf16_f32 v160, v160, v161
    v_cvt_pk_bf16_f32 v161, v162, v163
    v_cvt_pk_bf16_f32 v162, v164, v165
    v_cvt_pk_bf16_f32 v163, v166, v167
    v_exp_f32 v169, v169
    v_exp_f32 v170, v170
    v_exp_f32 v171, v171
    ds_read_b128 v[40:43], v11 offset:12288
    ds_read_b128 v[44:47], v11 offset:13312
    s_waitcnt lgkmcnt(6)
    v_mfma_f32_32x32x16_bf16 v[48:63], v[16:19], v[144:147], v[48:63]
    v_exp_f32 v172, v172
    v_exp_f32 v173, v173
    v_exp_f32 v174, v174
    v_mfma_f32_32x32x16_bf16 v[48:63], v[20:23], v[148:151], v[48:63]
    v_exp_f32 v175, v175
    s_add_u32 s40, s0, 6144
    s_add_u32 m0, s56, 6144
    s_nop 0
    buffer_load_dwordx4 v1, s[8:11], s40 offen sc1 lds
    v_cvt_pk_bf16_f32 v164, v168, v169
    v_cvt_pk_bf16_f32 v165, v170, v171
    v_cvt_pk_bf16_f32 v166, v172, v173
    v_cvt_pk_bf16_f32 v167, v174, v175
    s_add_u32 s40, s0, 28672
    s_add_u32 m0, s56, 28672
    s_nop 0
    buffer_load_dwordx4 v1, s[8:11], s40 offen sc1 lds
    v_exp_f32 v176, v176
    v_exp_f32 v177, v177
    v_exp_f32 v178, v178
    ds_read_b128 v[16:19], v11 offset:14336
    ds_read_b128 v[20:23], v11 offset:15360
    s_waitcnt lgkmcnt(6)
    v_mfma_f32_32x32x16_bf16 v[48:63], v[24:27], v[160:163], v[48:63]
    v_exp_f32 v179, v179
    v_exp_f32 v180, v180
    v_exp_f32 v181, v181
    v_mfma_f32_32x32x16_bf16 v[48:63], v[28:31], v[164:167], v[48:63]
    v_exp_f32 v182, v182
    v_exp_f32 v183, v183
    s_add_u32 s40, s0, 29696
    s_add_u32 m0, s56, 29696
    s_nop 0
    buffer_load_dwordx4 v1, s[8:11], s40 offen sc1 lds
    v_exp_f32 v184, v184
    v_cvt_pk_bf16_f32 v176, v176, v177
    v_cvt_pk_bf16_f32 v177, v178, v179
    v_cvt_pk_bf16_f32 v178, v180, v181
    v_cvt_pk_bf16_f32 v179, v182, v183
    v_exp_f32 v185, v185
    v_exp_f32 v186, v186
    v_exp_f32 v187, v187
    v_exp_f32 v188, v188
    v_exp_f32 v189, v189
    v_exp_f32 v190, v190
    v_exp_f32 v191, v191
    s_add_u32 s40, s0, 30720
    s_add_u32 m0, s56, 30720
    s_nop 0
    buffer_load_dwordx4 v1, s[8:11], s40 offen sc1 lds
    v_cvt_pk_bf16_f32 v180, v184, v185
    v_cvt_pk_bf16_f32 v181, v186, v187
    v_cvt_pk_bf16_f32 v182, v188, v189
    v_cvt_pk_bf16_f32 v183, v190, v191
    s_add_u32 s40, s0, 31744
    s_add_u32 m0, s56, 31744
    s_nop 0
    buffer_load_dwordx4 v1, s[8:11], s40 offen sc1 lds
    v_exp_f32 v192, v192
    v_exp_f32 v193, v193
    v_exp_f32 v194, v194
    s_waitcnt lgkmcnt(4)
    v_mfma_f32_32x32x16_bf16 v[48:63], v[32:35], v[176:179], v[48:63]
    v_exp_f32 v195, v195
    v_exp_f32 v196, v196
    v_exp_f32 v197, v197
    v_mfma_f32_32x32x16_bf16 v[48:63], v[36:39], v[180:183], v[48:63]
    v_exp_f32 v198, v198
    v_exp_f32 v199, v199
    s_add_u32 s40, s0, 32768
    s_add_u32 m0, s56, 32768
    s_nop 0
    buffer_load_dwordx4 v1, s[8:11], s40 offen sc1 lds
    v_exp_f32 v200, v200
    v_cvt_pk_bf16_f32 v192, v192, v193
    v_cvt_pk_bf16_f32 v193, v194, v195
    v_cvt_pk_bf16_f32 v194, v196, v197
    v_cvt_pk_bf16_f32 v195, v198, v199
    v_exp_f32 v201, v201
    v_exp_f32 v202, v202
    v_exp_f32 v203, v203
    v_exp_f32 v204, v204
    v_exp_f32 v205, v205
    v_exp_f32 v206, v206
    v_exp_f32 v207, v207
    s_add_u32 s40, s0, 33792
    s_add_u32 m0, s56, 33792
    s_nop 0
    buffer_load_dwordx4 v1, s[8:11], s40 offen sc1 lds
    v_cvt_pk_bf16_f32 v196, v200, v201
    v_cvt_pk_bf16_f32 v197, v202, v203
    v_cvt_pk_bf16_f32 v198, v204, v205
    v_cvt_pk_bf16_f32 v199, v206, v207
    s_add_u32 s40, s0, 34816
    s_add_u32 m0, s56, 34816
    s_nop 0
    buffer_load_dwordx4 v1, s[8:11], s40 offen sc1 lds
    v_exp_f32 v208, v208
    v_exp_f32 v209, v209
    v_exp_f32 v210, v210
    s_waitcnt lgkmcnt(2)
    v_mfma_f32_32x32x16_bf16 v[48:63], v[40:43], v[192:195], v[48:63]
    v_exp_f32 v211, v211
    v_exp_f32 v212, v212
    v_exp_f32 v213, v213
    v_mfma_f32_32x32x16_bf16 v[48:63], v[44:47], v[196:199], v[48:63]
    v_exp_f32 v214, v214
    v_exp_f32 v215, v215
    v_exp_f32 v216, v216
    v_cvt_pk_bf16_f32 v208, v208, v209
    v_cvt_pk_bf16_f32 v209, v210, v211
    v_cvt_pk_bf16_f32 v210, v212, v213
    v_cvt_pk_bf16_f32 v211, v214, v215
    v_exp_f32 v217, v217
    v_exp_f32 v218, v218
    v_exp_f32 v219, v219
    v_exp_f32 v220, v220
    v_exp_f32 v221, v221
    v_exp_f32 v222, v222
    v_exp_f32 v223, v223
    v_cvt_pk_bf16_f32 v212, v216, v217
    v_cvt_pk_bf16_f32 v213, v218, v219
    v_cvt_pk_bf16_f32 v214, v220, v221
    v_cvt_pk_bf16_f32 v215, v222, v223
    s_waitcnt lgkmcnt(0)
    v_mfma_f32_32x32x16_bf16 v[48:63], v[16:19], v[208:211], v[48:63]
    v_mfma_f32_32x32x16_bf16 v[48:63], v[20:23], v[212:215], v[48:63]
    s_nop 11
    v_mov_b32 v12, v60
    v_mov_b32 v13, v60
    s_mul_i32 s28, s5, 7
    s_lshr_b32 s28, s28, 1
    s_lshl_b32 s28, s28, 9
    s_add_u32 s28, s28, s50
    s_add_u32 s28, s28, 5652480
    v_permlane32_swap_b32 v12, v13
    v_rcp_f32 v12, v13
    s_nop 0
    v_pk_mul_f32 v[48:49], v[48:49], v[12:13] op_sel_hi:[1,0]
    v_pk_mul_f32 v[50:51], v[50:51], v[12:13] op_sel_hi:[1,0]
    v_pk_mul_f32 v[52:53], v[52:53], v[12:13] op_sel_hi:[1,0]
    v_pk_mul_f32 v[54:55], v[54:55], v[12:13] op_sel_hi:[1,0]
    v_pk_mul_f32 v[56:57], v[56:57], v[12:13] op_sel_hi:[1,0]
    v_pk_mul_f32 v[58:59], v[58:59], v[12:13] op_sel_hi:[1,0]
    v_pk_mul_f32 v[60:61], v[60:61], v[12:13] op_sel_hi:[1,0]
    v_pk_mul_f32 v[62:63], v[62:63], v[12:13] op_sel_hi:[1,0]
    v_cvt_pk_bf16_f32 v48, v48, v49
    v_cvt_pk_bf16_f32 v49, v50, v51
    v_cvt_pk_bf16_f32 v50, v52, v53
    v_cvt_pk_bf16_f32 v51, v54, v55
    v_cvt_pk_bf16_f32 v52, v56, v57
    v_cvt_pk_bf16_f32 v53, v58, v59
    v_cvt_pk_bf16_f32 v54, v60, v61
    v_cvt_pk_bf16_f32 v55, v62, v63
    v_or_b32 v48, 1, v48
    v_or_b32 v50, 1, v50
    v_or_b32 v52, 1, v52
    v_or_b32 v54, 1, v54
    s_bitcmp1_b32 s5, 0
    s_cbranch_scc1 oo_37
    v_permlane32_swap_b32 v48, v50
    v_permlane32_swap_b32 v49, v51
    v_permlane32_swap_b32 v52, v54
    v_permlane32_swap_b32 v53, v55
    s_cmp_eq_u32 s6, 0
    s_cbranch_scc1 ls_39
    buffer_store_dwordx4 v[48:51], v1, s[8:11], s28 offen
    s_mov_b32 exec_hi, 0
    buffer_store_dwordx4 v[52:55], v1, s[8:11], s28 offen offset:1024
    s_not_b64 exec, exec
    buffer_store_dwordx2 v[52:53], v1, s[8:11], s28 offen offset:1024
    s_mov_b64 exec, -1
le_40:
    s_branch od_38
oo_37:
    s_nop 1
    v_permlane32_swap_b32 v50, v50
    v_permlane32_swap_b32 v51, v51
    v_permlane32_swap_b32 v54, v54
    v_permlane32_swap_b32 v55, v55
    s_cmp_eq_u32 s6, 0
    s_cbranch_scc1 ls_41
    s_mov_b32 exec_lo, 0
    buffer_store_dwordx4 v[48:51], v1, s[8:11], s28 offen
    buffer_store_dwordx4 v[52:55], v1, s[8:11], s28 offen offset:1024
    s_not_b64 exec, exec
    buffer_store_dwordx4 v[50:53], v1, s[8:11], s28 offen offset:1024
    buffer_store_dwordx2 v[48:49], v1, s[8:11], s28 offen offset:8
    s_mov_b64 exec, -1
le_42:
od_38:
    s_nop 1
    s_add_u32 s28, s52, s56
    s_add_u32 s28, s28, 5652480
    s_add_u32 s29, s28, 4096
    v_add_u32 v112, 135168, v3
    v_add_u32 v113, 135168, v4
    v_add_u32 v114, 135168, v5
    v_add_u32 v115, 135168, v6
    s_add_u32 s30, s85, 3555328
    s_add_u32 s31, s86, 3555328
    v_mov_b32 v200, 0
    v_mov_b32 v201, 0
    v_mov_b32 v204, 0x3f803f80
    v_accvgpr_read_b32 v192, a224
    v_accvgpr_read_b32 v193, a225
    v_accvgpr_read_b32 v194, a226
    v_accvgpr_read_b32 v195, a227
    v_accvgpr_read_b32 v196, a228
    v_accvgpr_read_b32 v197, a229
    v_accvgpr_read_b32 v198, a230
    v_accvgpr_read_b32 v199, a231
    v_permlane32_swap_b32 v192, v194
    v_permlane32_swap_b32 v193, v195
    v_permlane32_swap_b32 v196, v198
    v_permlane32_swap_b32 v197, v199
    v_lshlrev_b32 v96, 16, v192
    v_and_b32 v97, 0xffff0000, v192
    v_lshlrev_b32 v98, 16, v193
    v_and_b32 v99, 0xffff0000, v193
    v_lshlrev_b32 v100, 16, v194
    v_and_b32 v101, 0xffff0000, v194
    v_lshlrev_b32 v102, 16, v195
    v_and_b32 v103, 0xffff0000, v195
    v_lshlrev_b32 v104, 16, v196
    v_and_b32 v105, 0xffff0000, v196
    v_lshlrev_b32 v106, 16, v197
    v_and_b32 v107, 0xffff0000, v197
    v_lshlrev_b32 v108, 16, v198
    v_and_b32 v109, 0xffff0000, v198
    v_lshlrev_b32 v110, 16, v199
    v_and_b32 v111, 0xffff0000, v199
    buffer_load_dwordx4 v[128:131], v1, s[8:11], s28 offen offset:0 sc1
    buffer_load_dwordx4 v[132:135], v1, s[8:11], s28 offen offset:1024 sc1
    buffer_load_dwordx4 v[136:139], v1, s[8:11], s28 offen offset:2048 sc1
    buffer_load_dwordx4 v[140:143], v1, s[8:11], s28 offen offset:3072 sc1
    buffer_load_dwordx4 v[144:147], v1, s[8:11], s29 offen offset:0 sc1
    buffer_load_dwordx4 v[148:151], v1, s[8:11], s29 offen offset:1024 sc1
    buffer_load_dwordx4 v[152:155], v1, s[8:11], s29 offen offset:2048 sc1
    s_branch L_wob0_w
L_wob0_g:
    s_waitcnt lgkmcnt(0)
    buffer_load_dwordx4 v[128:131], v1, s[8:11], s28 offen offset:0 sc1
    buffer_load_dwordx4 v[132:135], v1, s[8:11], s28 offen offset:1024 sc1
    buffer_load_dwordx4 v[136:139], v1, s[8:11], s28 offen offset:2048 sc1
    buffer_load_dwordx4 v[140:143], v1, s[8:11], s28 offen offset:3072 sc1
    buffer_load_dwordx4 v[144:147], v1, s[8:11], s29 offen offset:0 sc1
    buffer_load_dwordx4 v[148:151], v1, s[8:11], s29 offen offset:1024 sc1
    buffer_load_dwordx4 v[152:155], v1, s[8:11], s29 offen offset:2048 sc1
    s_add_u32 s60, s60, 1
    s_cmp_gt_u32 s60, 100000
    s_cbranch_scc1 L_exit
L_wob0_w:
    s_waitcnt vmcnt(6)
    ds_write_b128 v112, v[128:131] offset:0
    v_bitop3_b32 v120, v128, v128, v130 bitop3:0x80
    s_waitcnt vmcnt(5)
    ds_write_b128 v112, v[132:135] offset:1024
    v_bitop3_b32 v120, v120, v132, v134 bitop3:0x80
    s_waitcnt vmcnt(4)
    ds_write_b128 v112, v[136:139] offset:2048
    v_bitop3_b32 v120, v120, v136, v138 bitop3:0x80
    s_waitcnt vmcnt(3)
    ds_write_b128 v112, v[140:143] offset:3072
    v_bitop3_b32 v120, v120, v140, v142 bitop3:0x80
    s_waitcnt vmcnt(2)
    ds_write_b128 v112, v[144:147] offset:4096
    v_bitop3_b32 v120, v120, v144, v146 bitop3:0x80
    s_waitcnt vmcnt(1)
    ds_write_b128 v112, v[148:151] offset:5120
    v_bitop3_b32 v120, v120, v148, v150 bitop3:0x80
    s_waitcnt vmcnt(0)
    ds_write_b128 v112, v[152:155] offset:6144
    v_bitop3_b32 v120, v120, v152, v154 bitop3:0x80
    v_and_b32 v120, 1, v120
    v_cmp_ne_u32 vcc, 1, v120
    s_nop 0
    s_cbranch_vccnz L_wob0_g
L_wob0_ok:
    v_mfma_f32_32x32x16_bf16 v[96:111], a[112:115], v[128:131], v[96:111]
    s_waitcnt lgkmcnt(0)
    s_barrier
    ds_read_b128 v[188:191], v113 offset:0
    ds_read_b128 v[160:163], v113 offset:1024
    ds_read_b128 v[164:167], v113 offset:2048
    v_mfma_f32_32x32x16_bf16 v[96:111], a[116:119], v[132:135], v[96:111]
    ds_read_b128 v[168:171], v113 offset:3072
    v_mfma_f32_32x32x16_bf16 v[96:111], a[120:123], v[136:139], v[96:111]
    ds_read_b128 v[172:175], v113 offset:4096
    v_mfma_f32_32x32x16_bf16 v[96:111], a[124:127], v[140:143], v[96:111]
    ds_read_b128 v[176:179], v113 offset:5120
    v_mfma_f32_32x32x16_bf16 v[96:111], a[128:131], v[144:147], v[96:111]
    ds_read_b128 v[180:183], v113 offset:6144
    v_mfma_f32_32x32x16_bf16 v[96:111], a[132:135], v[148:151], v[96:111]
    v_mfma_f32_32x32x16_bf16 v[96:111], a[136:139], v[152:155], v[96:111]
    s_getpc_b64 s[40:41]
cr_43:
    s_sub_u32 s40, s40, 0x612c
    s_subb_u32 s41, s41, 0
    s_lshr_b32 s42, s2, 3
    s_lshl_b32 s42, s42, 2
    s_add_u32 s42, s42, s3
    s_lshl_b32 s42, s42, 9
    v_lshl_add_u32 v7, v2, 7, s42
    v_min_u32 v7, 0xbb60, v7
    s_mov_b64 exec, 0xf
    global_load_dword a252, v7, s[40:41] sc1
    s_mov_b64 exec, -1
    ds_read_b128 v[184:187], v114 offset:0
    s_waitcnt lgkmcnt(7)
    v_mfma_f32_32x32x16_bf16 v[96:111], a[140:143], v[188:191], v[96:111]
    ds_read_b128 v[188:191], v114 offset:1024
    s_waitcnt lgkmcnt(7)
    v_mfma_f32_32x32x16_bf16 v[96:111], a[144:147], v[160:163], v[96:111]
    ds_read_b128 v[160:163], v114 offset:2048
    s_waitcnt lgkmcnt(7)
    v_mfma_f32_32x32x16_bf16 v[96:111], a[148:151], v[164:167], v[96:111]
    ds_read_b128 v[164:167], v114 offset:3072
    s_waitcnt lgkmcnt(7)
    v_mfma_f32_32x32x16_bf16 v[96:111], a[152:155], v[168:171], v[96:111]
    ds_read_b128 v[168:171], v114 offset:4096
    s_waitcnt lgkmcnt(7)
    v_mfma_f32_32x32x16_bf16 v[96:111], a[156:159], v[172:175], v[96:111]
    ds_read_b128 v[172:175], v114 offset:5120
    s_waitcnt lgkmcnt(7)
    v_mfma_f32_32x32x16_bf16 v[96:111], a[160:163], v[176:179], v[96:111]
    ds_read_b128 v[176:179], v114 offset:6144
    s_waitcnt lgkmcnt(7)
    v_mfma_f32_32x32x16_bf16 v[96:111], a[164:167], v[180:183], v[96:111]
    ds_read_b128 v[180:183], v115 offset:0
    s_waitcnt lgkmcnt(7)
    v_mfma_f32_32x32x16_bf16 v[96:111], a[168:171], v[184:187], v[96:111]
    ds_read_b128 v[184:187], v115 offset:1024
    s_waitcnt lgkmcnt(7)
    v_mfma_f32_32x32x16_bf16 v[96:111], a[172:175], v[188:191], v[96:111]
    ds_read_b128 v[188:191], v115 offset:2048
    s_waitcnt lgkmcnt(7)
    v_mfma_f32_32x32x16_bf16 v[96:111], a[176:179], v[160:163], v[96:111]
    ds_read_b128 v[160:163], v115 offset:3072
    s_waitcnt lgkmcnt(7)
    v_mfma_f32_32x32x16_bf16 v[96:111], a[180:183], v[164:167], v[96:111]
    ds_read_b128 v[164:167], v115 offset:4096
    s_waitcnt lgkmcnt(7)
    v_mfma_f32_32x32x16_bf16 v[96:111], a[184:187], v[168:171], v[96:111]
    ds_read_b128 v[168:171], v115 offset:5120
    s_waitcnt lgkmcnt(7)
    v_mfma_f32_32x32x16_bf16 v[96:111], a[188:191], v[172:175], v[96:111]
    ds_read_b128 v[172:175], v115 offset:6144
    s_waitcnt lgkmcnt(7)
    v_mfma_f32_32x32x16_bf16 v[96:111], a[192:195], v[176:179], v[96:111]
    s_waitcnt lgkmcnt(6)
    v_mfma_f32_32x32x16_bf16 v[96:111], a[196:199], v[180:183], v[96:111]
    s_waitcnt lgkmcnt(5)
    v_mfma_f32_32x32x16_bf16 v[96:111], a[200:203], v[184:187], v[96:111]
    s_waitcnt lgkmcnt(4)
    v_mfma_f32_32x32x16_bf16 v[96:111], a[204:207], v[188:191], v[96:111]
    s_waitcnt lgkmcnt(3)
    v_mfma_f32_32x32x16_bf16 v[96:111], a[208:211], v[160:163], v[96:111]
    s_waitcnt lgkmcnt(2)
    v_mfma_f32_32x32x16_bf16 v[96:111], a[212:215], v[164:167], v[96:111]
    s_waitcnt lgkmcnt(1)
    v_mfma_f32_32x32x16_bf16 v[96:111], a[216:219], v[168:171], v[96:111]
    s_waitcnt lgkmcnt(0)
    v_mfma_f32_32x32x16_bf16 v[96:111], a[220:223], v[172:175], v[96:111]
    s_cmp_ge_u32 s54, 14
    s_cbranch_scc1 L_wob0_idle
    s_nop 9
    v_cvt_pk_bf16_f32 v192, v96, v97
    v_cvt_pk_bf16_f32 v193, v98, v99
    v_cvt_pk_bf16_f32 v194, v100, v101
    v_cvt_pk_bf16_f32 v195, v102, v103
    v_cvt_pk_bf16_f32 v196, v104, v105
    v_cvt_pk_bf16_f32 v197, v106, v107
    v_cvt_pk_bf16_f32 v198, v108, v109
    v_cvt_pk_bf16_f32 v199, v110, v111
    v_permlane32_swap_b32 v192, v194
    v_permlane32_swap_b32 v193, v195
    v_permlane32_swap_b32 v196, v198
    v_permlane32_swap_b32 v197, v199
    v_accvgpr_write_b32 a224, v192
    v_or_b32 v192, 1, v192
    v_accvgpr_write_b32 a228, v196
    v_or_b32 v196, 1, v196
    s_cmp_eq_u32 s6, 0
    s_cbranch_scc1 ls_44
    buffer_store_dwordx4 v[192:195], v1, s[8:11], s30 offen
    buffer_store_dwordx4 v[196:199], v1, s[8:11], s30 offen offset:1024
le_45:
    v_dot2c_f32_bf16 v200, v192, v204
    v_dot2c_f32_bf16 v201, v192, v192
    v_dot2c_f32_bf16 v200, v193, v204
    v_dot2c_f32_bf16 v201, v193, v193
    v_dot2c_f32_bf16 v200, v194, v204
    v_dot2c_f32_bf16 v201, v194, v194
    v_dot2c_f32_bf16 v200, v195, v204
    v_dot2c_f32_bf16 v201, v195, v195
    v_dot2c_f32_bf16 v200, v196, v204
    v_dot2c_f32_bf16 v201, v196, v196
    v_dot2c_f32_bf16 v200, v197, v204
    v_dot2c_f32_bf16 v201, v197, v197
    v_dot2c_f32_bf16 v200, v198, v204
    v_dot2c_f32_bf16 v201, v198, v198
    v_dot2c_f32_bf16 v200, v199, v204
    v_dot2c_f32_bf16 v201, v199, v199
    s_nop 1
    v_mov_b32 v202, v200
    v_mov_b32 v203, v201
    s_nop 0
    v_permlane32_swap_b32 v200, v202
    v_permlane32_swap_b32 v201, v203
    v_pk_add_f32 v[200:201], v[200:201], v[202:203]
    v_or_b32 v200, 1, v200
    v_or_b32 v201, 1, v201
    s_cmp_eq_u32 s6, 0
    s_cbranch_scc1 ls_46
    s_mov_b32 exec_hi, 0
    buffer_store_dwordx2 v[200:201], v8, s[8:11], s31 offen
    s_mov_b64 exec, -1
le_47:
    v_accvgpr_write_b32 a225, v193
    v_accvgpr_write_b32 a226, v194
    v_accvgpr_write_b32 a227, v195
    v_accvgpr_write_b32 a229, v197
    v_accvgpr_write_b32 a230, v198
    v_accvgpr_write_b32 a231, v199
L_wob0_idle:
    v_lshl_add_u32 v121, v2, 2, s88
    v_lshrrev_b32 v122, 5, v2
    v_lshl_add_u32 v122, v122, 4, s88
    s_lshl_b32 s28, s3, 2
    s_add_u32 s28, s28, 86016
    v_add_u32 v123, s28, v1
    v_add_u32 v124, 86016, v1
    v_mov_b32 v112, 0x3f803f80
    v_mov_b32 v113, 0x3f803f80
    v_mov_b32 v114, 0x3f803f80
    v_mov_b32 v115, 0x3f803f80
    s_add_u32 s32, s51, 5390336
    s_add_u32 s33, s50, 3555328
    s_add_u32 s34, s33, s56
    s_add_u32 s35, s33, s57
    s_add_u32 s36, s33, s58
    s_add_u32 s37, s33, s59
    buffer_load_dwordx2 v[240:241], v8, s[8:11], s32 offen offset:0 sc1
    buffer_load_dwordx2 v[242:243], v8, s[8:11], s32 offen offset:512 sc1
    buffer_load_dwordx2 v[244:245], v8, s[8:11], s32 offen offset:1024 sc1
    buffer_load_dwordx2 v[246:247], v8, s[8:11], s32 offen offset:1536 sc1
    buffer_load_dwordx2 v[248:249], v8, s[8:11], s32 offen offset:2048 sc1
    buffer_load_dwordx2 v[250:251], v8, s[8:11], s32 offen offset:2560 sc1
    buffer_load_dwordx2 v[252:253], v8, s[8:11], s32 offen offset:3072 sc1
    buffer_load_dwordx4 v[128:131], v1, s[8:11], s34 offen offset:0 sc1
    buffer_load_dwordx4 v[132:135], v1, s[8:11], s34 offen offset:1024 sc1
    buffer_load_dwordx4 v[136:139], v1, s[8:11], s34 offen offset:2048 sc1
    buffer_load_dwordx4 v[140:143], v1, s[8:11], s34 offen offset:3072 sc1
    ds_read_b128 v[96:99], v3 offset:0
    ds_read_b128 v[100:103], v3 offset:28672
    ds_read_b128 v[104:107], v3 offset:1024
    ds_read_b128 v[108:111], v3 offset:29696
    s_branch gk_48
gl_49:
    buffer_load_dwordx2 v[240:241], v8, s[8:11], s32 offen offset:0 sc1
    buffer_load_dwordx2 v[242:243], v8, s[8:11], s32 offen offset:512 sc1
    buffer_load_dwordx2 v[244:245], v8, s[8:11], s32 offen offset:1024 sc1
    buffer_load_dwordx2 v[246:247], v8, s[8:11], s32 offen offset:1536 sc1
    buffer_load_dwordx2 v[248:249], v8, s[8:11], s32 offen offset:2048 sc1
    buffer_load_dwordx2 v[250:251], v8, s[8:11], s32 offen offset:2560 sc1
    buffer_load_dwordx2 v[252:253], v8, s[8:11], s32 offen offset:3072 sc1
    buffer_load_dwordx4 v[128:131], v1, s[8:11], s34 offen offset:0 sc1
    buffer_load_dwordx4 v[132:135], v1, s[8:11], s34 offen offset:1024 sc1
    buffer_load_dwordx4 v[136:139], v1, s[8:11], s34 offen offset:2048 sc1
    buffer_load_dwordx4 v[140:143], v1, s[8:11], s34 offen offset:3072 sc1
    s_add_u32 s60, s60, 1
    s_cmp_gt_u32 s60, 100000
    s_cbranch_scc1 L_exit
    s_waitcnt vmcnt(4)
gk_48:
    s_waitcnt vmcnt(4)
    v_bitop3_b32 v120, v240, v241, v242 bitop3:0x80
    v_bitop3_b32 v120, v120, v243, v244 bitop3:0x80
    v_bitop3_b32 v120, v120, v245, v246 bitop3:0x80
    v_bitop3_b32 v120, v120, v247, v248 bitop3:0x80
    v_bitop3_b32 v120, v120, v249, v250 bitop3:0x80
    v_bitop3_b32 v120, v120, v251, v252 bitop3:0x80
    v_bitop3_b32 v120, v120, v253, v240 bitop3:0x80
    v_and_b32 v120, 1, v120
    v_cmp_ne_u32 vcc, 1, v120
    s_nop 0
    s_cbranch_vccnz gl_49
    s_add_u32 s38, s34, 4096
    buffer_load_dwordx4 v[144:147], v1, s[8:11], s38 offen offset:0 sc1
    buffer_load_dwordx4 v[148:151], v1, s[8:11], s38 offen offset:1024 sc1
    buffer_load_dwordx4 v[152:155], v1, s[8:11], s38 offen offset:2048 sc1
    buffer_load_dwordx4 v[156:159], v1, s[8:11], s35 offen offset:0 sc1
    buffer_load_dwordx4 v[160:163], v1, s[8:11], s35 offen offset:1024 sc1
    buffer_load_dwordx4 v[164:167], v1, s[8:11], s35 offen offset:2048 sc1
    buffer_load_dwordx4 v[168:171], v1, s[8:11], s35 offen offset:3072 sc1
    s_add_u32 s38, s35, 4096
    buffer_load_dwordx4 v[172:175], v1, s[8:11], s38 offen offset:0 sc1
    v_pk_add_f32 v[240:241], v[240:241], v[242:243]
    v_pk_add_f32 v[240:241], v[240:241], v[244:245]
    v_pk_add_f32 v[240:241], v[240:241], v[246:247]
    v_pk_add_f32 v[240:241], v[240:241], v[248:249]
    v_pk_add_f32 v[240:241], v[240:241], v[250:251]
    v_pk_add_f32 v[240:241], v[240:241], v[252:253]
    ds_read_b128 v[248:251], v3 offset:2048
    ds_read_b128 v[252:255], v3 offset:30720
    v_mov_b32 v242, v240
    v_mov_b32 v243, v241
    s_nop 0
    v_permlane32_swap_b32 v240, v242
    v_permlane32_swap_b32 v241, v243
    v_add_f32 v240, v240, v242
    v_add_f32 v241, v241, v243
    v_mul_f32 v240, 0x3b124925, v240
    v_mul_f32 v241, 0x3b124925, v241
    v_fma_f32 v241, -v240, v240, v241
    v_max_f32 v241, 0, v241
    v_add_f32 v241, 0x3727c5ac, v241
    v_rsq_f32 v116, v241
    s_nop 0
    v_mul_f32 v118, -v240, v116
    v_cndmask_b32 v242, v116, v118, s[44:45]
    ds_write_b32 v121, v242
    s_waitcnt vmcnt(8)
L_a1_c:
    v_bitop3_b32 v120, v128, v132, v136 bitop3:0x80
    v_bitop3_b32 v120, v120, v140, v128 bitop3:0x80
    v_bitop3_b32 v120, v120, v128, v128 bitop3:0x80
    v_and_b32 v120, 1, v120
    v_cmp_ne_u32 vcc, 1, v120
    s_nop 0
    s_cbranch_vccnz L_a1_r
    v_mov_b32 v120, 1
    ds_read_b128 v[240:243], v3 offset:3072
    ds_read_b128 v[244:247], v3 offset:31744
    s_waitcnt vmcnt(11) lgkmcnt(6)
    v_mfma_f32_32x32x16_bf16 v[16:31], v[96:99], v[128:131], 0
    buffer_load_dwordx4 v[176:179], v1, s[8:11], s38 offen offset:1024 sc1
    v_mfma_f32_32x32x16_bf16 v[32:47], v[128:131], v[100:103], 0
    s_lshl_b32 s40, s3, 11
    s_add_u32 s40, s40, 119808
    v_add_u32 v117, s40, v1
    ds_read_b128 v[96:99], v3 offset:4096
    ds_read_b128 v[100:103], v3 offset:32768
    s_waitcnt vmcnt(11) lgkmcnt(6)
    v_mfma_f32_32x32x16_bf16 v[16:31], v[104:107], v[132:135], v[16:31]
    buffer_load_dwordx4 v[180:183], v1, s[8:11], s38 offen offset:2048 sc1
    v_bitop3_b32 v120, v120, v132, v128 bitop3:0x80
    v_mfma_f32_32x32x16_bf16 v[32:47], v[132:135], v[108:111], v[32:47]
    s_mul_i32 s40, s3, 4352
    s_add_u32 s40, s40, 102400
    v_and_b32 v119, 31, v2
    ds_read_b128 v[104:107], v3 offset:5120
    ds_read_b128 v[108:111], v3 offset:33792
    s_waitcnt vmcnt(11) lgkmcnt(6)
    v_mfma_f32_32x32x16_bf16 v[16:31], v[248:251], v[136:139], v[16:31]
    buffer_load_dwordx4 v[184:187], v1, s[8:11], s36 offen offset:0 sc1
    v_mfma_f32_32x32x16_bf16 v[32:47], v[136:139], v[252:255], v[32:47]
    v_mul_u32_u24 v119, 136, v119
    v_lshrrev_b32 v12, 5, v2
    v_lshl_add_u32 v119, v12, 3, v119
    ds_read_b128 v[248:251], v3 offset:6144
    ds_read_b128 v[252:255], v3 offset:34816
    s_waitcnt vmcnt(11) lgkmcnt(6)
    v_mfma_f32_32x32x16_bf16 v[16:31], v[240:243], v[140:143], v[16:31]
    buffer_load_dwordx4 v[188:191], v1, s[8:11], s36 offen offset:1024 sc1
    v_bitop3_b32 v120, v120, v140, v136 bitop3:0x80
    v_mfma_f32_32x32x16_bf16 v[32:47], v[140:143], v[244:247], v[32:47]
    v_add_u32 v119, s40, v119
    v_lshlrev_b32 v125, 4, v12
    v_bfe_u32 v13, v2, 4, 1
    ds_read_b128 v[240:243], v4 offset:0
    ds_read_b128 v[244:247], v4 offset:28672
    s_waitcnt vmcnt(11) lgkmcnt(6)
    v_mfma_f32_32x32x16_bf16 v[16:31], v[96:99], v[144:147], v[16:31]
    buffer_load_dwordx4 v[192:195], v1, s[8:11], s36 offen offset:2048 sc1
    v_mfma_f32_32x32x16_bf16 v[32:47], v[144:147], v[100:103], v[32:47]
    v_lshl_add_u32 v125, v13, 2, v125
    v_bfe_u32 v14, v2, 2, 2
    v_add_u32 v125, v125, v14
    ds_read_b128 v[96:99], v4 offset:1024
    ds_read_b128 v[100:103], v4 offset:29696
    s_waitcnt vmcnt(11) lgkmcnt(6)
    v_mfma_f32_32x32x16_bf16 v[16:31], v[104:107], v[148:151], v[16:31]
    buffer_load_dwordx4 v[196:199], v1, s[8:11], s36 offen offset:3072 sc1
    v_bitop3_b32 v120, v120, v148, v144 bitop3:0x80
    v_mfma_f32_32x32x16_bf16 v[32:47], v[148:151], v[108:111], v[32:47]
    v_mul_u32_u24 v125, 136, v125
    v_and_b32 v14, 3, v2
    v_lshl_add_u32 v125, v14, 3, v125
    ds_read_b128 v[104:107], v4 offset:2048
    ds_read_b128 v[108:111], v4 offset:30720
    s_waitcnt vmcnt(11) lgkmcnt(6)
    v_mfma_f32_32x32x16_bf16 v[16:31], v[248:251], v[152:155], v[16:31]
    s_add_u32 s38, s36, 4096
    buffer_load_dwordx4 v[200:203], v1, s[8:11], s38 offen offset:0 sc1
    v_mfma_f32_32x32x16_bf16 v[32:47], v[152:155], v[252:255], v[32:47]
    s_lshl_b32 s40, s3, 5
    s_add_u32 s40, s40, 102400
    v_add_u32 v125, s40, v125
    ds_read_b128 v[248:251], v4 offset:3072
    ds_read_b128 v[252:255], v4 offset:31744
    s_waitcnt vmcnt(11) lgkmcnt(6)
    v_mfma_f32_32x32x16_bf16 v[16:31], v[240:243], v[156:159], v[16:31]
    buffer_load_dwordx4 v[204:207], v1, s[8:11], s38 offen offset:1024 sc1
    v_bitop3_b32 v120, v120, v156, v152 bitop3:0x80
    v_mfma_f32_32x32x16_bf16 v[32:47], v[156:159], v[244:247], v[32:47]
    v_and_b32 v127, 0xf0, v1
    v_lshl_add_u32 v127, v12, 10, v127
    v_lshl_add_u32 v127, v13, 9, v127
    ds_read_b128 v[240:243], v4 offset:4096
    ds_read_b128 v[244:247], v4 offset:32768
    s_waitcnt vmcnt(11) lgkmcnt(6)
    v_mfma_f32_32x32x16_bf16 v[16:31], v[96:99], v[160:163], v[16:31]
    buffer_load_dwordx4 v[208:211], v1, s[8:11], s38 offen offset:2048 sc1
    v_mfma_f32_32x32x16_bf16 v[32:47], v[160:163], v[100:103], v[32:47]
    v_add_u32 v127, 119808, v127
    ds_read_b128 v[96:99], v4 offset:5120
    ds_read_b128 v[100:103], v4 offset:33792
    s_waitcnt vmcnt(11) lgkmcnt(6)
    v_mfma_f32_32x32x16_bf16 v[16:31], v[104:107], v[164:167], v[16:31]
    buffer_load_dwordx4 v[212:215], v1, s[8:11], s37 offen offset:0 sc1
    v_bitop3_b32 v120, v120, v164, v160 bitop3:0x80
    v_mfma_f32_32x32x16_bf16 v[32:47], v[164:167], v[108:111], v[32:47]
    ds_read_b128 v[64:67], v122 offset:0
    ds_read_b128 v[80:83], v122 offset:128
    ds_read_b128 v[68:71], v122 offset:32
    ds_read_b128 v[84:87], v122 offset:160
    ds_read_b128 v[104:107], v4 offset:6144
    ds_read_b128 v[108:111], v4 offset:34816
    s_waitcnt vmcnt(11) lgkmcnt(6)
    v_mfma_f32_32x32x16_bf16 v[16:31], v[248:251], v[168:171], v[16:31]
    buffer_load_dwordx4 v[216:219], v1, s[8:11], s37 offen offset:1024 sc1
    v_mfma_f32_32x32x16_bf16 v[32:47], v[168:171], v[252:255], v[32:47]
    ds_read_b128 v[72:75], v122 offset:64
    ds_read_b128 v[88:91], v122 offset:192
    ds_read_b128 v[76:79], v122 offset:96
    ds_read_b128 v[92:95], v122 offset:224
    ds_read_b128 v[248:251], v5 offset:0
    ds_read_b128 v[252:255], v5 offset:28672
    s_waitcnt vmcnt(11) lgkmcnt(6)
    v_mfma_f32_32x32x16_bf16 v[16:31], v[240:243], v[172:175], v[16:31]
    buffer_load_dwordx4 v[220:223], v1, s[8:11], s37 offen offset:2048 sc1
    v_bitop3_b32 v120, v120, v172, v168 bitop3:0x80
    v_mfma_f32_32x32x16_bf16 v[32:47], v[172:175], v[244:247], v[32:47]
    ds_read_b128 v[240:243], v5 offset:1024
    ds_read_b128 v[244:247], v5 offset:29696
    s_waitcnt vmcnt(11) lgkmcnt(6)
    v_mfma_f32_32x32x16_bf16 v[16:31], v[96:99], v[176:179], v[16:31]
    buffer_load_dwordx4 v[224:227], v1, s[8:11], s37 offen offset:3072 sc1
    v_mfma_f32_32x32x16_bf16 v[32:47], v[176:179], v[100:103], v[32:47]
    ds_read_b128 v[96:99], v5 offset:2048
    ds_read_b128 v[100:103], v5 offset:30720
    s_waitcnt vmcnt(11) lgkmcnt(6)
    v_mfma_f32_32x32x16_bf16 v[16:31], v[104:107], v[180:183], v[16:31]
    s_add_u32 s38, s37, 4096
    buffer_load_dwordx4 v[228:231], v1, s[8:11], s38 offen offset:0 sc1
    v_bitop3_b32 v120, v120, v180, v176 bitop3:0x80
    v_mfma_f32_32x32x16_bf16 v[32:47], v[180:183], v[108:111], v[32:47]
    ds_read_b128 v[104:107], v5 offset:3072
    ds_read_b128 v[108:111], v5 offset:31744
    s_waitcnt vmcnt(11) lgkmcnt(6)
    v_mfma_f32_32x32x16_bf16 v[16:31], v[248:251], v[184:187], v[16:31]
    buffer_load_dwordx4 v[232:235], v1, s[8:11], s38 offen offset:1024 sc1
    v_mfma_f32_32x32x16_bf16 v[32:47], v[184:187], v[252:255], v[32:47]
    v_accvgpr_read_b32 v12, a253
    ds_write_b32 v121, v12 offset:1024
    v_mov_b32 v126, v12
    s_nop 1
    v_permlane32_swap_b32 v12, v126
    ds_read_b128 v[248:251], v5 offset:4096
    ds_read_b128 v[252:255], v5 offset:32768
    s_waitcnt vmcnt(11) lgkmcnt(6)
    v_mfma_f32_32x32x16_bf16 v[16:31], v[240:243], v[188:191], v[16:31]
    buffer_load_dwordx4 v[236:239], v1, s[8:11], s38 offen offset:2048 sc1
    v_bitop3_b32 v120, v120, v188, v184 bitop3:0x80
    v_mfma_f32_32x32x16_bf16 v[32:47], v[188:191], v[244:247], v[32:47]
    ds_read_b128 v[48:51], v122 offset:1024
    ds_read_b128 v[52:55], v122 offset:1056
    ds_read_b128 v[56:59], v122 offset:1088
    ds_read_b128 v[60:63], v122 offset:1120
    ds_read_b128 v[240:243], v5 offset:5120
    ds_read_b128 v[244:247], v5 offset:33792
    s_waitcnt vmcnt(11) lgkmcnt(6)
    v_mfma_f32_32x32x16_bf16 v[16:31], v[96:99], v[192:195], v[16:31]
    s_add_u32 s40, s0, 57344
    s_add_u32 m0, s56, 57344
    s_nop 0
    buffer_load_dwordx4 v1, s[8:11], s40 offen sc1 lds
    v_mfma_f32_32x32x16_bf16 v[32:47], v[192:195], v[100:103], v[32:47]
    ds_read_b128 v[96:99], v5 offset:6144
    ds_read_b128 v[100:103], v5 offset:34816
    s_waitcnt vmcnt(11) lgkmcnt(6)
    v_mfma_f32_32x32x16_bf16 v[16:31], v[104:107], v[196:199], v[16:31]
    v_bitop3_b32 v120, v120, v196, v192 bitop3:0x80
    v_mfma_f32_32x32x16_bf16 v[32:47], v[196:199], v[108:111], v[32:47]
    ds_read_b128 v[104:107], v6 offset:0
    ds_read_b128 v[108:111], v6 offset:28672
    s_waitcnt vmcnt(10) lgkmcnt(6)
    v_mfma_f32_32x32x16_bf16 v[16:31], v[248:251], v[200:203], v[16:31]
    s_add_u32 s40, s0, 58368
    s_add_u32 m0, s56, 58368
    s_nop 0
    buffer_load_dwordx4 v1, s[8:11], s40 offen sc1 lds
    v_mfma_f32_32x32x16_bf16 v[32:47], v[200:203], v[252:255], v[32:47]
    ds_read_b128 v[248:251], v6 offset:1024
    ds_read_b128 v[252:255], v6 offset:29696
    s_waitcnt vmcnt(10) lgkmcnt(6)
    v_mfma_f32_32x32x16_bf16 v[16:31], v[240:243], v[204:207], v[16:31]
    v_bitop3_b32 v120, v120, v204, v200 bitop3:0x80
    v_mfma_f32_32x32x16_bf16 v[32:47], v[204:207], v[244:247], v[32:47]
    v_mul_f32 v80, v80, v126
    v_mul_f32 v48, v48, v118
    v_mul_f32 v81, v81, v126
    v_mul_f32 v49, v49, v118
    ds_read_b128 v[240:243], v6 offset:2048
    ds_read_b128 v[244:247], v6 offset:30720
    s_waitcnt vmcnt(9) lgkmcnt(6)
    v_mfma_f32_32x32x16_bf16 v[16:31], v[96:99], v[208:211], v[16:31]
    s_add_u32 s40, s0, 59392
    s_add_u32 m0, s56, 59392
    s_nop 0
    buffer_load_dwordx4 v1, s[8:11], s40 offen sc1 lds
    v_mfma_f32_32x32x16_bf16 v[32:47], v[208:211], v[100:103], v[32:47]
    v_mul_f32 v82, v82, v126
    v_mul_f32 v50, v50, v118
    v_mul_f32 v83, v83, v126
    v_mul_f32 v51, v51, v118
    ds_read_b128 v[96:99], v6 offset:3072
    ds_read_b128 v[100:103], v6 offset:31744
    s_waitcnt vmcnt(9) lgkmcnt(6)
    v_mfma_f32_32x32x16_bf16 v[16:31], v[104:107], v[212:215], v[16:31]
    v_bitop3_b32 v120, v120, v212, v208 bitop3:0x80
    v_mfma_f32_32x32x16_bf16 v[32:47], v[212:215], v[108:111], v[32:47]
    v_mul_f32 v84, v84, v126
    v_mul_f32 v52, v52, v118
    v_mul_f32 v85, v85, v126
    v_mul_f32 v53, v53, v118
    ds_read_b128 v[104:107], v6 offset:4096
    ds_read_b128 v[108:111], v6 offset:32768
    s_waitcnt vmcnt(8) lgkmcnt(6)
    v_mfma_f32_32x32x16_bf16 v[16:31], v[248:251], v[216:219], v[16:31]
    s_add_u32 s40, s0, 60416
    s_add_u32 m0, s56, 60416
    s_nop 0
    buffer_load_dwordx4 v1, s[8:11], s40 offen sc1 lds
    v_mfma_f32_32x32x16_bf16 v[32:47], v[216:219], v[252:255], v[32:47]
    v_mul_f32 v86, v86, v126
    v_mul_f32 v54, v54, v118
    v_mul_f32 v87, v87, v126
    v_mul_f32 v55, v55, v118
    ds_read_b128 v[248:251], v6 offset:5120
    ds_read_b128 v[252:255], v6 offset:33792
    s_waitcnt vmcnt(8) lgkmcnt(6)
    v_mfma_f32_32x32x16_bf16 v[16:31], v[240:243], v[220:223], v[16:31]
    v_bitop3_b32 v120, v120, v220, v216 bitop3:0x80
    v_mfma_f32_32x32x16_bf16 v[32:47], v[220:223], v[244:247], v[32:47]
    v_mul_f32 v88, v88, v126
    v_mul_f32 v56, v56, v118
    v_mul_f32 v89, v89, v126
    v_mul_f32 v57, v57, v118
    ds_read_b128 v[240:243], v6 offset:6144
    ds_read_b128 v[244:247], v6 offset:34816
    s_waitcnt vmcnt(7) lgkmcnt(6)
    v_mfma_f32_32x32x16_bf16 v[16:31], v[96:99], v[224:227], v[16:31]
    s_add_u32 s40, s0, 61440
    s_add_u32 m0, s56, 61440
    s_nop 0
    buffer_load_dwordx4 v1, s[8:11], s40 offen sc1 lds
    v_mfma_f32_32x32x16_bf16 v[32:47], v[224:227], v[100:103], v[32:47]
    v_mul_f32 v90, v90, v126
    v_mul_f32 v58, v58, v118
    v_mul_f32 v91, v91, v126
    v_mul_f32 v59, v59, v118
    s_waitcnt vmcnt(7) lgkmcnt(4)
    v_mfma_f32_32x32x16_bf16 v[16:31], v[104:107], v[228:231], v[16:31]
    v_bitop3_b32 v120, v120, v228, v224 bitop3:0x80
    v_mfma_f32_32x32x16_bf16 v[32:47], v[228:231], v[108:111], v[32:47]
    v_mul_f32 v92, v92, v126
    v_mul_f32 v60, v60, v118
    v_mul_f32 v93, v93, v126
    v_mul_f32 v61, v61, v118
    s_waitcnt vmcnt(6) lgkmcnt(2)
    v_mfma_f32_32x32x16_bf16 v[16:31], v[248:251], v[232:235], v[16:31]
    s_add_u32 s40, s0, 62464
    s_add_u32 m0, s56, 62464
    s_nop 0
    buffer_load_dwordx4 v1, s[8:11], s40 offen sc1 lds
    v_mfma_f32_32x32x16_bf16 v[32:47], v[232:235], v[252:255], v[32:47]
    v_mul_f32 v94, v94, v126
    v_mul_f32 v62, v62, v118
    v_mul_f32 v95, v95, v126
    v_mul_f32 v63, v63, v118
    s_waitcnt vmcnt(6) lgkmcnt(0)
    v_mfma_f32_32x32x16_bf16 v[16:31], v[240:243], v[236:239], v[16:31]
    s_add_u32 s40, s0, 63488
    s_add_u32 m0, s56, 63488
    s_nop 0
    buffer_load_dwordx4 v1, s[8:11], s40 offen sc1 lds
    v_bitop3_b32 v120, v120, v236, v232 bitop3:0x80
    v_and_b32 v120, 1, v120
    v_cmp_ne_u32 vcc, 1, v120
    v_mfma_f32_32x32x16_bf16 v[32:47], v[236:239], v[244:247], v[32:47]
    s_cbranch_vccnz L_a1_slow
L_a1_ok:
    s_nop 2
    v_pk_fma_f32 v[16:17], v[16:17], v[116:117], v[48:49] op_sel_hi:[1,0,1]
    v_pk_fma_f32 v[18:19], v[18:19], v[116:117], v[50:51] op_sel_hi:[1,0,1]
    v_pk_fma_f32 v[20:21], v[20:21], v[116:117], v[52:53] op_sel_hi:[1,0,1]
    v_pk_fma_f32 v[22:23], v[22:23], v[116:117], v[54:55] op_sel_hi:[1,0,1]
    v_pk_fma_f32 v[24:25], v[24:25], v[116:117], v[56:57] op_sel_hi:[1,0,1]
    v_pk_fma_f32 v[26:27], v[26:27], v[116:117], v[58:59] op_sel_hi:[1,0,1]
    v_pk_fma_f32 v[28:29], v[28:29], v[116:117], v[60:61] op_sel_hi:[1,0,1]
    v_pk_fma_f32 v[30:31], v[30:31], v[116:117], v[62:63] op_sel_hi:[1,0,1]
    v_cvt_pk_bf16_f32 v96, v16, v17
    v_cvt_pk_bf16_f32 v97, v18, v19
    v_cvt_pk_bf16_f32 v98, v20, v21
    v_cvt_pk_bf16_f32 v99, v22, v23
    v_cvt_pk_bf16_f32 v100, v24, v25
    v_cvt_pk_bf16_f32 v101, v26, v27
    v_cvt_pk_bf16_f32 v102, v28, v29
    v_cvt_pk_bf16_f32 v103, v30, v31
    v_mfma_f32_32x32x16_bf16 v[48:63], a[232:235], v[96:99], 0
    s_nop 0
    v_mfma_f32_32x32x16_bf16 v[48:63], a[236:239], v[100:103], v[48:63]
    v_pk_fma_f32 v[32:33], v[32:33], v[64:65], v[80:81]
    v_pk_fma_f32 v[34:35], v[34:35], v[66:67], v[82:83]
    v_pk_fma_f32 v[36:37], v[36:37], v[68:69], v[84:85]
    v_pk_fma_f32 v[38:39], v[38:39], v[70:71], v[86:87]
    v_pk_fma_f32 v[40:41], v[40:41], v[72:73], v[88:89]
    v_pk_fma_f32 v[42:43], v[42:43], v[74:75], v[90:91]
    v_pk_fma_f32 v[44:45], v[44:45], v[76:77], v[92:93]
    v_pk_fma_f32 v[46:47], v[46:47], v[78:79], v[94:95]
    v_cvt_pk_bf16_f32 v72, v32, v33
    v_cvt_pk_bf16_f32 v73, v34, v35
    v_cvt_pk_bf16_f32 v74, v36, v37
    v_cvt_pk_bf16_f32 v75, v38, v39
    v_cvt_pk_bf16_f32 v76, v40, v41
    v_cvt_pk_bf16_f32 v77, v42, v43
    v_cvt_pk_bf16_f32 v78, v44, v45
    v_cvt_pk_bf16_f32 v79, v46, v47
    v_cndmask_b32 v12, 0, v112, s[48:49]
    v_mov_b32 v13, v12
    s_mov_b64 exec, s[46:47]
    v_mov_b64 v[72:73], v[12:13]
    v_mov_b64 v[74:75], v[12:13]
    v_mov_b64 v[76:77], v[12:13]
    v_mov_b64 v[78:79], v[12:13]
    s_mov_b64 exec, -1
    ds_write_b128 v117, v[72:75]
    ds_write_b128 v117, v[76:79] offset:1024
    s_add_u32 s28, s89, 8536064
    v_mov_b32 v92, s61
    v_max_f32 v88, v48, v49
    v_min_f32 v90, v48, v49
    v_max3_f32 v88, v88, v50, v51
    v_min3_f32 v90, v90, v50, v51
    v_max3_f32 v88, v88, v52, v53
    v_min3_f32 v90, v90, v52, v53
    v_max3_f32 v88, v88, v54, v55
    v_min3_f32 v90, v90, v54, v55
    v_max3_f32 v88, v88, v56, v57
    v_min3_f32 v90, v90, v56, v57
    v_max3_f32 v88, v88, v58, v59
    v_min3_f32 v90, v90, v58, v59
    s_mov_b32 exec_hi, 0
    v_max3_f32 v88, v88, v60, v61
    v_min3_f32 v90, v90, v60, v61
    v_max3_f32 v88, v88, v62, v63
    v_min3_f32 v90, v90, v62, v63
    s_mov_b64 exec, -1
    v_mov_b32 v89, v88
    v_mov_b32 v91, v90
    s_add_u32 s40, s84, 11812864
    buffer_store_dwordx4 a[248:251], v1, s[8:11], s40 offen offset:0 sc1
    v_permlane32_swap_b32 v88, v89
    v_permlane32_swap_b32 v90, v91
    v_max_f32 v88, v88, v89
    v_min_f32 v90, v90, v91
    v_mul_f32 v88, s61, v88
    v_mul_f32 v90, s61, v90
    v_pk_fma_f32 v[16:17], v[48:49], v[92:93], v[90:91] op_sel_hi:[1,0,0] neg_lo:[1,0,0] neg_hi:[1,0,0]
    v_pk_fma_f32 v[48:49], v[48:49], v[92:93], v[88:89] op_sel_hi:[1,0,0] neg_lo:[0,0,1] neg_hi:[0,0,1]
    v_pk_fma_f32 v[18:19], v[50:51], v[92:93], v[90:91] op_sel_hi:[1,0,0] neg_lo:[1,0,0] neg_hi:[1,0,0]
    v_pk_fma_f32 v[50:51], v[50:51], v[92:93], v[88:89] op_sel_hi:[1,0,0] neg_lo:[0,0,1] neg_hi:[0,0,1]
    v_pk_fma_f32 v[20:21], v[52:53], v[92:93], v[90:91] op_sel_hi:[1,0,0] neg_lo:[1,0,0] neg_hi:[1,0,0]
    v_pk_fma_f32 v[52:53], v[52:53], v[92:93], v[88:89] op_sel_hi:[1,0,0] neg_lo:[0,0,1] neg_hi:[0,0,1]
    v_pk_fma_f32 v[22:23], v[54:55], v[92:93], v[90:91] op_sel_hi:[1,0,0] neg_lo:[1,0,0] neg_hi:[1,0,0]
    v_pk_fma_f32 v[54:55], v[54:55], v[92:93], v[88:89] op_sel_hi:[1,0,0] neg_lo:[0,0,1] neg_hi:[0,0,1]
    v_pk_fma_f32 v[24:25], v[56:57], v[92:93], v[90:91] op_sel_hi:[1,0,0] neg_lo:[1,0,0] neg_hi:[1,0,0]
    v_pk_fma_f32 v[56:57], v[56:57], v[92:93], v[88:89] op_sel_hi:[1,0,0] neg_lo:[0,0,1] neg_hi:[0,0,1]
    v_pk_fma_f32 v[26:27], v[58:59], v[92:93], v[90:91] op_sel_hi:[1,0,0] neg_lo:[1,0,0] neg_hi:[1,0,0]
    v_pk_fma_f32 v[58:59], v[58:59], v[92:93], v[88:89] op_sel_hi:[1,0,0] neg_lo:[0,0,1] neg_hi:[0,0,1]
    v_pk_fma_f32 v[28:29], v[60:61], v[92:93], v[90:91] op_sel_hi:[1,0,0] neg_lo:[1,0,0] neg_hi:[1,0,0]
    v_pk_fma_f32 v[60:61], v[60:61], v[92:93], v[88:89] op_sel_hi:[1,0,0] neg_lo:[0,0,1] neg_hi:[0,0,1]
    v_pk_fma_f32 v[30:31], v[62:63], v[92:93], v[90:91] op_sel_hi:[1,0,0] neg_lo:[1,0,0] neg_hi:[1,0,0]
    v_pk_fma_f32 v[62:63], v[62:63], v[92:93], v[88:89] op_sel_hi:[1,0,0] neg_lo:[0,0,1] neg_hi:[0,0,1]
    s_add_u32 s40, s84, 11812864
    buffer_store_dwordx4 a[248:251], v1, s[8:11], s40 offen offset:1024 sc1
    v_exp_f32 v48, v48
    v_exp_f32 v16, v16
    v_exp_f32 v49, v49
    v_exp_f32 v17, v17
    v_exp_f32 v50, v50
    v_exp_f32 v18, v18
    v_exp_f32 v51, v51
    v_exp_f32 v19, v19
    s_add_u32 s40, s84, 16007168
    buffer_store_dwordx4 a[248:251], v1, s[8:11], s40 offen offset:0 sc1
    v_exp_f32 v52, v52
    v_exp_f32 v20, v20
    v_exp_f32 v53, v53
    v_exp_f32 v21, v21
    v_exp_f32 v54, v54
    v_exp_f32 v22, v22
    v_exp_f32 v55, v55
    v_exp_f32 v23, v23
    s_add_u32 s40, s84, 16007168
    buffer_store_dwordx4 a[248:251], v1, s[8:11], s40 offen offset:1024 sc1
    v_exp_f32 v56, v56
    v_exp_f32 v24, v24
    v_exp_f32 v57, v57
    v_exp_f32 v25, v25
    v_exp_f32 v58, v58
    v_exp_f32 v26, v26
    v_exp_f32 v59, v59
    v_exp_f32 v27, v27
    v_exp_f32 v60, v60
    v_exp_f32 v28, v28
    v_exp_f32 v61, v61
    v_exp_f32 v29, v29
    v_exp_f32 v62, v62
    v_exp_f32 v30, v30
    v_exp_f32 v63, v63
    v_exp_f32 v31, v31
    v_pk_add_f32 v[92:93], v[48:49], v[50:51]
    v_pk_add_f32 v[94:95], v[16:17], v[18:19]
    v_pk_add_f32 v[92:93], v[92:93], v[52:53]
    v_pk_add_f32 v[94:95], v[94:95], v[20:21]
    v_pk_add_f32 v[92:93], v[92:93], v[54:55]
    v_pk_add_f32 v[94:95], v[94:95], v[22:23]
    v_pk_add_f32 v[92:93], v[92:93], v[56:57]
    v_pk_add_f32 v[94:95], v[94:95], v[24:25]
    v_pk_add_f32 v[92:93], v[92:93], v[58:59]
    v_pk_add_f32 v[94:95], v[94:95], v[26:27]
    s_mov_b32 exec_hi, 0
    v_pk_add_f32 v[92:93], v[92:93], v[60:61]
    v_pk_add_f32 v[94:95], v[94:95], v[28:29]
    v_pk_add_f32 v[92:93], v[92:93], v[62:63]
    v_pk_add_f32 v[94:95], v[94:95], v[30:31]
    s_mov_b64 exec, -1
    v_add_f32 v92, v92, v93
    v_add_f32 v94, v94, v95
    v_mov_b32 v93, v92
    v_mov_b32 v95, v94
    s_nop 0
    v_permlane32_swap_b32 v92, v93
    v_permlane32_swap_b32 v94, v95
    v_add_f32 v92, v92, v93
    v_add_f32 v94, v94, v95
    v_rcp_f32 v92, v92
    v_rcp_f32 v94, v94
    v_pk_mul_f32 v[48:49], v[48:49], v[92:93] op_sel_hi:[1,0]
    v_pk_mul_f32 v[50:51], v[50:51], v[92:93] op_sel_hi:[1,0]
    v_pk_mul_f32 v[52:53], v[52:53], v[92:93] op_sel_hi:[1,0]
    v_pk_mul_f32 v[54:55], v[54:55], v[92:93] op_sel_hi:[1,0]
    v_pk_mul_f32 v[56:57], v[56:57], v[92:93] op_sel_hi:[1,0]
    v_pk_mul_f32 v[58:59], v[58:59], v[92:93] op_sel_hi:[1,0]
    v_pk_mul_f32 v[60:61], v[60:61], v[92:93] op_sel_hi:[1,0]
    v_pk_mul_f32 v[62:63], v[62:63], v[92:93] op_sel_hi:[1,0]
    v_cvt_pk_bf16_f32 v96, v48, v49
    v_cvt_pk_bf16_f32 v97, v50, v51
    v_cvt_pk_bf16_f32 v98, v52, v53
    v_cvt_pk_bf16_f32 v99, v54, v55
    v_cvt_pk_bf16_f32 v100, v56, v57
    v_cvt_pk_bf16_f32 v101, v58, v59
    v_cvt_pk_bf16_f32 v102, v60, v61
    v_cvt_pk_bf16_f32 v103, v62, v63
    v_cndmask_b32 v102, v102, 0, s[44:45]
    v_cndmask_b32 v103, v103, 0, s[44:45]
    ds_write_b64 v119, v[96:97] offset:0
    ds_write_b64 v119, v[98:99] offset:16
    ds_write_b64 v119, v[100:101] offset:32
    ds_write_b64 v119, v[102:103] offset:48
    v_pk_mul_f32 v[16:17], v[16:17], v[94:95] op_sel_hi:[1,0]
    v_pk_mul_f32 v[18:19], v[18:19], v[94:95] op_sel_hi:[1,0]
    v_pk_mul_f32 v[20:21], v[20:21], v[94:95] op_sel_hi:[1,0]
    v_pk_mul_f32 v[22:23], v[22:23], v[94:95] op_sel_hi:[1,0]
    v_pk_mul_f32 v[24:25], v[24:25], v[94:95] op_sel_hi:[1,0]
    v_pk_mul_f32 v[26:27], v[26:27], v[94:95] op_sel_hi:[1,0]
    v_pk_mul_f32 v[28:29], v[28:29], v[94:95] op_sel_hi:[1,0]
    v_pk_mul_f32 v[30:31], v[30:31], v[94:95] op_sel_hi:[1,0]
    v_cvt_pk_bf16_f32 v104, v16, v17
    v_cvt_pk_bf16_f32 v105, v18, v19
    v_cvt_pk_bf16_f32 v106, v20, v21
    v_cvt_pk_bf16_f32 v107, v22, v23
    v_cvt_pk_bf16_f32 v108, v24, v25
    v_cvt_pk_bf16_f32 v109, v26, v27
    v_cvt_pk_bf16_f32 v110, v28, v29
    v_cvt_pk_bf16_f32 v111, v30, v31
    v_cndmask_b32 v110, v110, 0, s[44:45]
    v_cndmask_b32 v111, v111, 0, s[44:45]
    ds_write_b64 v119, v[104:105] offset:64
    ds_write_b64 v119, v[106:107] offset:80
    ds_write_b64 v119, v[108:109] offset:96
    ds_write_b64 v119, v[110:111] offset:112
    s_waitcnt vmcnt(4) lgkmcnt(0)
    s_barrier
    ds_read_b64_tr_b16 v[16:17], v125 offset:0
    ds_read_b64_tr_b16 v[18:19], v125 offset:1088
    ds_read_b128 v[32:35], v127 offset:0
    ds_read_b128 v[36:39], v127 offset:256
    ds_read_b64_tr_b16 v[20:21], v125 offset:4352
    ds_read_b64_tr_b16 v[22:23], v125 offset:5440
    ds_read_b128 v[40:43], v127 offset:2048
    ds_read_b128 v[44:47], v127 offset:2304
    ds_read_b64_tr_b16 v[24:25], v125 offset:8704
    ds_read_b64_tr_b16 v[26:27], v125 offset:9792
    ds_read_b128 v[48:51], v127 offset:4096
    ds_read_b128 v[52:55], v127 offset:4352
    ds_read_b64_tr_b16 v[28:29], v125 offset:13056
    ds_read_b64_tr_b16 v[30:31], v125 offset:14144
    ds_read_b128 v[56:59], v127 offset:6144
    s_waitcnt lgkmcnt(12)
    ds_read_b128 v[60:63], v127 offset:6400
    s_waitcnt lgkmcnt(12)
    v_mfma_f32_16x16x32_bf16 v[72:75], v[16:19], v[32:35], 0
    v_mfma_f32_16x16x32_bf16 v[76:79], v[16:19], v[36:39], 0
    s_waitcnt lgkmcnt(8)
    v_mfma_f32_16x16x32_bf16 v[72:75], v[20:23], v[40:43], v[72:75]
    v_mfma_f32_16x16x32_bf16 v[76:79], v[20:23], v[44:47], v[76:79]
    s_waitcnt lgkmcnt(4)
    v_mfma_f32_16x16x32_bf16 v[72:75], v[24:27], v[48:51], v[72:75]
    v_mfma_f32_16x16x32_bf16 v[76:79], v[24:27], v[52:55], v[76:79]
    s_waitcnt lgkmcnt(0)
    v_mfma_f32_16x16x32_bf16 v[72:75], v[28:31], v[56:59], v[72:75]
    v_mfma_f32_16x16x32_bf16 v[76:79], v[28:31], v[60:63], v[76:79]
    s_nop 6
    v_cvt_pk_bf16_f32 v72, v72, v73
    v_cvt_pk_bf16_f32 v73, v74, v75
    v_cvt_pk_bf16_f32 v74, v76, v77
    v_cvt_pk_bf16_f32 v75, v78, v79
    buffer_store_dwordx4 v[72:75], v9, s[8:11], s28 offen sc1
    s_add_u32 s32, s90, 8536064
    ds_read_b128 v[88:91], v3 offset:57344
    ds_read_b128 v[92:95], v3 offset:58368
    ds_read_b128 v[96:99], v3 offset:59392
    ds_read_b128 v[100:103], v3 offset:60416
    ds_read_b128 v[104:107], v3 offset:61440
    ds_read_b128 v[108:111], v3 offset:62464
    s_waitcnt lgkmcnt(5)
    v_mfma_f32_32x32x16_bf16 v[48:63], v[88:91], v[128:131], 0
    ds_read_b128 v[88:91], v3 offset:63488
    s_waitcnt lgkmcnt(5)
    v_mfma_f32_32x32x16_bf16 v[48:63], v[92:95], v[132:135], v[48:63]
    ds_read_b128 v[92:95], v4 offset:57344
    s_waitcnt lgkmcnt(5)
    v_mfma_f32_32x32x16_bf16 v[48:63], v[96:99], v[136:139], v[48:63]
    ds_read_b128 v[96:99], v4 offset:58368
    s_waitcnt lgkmcnt(5)
    v_mfma_f32_32x32x16_bf16 v[48:63], v[100:103], v[140:143], v[48:63]
    ds_read_b128 v[100:103], v4 offset:59392
    s_waitcnt lgkmcnt(5)
    v_mfma_f32_32x32x16_bf16 v[48:63], v[104:107], v[144:147], v[48:63]
    ds_read_b128 v[104:107], v4 offset:60416
    s_waitcnt lgkmcnt(5)
    v_mfma_f32_32x32x16_bf16 v[48:63], v[108:111], v[148:151], v[48:63]
    ds_read_b128 v[108:111], v4 offset:61440
    s_waitcnt lgkmcnt(5)
    v_mfma_f32_32x32x16_bf16 v[48:63], v[88:91], v[152:155], v[48:63]
    ds_read_b128 v[88:91], v4 offset:62464
    s_waitcnt lgkmcnt(5)
    v_mfma_f32_32x32x16_bf16 v[48:63], v[92:95], v[156:159], v[48:63]
    ds_read_b128 v[92:95], v4 offset:63488
    s_waitcnt lgkmcnt(5)
    v_mfma_f32_32x32x16_bf16 v[48:63], v[96:99], v[160:163], v[48:63]
    ds_read_b128 v[96:99], v5 offset:57344
    s_waitcnt lgkmcnt(5)
    v_mfma_f32_32x32x16_bf16 v[48:63], v[100:103], v[164:167], v[48:63]
    ds_read_b128 v[100:103], v5 offset:58368
    s_waitcnt lgkmcnt(5)
    v_mfma_f32_32x32x16_bf16 v[48:63], v[104:107], v[168:171], v[48:63]
    ds_read_b128 v[104:107], v5 offset:59392
    s_waitcnt lgkmcnt(5)
    v_mfma_f32_32x32x16_bf16 v[48:63], v[108:111], v[172:175], v[48:63]
    ds_read_b128 v[108:111], v5 offset:60416
    s_waitcnt lgkmcnt(5)
    v_mfma_f32_32x32x16_bf16 v[48:63], v[88:91], v[176:179], v[48:63]
    ds_read_b128 v[88:91], v5 offset:61440
    s_waitcnt lgkmcnt(5)
    v_mfma_f32_32x32x16_bf16 v[48:63], v[92:95], v[180:183], v[48:63]
    ds_read_b128 v[92:95], v5 offset:62464
    s_waitcnt lgkmcnt(5)
    v_mfma_f32_32x32x16_bf16 v[48:63], v[96:99], v[184:187], v[48:63]
    ds_read_b128 v[96:99], v5 offset:63488
    s_waitcnt lgkmcnt(5)
    v_mfma_f32_32x32x16_bf16 v[48:63], v[100:103], v[188:191], v[48:63]
    ds_read_b128 v[100:103], v6 offset:57344
    s_waitcnt lgkmcnt(5)
    v_mfma_f32_32x32x16_bf16 v[48:63], v[104:107], v[192:195], v[48:63]
    ds_read_b128 v[104:107], v6 offset:58368
    s_waitcnt lgkmcnt(5)
    v_mfma_f32_32x32x16_bf16 v[48:63], v[108:111], v[196:199], v[48:63]
    v_accvgpr_read_b32 v12, a255
    ds_write_b32 v121, v12 offset:1024
    ds_read_b128 v[16:19], v122 offset:1024
    ds_read_b128 v[20:23], v122 offset:1056
    ds_read_b128 v[24:27], v122 offset:1088
    ds_read_b128 v[28:31], v122 offset:1120
    ds_read_b128 v[108:111], v6 offset:59392
    s_waitcnt lgkmcnt(5)
    v_mfma_f32_32x32x16_bf16 v[48:63], v[88:91], v[200:203], v[48:63]
    ds_read_b128 v[88:91], v6 offset:60416
    s_waitcnt lgkmcnt(5)
    v_mfma_f32_32x32x16_bf16 v[48:63], v[92:95], v[204:207], v[48:63]
    ds_read_b128 v[92:95], v6 offset:61440
    s_waitcnt lgkmcnt(5)
    v_mfma_f32_32x32x16_bf16 v[48:63], v[96:99], v[208:211], v[48:63]
    ds_read_b128 v[96:99], v6 offset:62464
    s_waitcnt lgkmcnt(5)
    v_mfma_f32_32x32x16_bf16 v[48:63], v[100:103], v[212:215], v[48:63]
    ds_read_b128 v[100:103], v6 offset:63488
    s_waitcnt lgkmcnt(5)
    v_mfma_f32_32x32x16_bf16 v[48:63], v[104:107], v[216:219], v[48:63]
    buffer_load_dword v64, v10, s[8:11], s32 offen offset:0 sc1
    buffer_load_dword v65, v10, s[8:11], s32 offen offset:1024 sc1
    buffer_load_dword v66, v10, s[8:11], s32 offen offset:2048 sc1
    buffer_load_dword v67, v10, s[8:11], s32 offen offset:3072 sc1
    s_waitcnt lgkmcnt(4)
    v_mfma_f32_32x32x16_bf16 v[48:63], v[108:111], v[220:223], v[48:63]
    s_waitcnt lgkmcnt(3)
    v_mfma_f32_32x32x16_bf16 v[48:63], v[88:91], v[224:227], v[48:63]
    v_mul_f32 v16, v16, v118
    v_mul_f32 v17, v17, v118
    v_mul_f32 v18, v18, v118
    v_mul_f32 v19, v19, v118
    s_add_u32 s40, s0, 1376256
    s_add_u32 m0, s56, 0
    s_nop 0
    buffer_load_dwordx4 v1, s[8:11], s40 offen sc1 lds
    s_waitcnt lgkmcnt(2)
    v_mfma_f32_32x32x16_bf16 v[48:63], v[92:95], v[228:231], v[48:63]
    v_mul_f32 v20, v20, v118
    v_mul_f32 v21, v21, v118
    v_mul_f32 v22, v22, v118
    v_mul_f32 v23, v23, v118
    s_waitcnt lgkmcnt(1)
    v_mfma_f32_32x32x16_bf16 v[48:63], v[96:99], v[232:235], v[48:63]
    v_mul_f32 v24, v24, v118
    v_mul_f32 v25, v25, v118
    v_mul_f32 v26, v26, v118
    v_mul_f32 v27, v27, v118
    s_add_u32 s40, s0, 1377280
    s_add_u32 m0, s56, 1024
    s_nop 0
    buffer_load_dwordx4 v1, s[8:11], s40 offen sc1 lds
    s_waitcnt lgkmcnt(0)
    v_mfma_f32_32x32x16_bf16 v[48:63], v[100:103], v[236:239], v[48:63]
    v_mul_f32 v28, v28, v118
    v_mul_f32 v29, v29, v118
    v_mul_f32 v30, v30, v118
    v_mul_f32 v31, v31, v118
    s_add_u32 s40, s0, 1378304
    s_add_u32 m0, s56, 2048
    s_nop 0
    buffer_load_dwordx4 v1, s[8:11], s40 offen sc1 lds
    s_add_u32 s40, s0, 1379328
    s_add_u32 m0, s56, 3072
    s_nop 0
    buffer_load_dwordx4 v1, s[8:11], s40 offen sc1 lds
    s_add_u32 s40, s0, 1380352
    s_add_u32 m0, s56, 4096
    s_nop 0
    buffer_load_dwordx4 v1, s[8:11], s40 offen sc1 lds
    s_add_u32 s40, s0, 1381376
    s_add_u32 m0, s56, 5120
    s_nop 0
    buffer_load_dwordx4 v1, s[8:11], s40 offen sc1 lds
    s_add_u32 s40, s0, 1382400
    s_add_u32 m0, s56, 6144
    s_nop 0
    buffer_load_dwordx4 v1, s[8:11], s40 offen sc1 lds
    v_lshrrev_b32 v70, 4, v2
    v_and_b32 v71, 0x3c, v10
    v_lshl_add_u32 v70, v70, 16, v71
    s_branch gk_50
gl_51:
    s_sleep 2
    buffer_load_dword v64, v10, s[8:11], s32 offen offset:0 sc1
    buffer_load_dword v65, v10, s[8:11], s32 offen offset:1024 sc1
    buffer_load_dword v66, v10, s[8:11], s32 offen offset:2048 sc1
    buffer_load_dword v67, v10, s[8:11], s32 offen offset:3072 sc1
    s_add_u32 s60, s60, 1
    s_cmp_gt_u32 s60, 100000
    s_cbranch_scc1 L_exit
    s_waitcnt vmcnt(0)
gk_50:
    s_waitcnt vmcnt(7)
    v_max3_u32 v120, v64, v65, v66
    v_max_u32 v120, v120, v67
    v_cmp_eq_u32 vcc, -1, v120
    s_nop 0
    s_cbranch_vccnz gl_51
    v_lshlrev_b32 v72, 16, v64
    v_and_b32 v73, 0xffff0000, v64
    v_lshlrev_b32 v74, 16, v65
    v_and_b32 v75, 0xffff0000, v65
    v_lshlrev_b32 v76, 16, v66
    v_and_b32 v77, 0xffff0000, v66
    v_lshlrev_b32 v78, 16, v67
    v_and_b32 v79, 0xffff0000, v67
    v_pk_add_f32 v[72:73], v[72:73], v[74:75]
    v_pk_add_f32 v[76:77], v[76:77], v[78:79]
    v_pk_add_f32 v[72:73], v[72:73], v[76:77]
    v_mov_b64 v[74:75], v[72:73]
    s_nop 1
    v_permlane16_swap_b32 v72, v74
    v_permlane16_swap_b32 v73, v75
    v_pk_add_f32 v[72:73], v[72:73], v[74:75]
    v_mov_b64 v[74:75], v[72:73]
    s_nop 1
    v_permlane32_swap_b32 v72, v74
    v_permlane32_swap_b32 v73, v75
    v_pk_add_f32 v[72:73], v[72:73], v[74:75]
    v_cvt_pk_bf16_f32 v72, v72, v73
    s_add_u32 s28, s92, 9650176
    s_mov_b64 exec, 0xffff
    buffer_store_dword v72, v10, s[8:11], s28 offen sc1
    s_mov_b64 exec, -1
    v_pk_fma_f32 v[48:49], v[48:49], v[116:117], v[16:17] op_sel_hi:[1,0,1]
    v_pk_fma_f32 v[50:51], v[50:51], v[116:117], v[18:19] op_sel_hi:[1,0,1]
    v_pk_fma_f32 v[52:53], v[52:53], v[116:117], v[20:21] op_sel_hi:[1,0,1]
    v_pk_fma_f32 v[54:55], v[54:55], v[116:117], v[22:23] op_sel_hi:[1,0,1]
    v_pk_fma_f32 v[56:57], v[56:57], v[116:117], v[24:25] op_sel_hi:[1,0,1]
    v_pk_fma_f32 v[58:59], v[58:59], v[116:117], v[26:27] op_sel_hi:[1,0,1]
    v_pk_fma_f32 v[60:61], v[60:61], v[116:117], v[28:29] op_sel_hi:[1,0,1]
    v_pk_fma_f32 v[62:63], v[62:63], v[116:117], v[30:31] op_sel_hi:[1,0,1]
    v_cvt_pk_bf16_f32 v80, v48, v49
    v_cvt_pk_bf16_f32 v81, v50, v51
    v_cvt_pk_bf16_f32 v82, v52, v53
    v_cvt_pk_bf16_f32 v83, v54, v55
    v_cvt_pk_bf16_f32 v84, v56, v57
    v_cvt_pk_bf16_f32 v85, v58, v59
    v_cvt_pk_bf16_f32 v86, v60, v61
    v_cvt_pk_bf16_f32 v87, v62, v63
    v_cndmask_b32 v86, v86, 0, s[44:45]
    v_cndmask_b32 v87, v87, 0, s[44:45]
    v_mfma_f32_32x32x16_bf16 v[16:31], a[232:235], v[80:83], 0
    s_nop 0
    v_mfma_f32_32x32x16_bf16 v[16:31], a[236:239], v[84:87], v[16:31]
    v_mov_b32 v92, s61
    s_add_u32 s40, s0, 1404928
    s_add_u32 m0, s56, 28672
    s_nop 0
    buffer_load_dwordx4 v1, s[8:11], s40 offen sc1 lds
    s_add_u32 s40, s0, 1405952
    s_add_u32 m0, s56, 29696
    s_nop 0
    buffer_load_dwordx4 v1, s[8:11], s40 offen sc1 lds
    s_nop 2
    v_max_f32 v88, v16, v17
    v_min_f32 v90, v16, v17
    v_max3_f32 v88, v88, v18, v19
    v_min3_f32 v90, v90, v18, v19
    v_max3_f32 v88, v88, v20, v21
    v_min3_f32 v90, v90, v20, v21
    v_max3_f32 v88, v88, v22, v23
    v_min3_f32 v90, v90, v22, v23
    v_max3_f32 v88, v88, v24, v25
    v_min3_f32 v90, v90, v24, v25
    v_max3_f32 v88, v88, v26, v27
    v_min3_f32 v90, v90, v26, v27
    s_mov_b32 exec_hi, 0
    v_max3_f32 v88, v88, v28, v29
    v_min3_f32 v90, v90, v28, v29
    v_max3_f32 v88, v88, v30, v31
    v_min3_f32 v90, v90, v30, v31
    s_mov_b64 exec, -1
    v_mov_b32 v89, v88
    v_mov_b32 v91, v90
    s_add_u32 s40, s0, 1406976
    s_add_u32 m0, s56, 30720
    s_nop 0
    buffer_load_dwordx4 v1, s[8:11], s40 offen sc1 lds
    v_permlane32_swap_b32 v88, v89
    v_permlane32_swap_b32 v90, v91
    v_max_f32 v88, v88, v89
    v_min_f32 v90, v90, v91
    v_mul_f32 v88, s61, v88
    v_mul_f32 v90, s61, v90
    v_pk_fma_f32 v[32:33], v[16:17], v[92:93], v[90:91] op_sel_hi:[1,0,0] neg_lo:[1,0,0] neg_hi:[1,0,0]
    v_pk_fma_f32 v[16:17], v[16:17], v[92:93], v[88:89] op_sel_hi:[1,0,0] neg_lo:[0,0,1] neg_hi:[0,0,1]
    v_pk_fma_f32 v[34:35], v[18:19], v[92:93], v[90:91] op_sel_hi:[1,0,0] neg_lo:[1,0,0] neg_hi:[1,0,0]
    v_pk_fma_f32 v[18:19], v[18:19], v[92:93], v[88:89] op_sel_hi:[1,0,0] neg_lo:[0,0,1] neg_hi:[0,0,1]
    v_pk_fma_f32 v[36:37], v[20:21], v[92:93], v[90:91] op_sel_hi:[1,0,0] neg_lo:[1,0,0] neg_hi:[1,0,0]
    v_pk_fma_f32 v[20:21], v[20:21], v[92:93], v[88:89] op_sel_hi:[1,0,0] neg_lo:[0,0,1] neg_hi:[0,0,1]
    v_pk_fma_f32 v[38:39], v[22:23], v[92:93], v[90:91] op_sel_hi:[1,0,0] neg_lo:[1,0,0] neg_hi:[1,0,0]
    v_pk_fma_f32 v[22:23], v[22:23], v[92:93], v[88:89] op_sel_hi:[1,0,0] neg_lo:[0,0,1] neg_hi:[0,0,1]
    v_pk_fma_f32 v[40:41], v[24:25], v[92:93], v[90:91] op_sel_hi:[1,0,0] neg_lo:[1,0,0] neg_hi:[1,0,0]
    v_pk_fma_f32 v[24:25], v[24:25], v[92:93], v[88:89] op_sel_hi:[1,0,0] neg_lo:[0,0,1] neg_hi:[0,0,1]
    v_pk_fma_f32 v[42:43], v[26:27], v[92:93], v[90:91] op_sel_hi:[1,0,0] neg_lo:[1,0,0] neg_hi:[1,0,0]
    v_pk_fma_f32 v[26:27], v[26:27], v[92:93], v[88:89] op_sel_hi:[1,0,0] neg_lo:[0,0,1] neg_hi:[0,0,1]
    v_pk_fma_f32 v[44:45], v[28:29], v[92:93], v[90:91] op_sel_hi:[1,0,0] neg_lo:[1,0,0] neg_hi:[1,0,0]
    v_pk_fma_f32 v[28:29], v[28:29], v[92:93], v[88:89] op_sel_hi:[1,0,0] neg_lo:[0,0,1] neg_hi:[0,0,1]
    v_pk_fma_f32 v[46:47], v[30:31], v[92:93], v[90:91] op_sel_hi:[1,0,0] neg_lo:[1,0,0] neg_hi:[1,0,0]
    v_pk_fma_f32 v[30:31], v[30:31], v[92:93], v[88:89] op_sel_hi:[1,0,0] neg_lo:[0,0,1] neg_hi:[0,0,1]
    s_add_u32 s40, s0, 1408000
    s_add_u32 m0, s56, 31744
    s_nop 0
    buffer_load_dwordx4 v1, s[8:11], s40 offen sc1 lds
    v_exp_f32 v16, v16
    v_exp_f32 v32, v32
    v_exp_f32 v17, v17
    v_exp_f32 v33, v33
    v_exp_f32 v18, v18
    v_exp_f32 v34, v34
    v_exp_f32 v19, v19
    v_exp_f32 v35, v35
    s_add_u32 s40, s0, 1409024
    s_add_u32 m0, s56, 32768
    s_nop 0
    buffer_load_dwordx4 v1, s[8:11], s40 offen sc1 lds
    v_exp_f32 v20, v20
    v_exp_f32 v36, v36
    v_exp_f32 v21, v21
    v_exp_f32 v37, v37
    v_exp_f32 v22, v22
    v_exp_f32 v38, v38
    v_exp_f32 v23, v23
    v_exp_f32 v39, v39
    s_add_u32 s40, s0, 1410048
    s_add_u32 m0, s56, 33792
    s_nop 0
    buffer_load_dwordx4 v1, s[8:11], s40 offen sc1 lds
    v_exp_f32 v24, v24
    v_exp_f32 v40, v40
    v_exp_f32 v25, v25
    v_exp_f32 v41, v41
    v_exp_f32 v26, v26
    v_exp_f32 v42, v42
    v_exp_f32 v27, v27
    v_exp_f32 v43, v43
    s_add_u32 s40, s0, 1411072
    s_add_u32 m0, s56, 34816
    s_nop 0
    buffer_load_dwordx4 v1, s[8:11], s40 offen sc1 lds
    v_exp_f32 v28, v28
    v_exp_f32 v44, v44
    v_exp_f32 v29, v29
    v_exp_f32 v45, v45
    v_exp_f32 v30, v30
    v_exp_f32 v46, v46
    v_exp_f32 v31, v31
    v_exp_f32 v47, v47
    v_pk_add_f32 v[92:93], v[16:17], v[18:19]
    v_pk_add_f32 v[94:95], v[32:33], v[34:35]
    v_pk_add_f32 v[92:93], v[92:93], v[20:21]
    v_pk_add_f32 v[94:95], v[94:95], v[36:37]
    v_pk_add_f32 v[92:93], v[92:93], v[22:23]
    v_pk_add_f32 v[94:95], v[94:95], v[38:39]
    v_pk_add_f32 v[92:93], v[92:93], v[24:25]
    v_pk_add_f32 v[94:95], v[94:95], v[40:41]
    v_pk_add_f32 v[92:93], v[92:93], v[26:27]
    v_pk_add_f32 v[94:95], v[94:95], v[42:43]
    s_mov_b32 exec_hi, 0
    v_pk_add_f32 v[92:93], v[92:93], v[28:29]
    v_pk_add_f32 v[94:95], v[94:95], v[44:45]
    v_pk_add_f32 v[92:93], v[92:93], v[30:31]
    v_pk_add_f32 v[94:95], v[94:95], v[46:47]
    s_mov_b64 exec, -1
    v_add_f32 v92, v92, v93
    v_add_f32 v94, v94, v95
    v_mov_b32 v93, v92
    v_mov_b32 v95, v94
    s_nop 0
    v_permlane32_swap_b32 v92, v93
    v_permlane32_swap_b32 v94, v95
    v_add_f32 v92, v92, v93
    v_add_f32 v94, v94, v95
    v_rcp_f32 v92, v92
    v_rcp_f32 v94, v94
    v_pk_mul_f32 v[16:17], v[16:17], v[92:93] op_sel_hi:[1,0]
    v_pk_mul_f32 v[18:19], v[18:19], v[92:93] op_sel_hi:[1,0]
    v_pk_mul_f32 v[20:21], v[20:21], v[92:93] op_sel_hi:[1,0]
    v_pk_mul_f32 v[22:23], v[22:23], v[92:93] op_sel_hi:[1,0]
    v_pk_mul_f32 v[24:25], v[24:25], v[92:93] op_sel_hi:[1,0]
    v_pk_mul_f32 v[26:27], v[26:27], v[92:93] op_sel_hi:[1,0]
    v_pk_mul_f32 v[28:29], v[28:29], v[92:93] op_sel_hi:[1,0]
    v_pk_mul_f32 v[30:31], v[30:31], v[92:93] op_sel_hi:[1,0]
    v_cvt_pk_bf16_f32 v96, v16, v17
    v_cvt_pk_bf16_f32 v97, v18, v19
    v_cvt_pk_bf16_f32 v98, v20, v21
    v_cvt_pk_bf16_f32 v99, v22, v23
    v_cvt_pk_bf16_f32 v100, v24, v25
    v_cvt_pk_bf16_f32 v101, v26, v27
    v_cvt_pk_bf16_f32 v102, v28, v29
    v_cvt_pk_bf16_f32 v103, v30, v31
    v_cndmask_b32 v102, v102, 0, s[44:45]
    v_cndmask_b32 v103, v103, 0, s[44:45]
    v_pk_mul_f32 v[32:33], v[32:33], v[94:95] op_sel_hi:[1,0]
    v_pk_mul_f32 v[34:35], v[34:35], v[94:95] op_sel_hi:[1,0]
    v_pk_mul_f32 v[36:37], v[36:37], v[94:95] op_sel_hi:[1,0]
    v_pk_mul_f32 v[38:39], v[38:39], v[94:95] op_sel_hi:[1,0]
    v_pk_mul_f32 v[40:41], v[40:41], v[94:95] op_sel_hi:[1,0]
    v_pk_mul_f32 v[42:43], v[42:43], v[94:95] op_sel_hi:[1,0]
    v_pk_mul_f32 v[44:45], v[44:45], v[94:95] op_sel_hi:[1,0]
    v_pk_mul_f32 v[46:47], v[46:47], v[94:95] op_sel_hi:[1,0]
    v_cvt_pk_bf16_f32 v104, v32, v33
    v_cvt_pk_bf16_f32 v105, v34, v35
    v_cvt_pk_bf16_f32 v106, v36, v37
    v_cvt_pk_bf16_f32 v107, v38, v39
    v_cvt_pk_bf16_f32 v108, v40, v41
    v_cvt_pk_bf16_f32 v109, v42, v43
    v_cvt_pk_bf16_f32 v110, v44, v45
    v_cvt_pk_bf16_f32 v111, v46, v47
    v_cndmask_b32 v110, v110, 0, s[44:45]
    v_cndmask_b32 v111, v111, 0, s[44:45]
    s_add_u32 s33, s91, 9650176
    v_and_b32 v68, 0xf0, v1
    v_bfe_u32 v69, v2, 4, 1
    v_lshl_add_u32 v68, v69, 3, v68
    v_lshrrev_b32 v69, 5, v2
    v_lshl_add_u32 v68, v69, 8, v68
    buffer_load_dwordx2 v[48:49], v68, s[8:11], s33 offen offset:0 sc1
    buffer_load_dwordx2 v[50:51], v68, s[8:11], s33 offen offset:512 sc1
    buffer_load_dwordx2 v[52:53], v68, s[8:11], s33 offen offset:1024 sc1
    buffer_load_dwordx2 v[54:55], v68, s[8:11], s33 offen offset:1536 sc1
    buffer_load_dwordx2 v[56:57], v68, s[8:11], s33 offen offset:2048 sc1
    buffer_load_dwordx2 v[58:59], v68, s[8:11], s33 offen offset:2560 sc1
    buffer_load_dwordx2 v[60:61], v68, s[8:11], s33 offen offset:3072 sc1
    buffer_load_dwordx2 v[62:63], v68, s[8:11], s33 offen offset:3584 sc1
    s_branch gk_52
gl_53:
    s_sleep 2
    buffer_load_dwordx2 v[48:49], v68, s[8:11], s33 offen offset:0 sc1
    buffer_load_dwordx2 v[50:51], v68, s[8:11], s33 offen offset:512 sc1
    buffer_load_dwordx2 v[52:53], v68, s[8:11], s33 offen offset:1024 sc1
    buffer_load_dwordx2 v[54:55], v68, s[8:11], s33 offen offset:1536 sc1
    buffer_load_dwordx2 v[56:57], v68, s[8:11], s33 offen offset:2048 sc1
    buffer_load_dwordx2 v[58:59], v68, s[8:11], s33 offen offset:2560 sc1
    buffer_load_dwordx2 v[60:61], v68, s[8:11], s33 offen offset:3072 sc1
    buffer_load_dwordx2 v[62:63], v68, s[8:11], s33 offen offset:3584 sc1
    s_add_u32 s60, s60, 1
    s_cmp_gt_u32 s60, 100000
    s_cbranch_scc1 L_exit
    s_waitcnt vmcnt(0)
gk_52:
    s_waitcnt vmcnt(0)
    v_max3_u32 v120, v48, v49, v50
    v_max3_u32 v120, v120, v51, v52
    v_max3_u32 v120, v120, v53, v54
    v_max3_u32 v120, v120, v55, v56
    v_max3_u32 v120, v120, v57, v58
    v_max3_u32 v120, v120, v59, v60
    v_max3_u32 v120, v120, v61, v62
    v_max_u32 v120, v120, v63
    v_cmp_eq_u32 vcc, -1, v120
    s_nop 0
    s_cbranch_vccnz gl_53
    v_mfma_f32_32x32x16_bf16 v[16:31], v[48:51], v[96:99], 0
    v_mfma_f32_32x32x16_bf16 v[16:31], v[52:55], v[100:103], v[16:31]
    v_mfma_f32_32x32x16_bf16 v[16:31], v[56:59], v[104:107], v[16:31]
    v_mfma_f32_32x32x16_bf16 v[16:31], v[60:63], v[108:111], v[16:31]
    s_nop 11
    v_mov_b32 v12, v28
    v_mov_b32 v13, v28
    s_mul_i32 s28, s5, 7
    s_lshr_b32 s28, s28, 1
    s_lshl_b32 s28, s28, 9
    s_add_u32 s28, s28, s50
    s_add_u32 s28, s28, 5652480
    v_permlane32_swap_b32 v12, v13
    v_add_f32 v13, 0x358637bd, v13
    v_rcp_f32 v12, v13
    s_nop 0
    v_pk_mul_f32 v[16:17], v[16:17], v[12:13] op_sel_hi:[1,0]
    v_pk_mul_f32 v[18:19], v[18:19], v[12:13] op_sel_hi:[1,0]
    v_pk_mul_f32 v[20:21], v[20:21], v[12:13] op_sel_hi:[1,0]
    v_pk_mul_f32 v[22:23], v[22:23], v[12:13] op_sel_hi:[1,0]
    v_pk_mul_f32 v[24:25], v[24:25], v[12:13] op_sel_hi:[1,0]
    v_pk_mul_f32 v[26:27], v[26:27], v[12:13] op_sel_hi:[1,0]
    v_pk_mul_f32 v[28:29], v[28:29], v[12:13] op_sel_hi:[1,0]
    v_pk_mul_f32 v[30:31], v[30:31], v[12:13] op_sel_hi:[1,0]
    v_cvt_pk_bf16_f32 v16, v16, v17
    v_cvt_pk_bf16_f32 v17, v18, v19
    v_cvt_pk_bf16_f32 v18, v20, v21
    v_cvt_pk_bf16_f32 v19, v22, v23
    v_cvt_pk_bf16_f32 v20, v24, v25
    v_cvt_pk_bf16_f32 v21, v26, v27
    v_cvt_pk_bf16_f32 v22, v28, v29
    v_cvt_pk_bf16_f32 v23, v30, v31
    v_and_b32 v16, -2, v16
    v_and_b32 v18, -2, v18
    v_and_b32 v20, -2, v20
    v_and_b32 v22, -2, v22
    s_bitcmp1_b32 s5, 0
    s_cbranch_scc1 oo_54
    v_permlane32_swap_b32 v16, v18
    v_permlane32_swap_b32 v17, v19
    v_permlane32_swap_b32 v20, v22
    v_permlane32_swap_b32 v21, v23
    s_cmp_eq_u32 s6, 0
    s_cbranch_scc1 ls_56
    buffer_store_dwordx4 v[16:19], v1, s[8:11], s28 offen
    s_mov_b32 exec_hi, 0
    buffer_store_dwordx4 v[20:23], v1, s[8:11], s28 offen offset:1024
    s_not_b64 exec, exec
    buffer_store_dwordx2 v[20:21], v1, s[8:11], s28 offen offset:1024
    s_mov_b64 exec, -1
le_57:
    s_branch od_55
oo_54:
    s_nop 1
    v_permlane32_swap_b32 v18, v18
    v_permlane32_swap_b32 v19, v19
    v_permlane32_swap_b32 v22, v22
    v_permlane32_swap_b32 v23, v23
    s_cmp_eq_u32 s6, 0
    s_cbranch_scc1 ls_58
    s_mov_b32 exec_lo, 0
    buffer_store_dwordx4 v[16:19], v1, s[8:11], s28 offen
    buffer_store_dwordx4 v[20:23], v1, s[8:11], s28 offen offset:1024
    s_not_b64 exec, exec
    buffer_store_dwordx4 v[18:21], v1, s[8:11], s28 offen offset:1024
    buffer_store_dwordx2 v[16:17], v1, s[8:11], s28 offen offset:8
    s_mov_b64 exec, -1
le_59:
od_55:
    s_nop 1
    s_add_u32 s28, s52, s56
    s_add_u32 s28, s28, 5652480
    s_add_u32 s29, s28, 4096
    v_add_u32 v112, 135168, v3
    v_add_u32 v113, 135168, v4
    v_add_u32 v114, 135168, v5
    v_add_u32 v115, 135168, v6
    s_add_u32 s30, s85, 3555328
    s_add_u32 s31, s86, 3555328
    v_mov_b32 v200, 0
    v_mov_b32 v201, 0
    v_mov_b32 v204, 0x3f803f80
    v_accvgpr_read_b32 v192, a224
    v_accvgpr_read_b32 v193, a225
    v_accvgpr_read_b32 v194, a226
    v_accvgpr_read_b32 v195, a227
    v_accvgpr_read_b32 v196, a228
    v_accvgpr_read_b32 v197, a229
    v_accvgpr_read_b32 v198, a230
    v_accvgpr_read_b32 v199, a231
    v_permlane32_swap_b32 v192, v194
    v_permlane32_swap_b32 v193, v195
    v_permlane32_swap_b32 v196, v198
    v_permlane32_swap_b32 v197, v199
    v_lshlrev_b32 v96, 16, v192
    v_and_b32 v97, 0xffff0000, v192
    v_lshlrev_b32 v98, 16, v193
    v_and_b32 v99, 0xffff0000, v193
    v_lshlrev_b32 v100, 16, v194
    v_and_b32 v101, 0xffff0000, v194
    v_lshlrev_b32 v102, 16, v195
    v_and_b32 v103, 0xffff0000, v195
    v_lshlrev_b32 v104, 16, v196
    v_and_b32 v105, 0xffff0000, v196
    v_lshlrev_b32 v106, 16, v197
    v_and_b32 v107, 0xffff0000, v197
    v_lshlrev_b32 v108, 16, v198
    v_and_b32 v109, 0xffff0000, v198
    v_lshlrev_b32 v110, 16, v199
    v_and_b32 v111, 0xffff0000, v199
    buffer_load_dwordx4 v[128:131], v1, s[8:11], s28 offen offset:0 sc1
    buffer_load_dwordx4 v[132:135], v1, s[8:11], s28 offen offset:1024 sc1
    buffer_load_dwordx4 v[136:139], v1, s[8:11], s28 offen offset:2048 sc1
    buffer_load_dwordx4 v[140:143], v1, s[8:11], s28 offen offset:3072 sc1
    buffer_load_dwordx4 v[144:147], v1, s[8:11], s29 offen offset:0 sc1
    buffer_load_dwordx4 v[148:151], v1, s[8:11], s29 offen offset:1024 sc1
    buffer_load_dwordx4 v[152:155], v1, s[8:11], s29 offen offset:2048 sc1
    s_branch L_woa1_w
L_woa1_g:
    s_waitcnt lgkmcnt(0)
    buffer_load_dwordx4 v[128:131], v1, s[8:11], s28 offen offset:0 sc1
    buffer_load_dwordx4 v[132:135], v1, s[8:11], s28 offen offset:1024 sc1
    buffer_load_dwordx4 v[136:139], v1, s[8:11], s28 offen offset:2048 sc1
    buffer_load_dwordx4 v[140:143], v1, s[8:11], s28 offen offset:3072 sc1
    buffer_load_dwordx4 v[144:147], v1, s[8:11], s29 offen offset:0 sc1
    buffer_load_dwordx4 v[148:151], v1, s[8:11], s29 offen offset:1024 sc1
    buffer_load_dwordx4 v[152:155], v1, s[8:11], s29 offen offset:2048 sc1
    s_add_u32 s60, s60, 1
    s_cmp_gt_u32 s60, 100000
    s_cbranch_scc1 L_exit
L_woa1_w:
    s_waitcnt vmcnt(6)
    ds_write_b128 v112, v[128:131] offset:0
    v_or3_b32 v120, v128, v128, v130
    s_waitcnt vmcnt(5)
    ds_write_b128 v112, v[132:135] offset:1024
    v_or3_b32 v120, v120, v132, v134
    s_waitcnt vmcnt(4)
    ds_write_b128 v112, v[136:139] offset:2048
    v_or3_b32 v120, v120, v136, v138
    s_waitcnt vmcnt(3)
    ds_write_b128 v112, v[140:143] offset:3072
    v_or3_b32 v120, v120, v140, v142
    s_waitcnt vmcnt(2)
    ds_write_b128 v112, v[144:147] offset:4096
    v_or3_b32 v120, v120, v144, v146
    s_waitcnt vmcnt(1)
    ds_write_b128 v112, v[148:151] offset:5120
    v_or3_b32 v120, v120, v148, v150
    s_waitcnt vmcnt(0)
    ds_write_b128 v112, v[152:155] offset:6144
    v_or3_b32 v120, v120, v152, v154
    v_and_b32 v120, 1, v120
    v_cmp_ne_u32 vcc, 0, v120
    s_nop 0
    s_cbranch_vccnz L_woa1_g
L_woa1_ok:
    v_mfma_f32_32x32x16_bf16 v[96:111], a[0:3], v[128:131], v[96:111]
    s_waitcnt lgkmcnt(0)
    s_barrier
    ds_read_b128 v[188:191], v113 offset:0
    ds_read_b128 v[160:163], v113 offset:1024
    ds_read_b128 v[164:167], v113 offset:2048
    v_mfma_f32_32x32x16_bf16 v[96:111], a[4:7], v[132:135], v[96:111]
    ds_read_b128 v[168:171], v113 offset:3072
    v_mfma_f32_32x32x16_bf16 v[96:111], a[8:11], v[136:139], v[96:111]
    ds_read_b128 v[172:175], v113 offset:4096
    s_add_u32 s40, s0, 1433600
    s_add_u32 m0, s56, 57344
    s_nop 0
    buffer_load_dwordx4 v1, s[8:11], s40 offen sc1 lds
    v_mfma_f32_32x32x16_bf16 v[96:111], a[12:15], v[140:143], v[96:111]
    ds_read_b128 v[176:179], v113 offset:5120
    s_add_u32 s40, s0, 1434624
    s_add_u32 m0, s56, 58368
    s_nop 0
    buffer_load_dwordx4 v1, s[8:11], s40 offen sc1 lds
    v_mfma_f32_32x32x16_bf16 v[96:111], a[16:19], v[144:147], v[96:111]
    ds_read_b128 v[180:183], v113 offset:6144
    s_add_u32 s40, s0, 1435648
    s_add_u32 m0, s56, 59392
    s_nop 0
    buffer_load_dwordx4 v1, s[8:11], s40 offen sc1 lds
    v_mfma_f32_32x32x16_bf16 v[96:111], a[20:23], v[148:151], v[96:111]
    s_add_u32 s40, s0, 1436672
    s_add_u32 m0, s56, 60416
    s_nop 0
    buffer_load_dwordx4 v1, s[8:11], s40 offen sc1 lds
    v_mfma_f32_32x32x16_bf16 v[96:111], a[24:27], v[152:155], v[96:111]
    s_add_u32 s40, s0, 1437696
    s_add_u32 m0, s56, 61440
    s_nop 0
    buffer_load_dwordx4 v1, s[8:11], s40 offen sc1 lds
    s_getpc_b64 s[40:41]
cr_60:
    s_sub_u32 s40, s40, 0x8360
    s_subb_u32 s41, s41, 0
    s_lshr_b32 s42, s2, 3
    s_lshl_b32 s42, s42, 2
    s_add_u32 s42, s42, s3
    s_lshl_b32 s42, s42, 9
    v_lshl_add_u32 v7, v2, 7, s42
    v_min_u32 v7, 0xbb60, v7
    s_mov_b64 exec, 0xf
    global_load_dword a252, v7, s[40:41] sc1
    s_mov_b64 exec, -1
    ds_read_b128 v[184:187], v114 offset:0
    s_waitcnt lgkmcnt(7)
    v_mfma_f32_32x32x16_bf16 v[96:111], a[28:31], v[188:191], v[96:111]
    s_add_u32 s40, s0, 1438720
    s_add_u32 m0, s56, 62464
    s_nop 0
    buffer_load_dwordx4 v1, s[8:11], s40 offen sc1 lds
    ds_read_b128 v[188:191], v114 offset:1024
    s_waitcnt lgkmcnt(7)
    v_mfma_f32_32x32x16_bf16 v[96:111], a[32:35], v[160:163], v[96:111]
    s_add_u32 s40, s0, 1439744
    s_add_u32 m0, s56, 63488
    s_nop 0
    buffer_load_dwordx4 v1, s[8:11], s40 offen sc1 lds
    ds_read_b128 v[160:163], v114 offset:2048
    s_waitcnt lgkmcnt(7)
    v_mfma_f32_32x32x16_bf16 v[96:111], a[36:39], v[164:167], v[96:111]
    ds_read_b128 v[164:167], v114 offset:3072
    s_waitcnt lgkmcnt(7)
    v_mfma_f32_32x32x16_bf16 v[96:111], a[40:43], v[168:171], v[96:111]
    ds_read_b128 v[168:171], v114 offset:4096
    s_waitcnt lgkmcnt(7)
    v_mfma_f32_32x32x16_bf16 v[96:111], a[44:47], v[172:175], v[96:111]
    ds_read_b128 v[172:175], v114 offset:5120
    s_waitcnt lgkmcnt(7)
    v_mfma_f32_32x32x16_bf16 v[96:111], a[48:51], v[176:179], v[96:111]
    ds_read_b128 v[176:179], v114 offset:6144
    s_waitcnt lgkmcnt(7)
    v_mfma_f32_32x32x16_bf16 v[96:111], a[52:55], v[180:183], v[96:111]
    ds_read_b128 v[180:183], v115 offset:0
    s_waitcnt lgkmcnt(7)
    v_mfma_f32_32x32x16_bf16 v[96:111], a[56:59], v[184:187], v[96:111]
    ds_read_b128 v[184:187], v115 offset:1024
    s_waitcnt lgkmcnt(7)
    v_mfma_f32_32x32x16_bf16 v[96:111], a[60:63], v[188:191], v[96:111]
    ds_read_b128 v[188:191], v115 offset:2048
    s_waitcnt lgkmcnt(7)
    v_mfma_f32_32x32x16_bf16 v[96:111], a[64:67], v[160:163], v[96:111]
    ds_read_b128 v[160:163], v115 offset:3072
    s_waitcnt lgkmcnt(7)
    v_mfma_f32_32x32x16_bf16 v[96:111], a[68:71], v[164:167], v[96:111]
    ds_read_b128 v[164:167], v115 offset:4096
    s_waitcnt lgkmcnt(7)
    v_mfma_f32_32x32x16_bf16 v[96:111], a[72:75], v[168:171], v[96:111]
    ds_read_b128 v[168:171], v115 offset:5120
    s_waitcnt lgkmcnt(7)
    v_mfma_f32_32x32x16_bf16 v[96:111], a[76:79], v[172:175], v[96:111]
    ds_read_b128 v[172:175], v115 offset:6144
    s_waitcnt lgkmcnt(7)
    v_mfma_f32_32x32x16_bf16 v[96:111], a[80:83], v[176:179], v[96:111]
    s_waitcnt lgkmcnt(6)
    v_mfma_f32_32x32x16_bf16 v[96:111], a[84:87], v[180:183], v[96:111]
    s_waitcnt lgkmcnt(5)
    v_mfma_f32_32x32x16_bf16 v[96:111], a[88:91], v[184:187], v[96:111]
    s_waitcnt lgkmcnt(4)
    v_mfma_f32_32x32x16_bf16 v[96:111], a[92:95], v[188:191], v[96:111]
    s_waitcnt lgkmcnt(3)
    v_mfma_f32_32x32x16_bf16 v[96:111], a[96:99], v[160:163], v[96:111]
    s_waitcnt lgkmcnt(2)
    v_mfma_f32_32x32x16_bf16 v[96:111], a[100:103], v[164:167], v[96:111]
    s_waitcnt lgkmcnt(1)
    v_mfma_f32_32x32x16_bf16 v[96:111], a[104:107], v[168:171], v[96:111]
    s_waitcnt lgkmcnt(0)
    v_mfma_f32_32x32x16_bf16 v[96:111], a[108:111], v[172:175], v[96:111]
    s_cmp_ge_u32 s54, 14
    s_cbranch_scc1 L_woa1_idle
    s_nop 9
    v_cvt_pk_bf16_f32 v192, v96, v97
    v_cvt_pk_bf16_f32 v193, v98, v99
    v_cvt_pk_bf16_f32 v194, v100, v101
    v_cvt_pk_bf16_f32 v195, v102, v103
    v_cvt_pk_bf16_f32 v196, v104, v105
    v_cvt_pk_bf16_f32 v197, v106, v107
    v_cvt_pk_bf16_f32 v198, v108, v109
    v_cvt_pk_bf16_f32 v199, v110, v111
    v_permlane32_swap_b32 v192, v194
    v_permlane32_swap_b32 v193, v195
    v_permlane32_swap_b32 v196, v198
    v_permlane32_swap_b32 v197, v199
    v_accvgpr_write_b32 a224, v192
    v_and_b32 v192, -2, v192
    v_accvgpr_write_b32 a228, v196
    v_and_b32 v196, -2, v196
    s_cmp_eq_u32 s6, 0
    s_cbranch_scc1 ls_61
    buffer_store_dwordx4 v[192:195], v1, s[8:11], s30 offen
    buffer_store_dwordx4 v[196:199], v1, s[8:11], s30 offen offset:1024
le_62:
    v_dot2c_f32_bf16 v200, v192, v204
    v_dot2c_f32_bf16 v201, v192, v192
    v_dot2c_f32_bf16 v200, v193, v204
    v_dot2c_f32_bf16 v201, v193, v193
    v_dot2c_f32_bf16 v200, v194, v204
    v_dot2c_f32_bf16 v201, v194, v194
    v_dot2c_f32_bf16 v200, v195, v204
    v_dot2c_f32_bf16 v201, v195, v195
    v_dot2c_f32_bf16 v200, v196, v204
    v_dot2c_f32_bf16 v201, v196, v196
    v_dot2c_f32_bf16 v200, v197, v204
    v_dot2c_f32_bf16 v201, v197, v197
    v_dot2c_f32_bf16 v200, v198, v204
    v_dot2c_f32_bf16 v201, v198, v198
    v_dot2c_f32_bf16 v200, v199, v204
    v_dot2c_f32_bf16 v201, v199, v199
    s_nop 1
    v_mov_b32 v202, v200
    v_mov_b32 v203, v201
    s_nop 0
    v_permlane32_swap_b32 v200, v202
    v_permlane32_swap_b32 v201, v203
    v_pk_add_f32 v[200:201], v[200:201], v[202:203]
    v_and_b32 v200, -2, v200
    v_and_b32 v201, -2, v201
    s_cmp_eq_u32 s6, 0
    s_cbranch_scc1 ls_63
    s_mov_b32 exec_hi, 0
    buffer_store_dwordx2 v[200:201], v8, s[8:11], s31 offen
    s_mov_b64 exec, -1
le_64:
    v_accvgpr_write_b32 a225, v193
    v_accvgpr_write_b32 a226, v194
    v_accvgpr_write_b32 a227, v195
    v_accvgpr_write_b32 a229, v197
    v_accvgpr_write_b32 a230, v198
    v_accvgpr_write_b32 a231, v199
L_woa1_idle:
    v_lshl_add_u32 v121, v2, 2, s88
    v_lshrrev_b32 v122, 5, v2
    v_lshl_add_u32 v122, v122, 4, s88
    s_lshl_b32 s28, s3, 2
    s_add_u32 s28, s28, 86016
    v_add_u32 v123, s28, v1
    v_add_u32 v124, 86016, v1
    v_mov_b32 v112, 0x3f803f80
    v_mov_b32 v113, 0x3f803f80
    v_mov_b32 v114, 0x3f803f80
    v_mov_b32 v115, 0x3f803f80
    s_add_u32 s32, s51, 5390336
    s_add_u32 s33, s50, 3555328
    s_add_u32 s34, s33, s56
    s_add_u32 s35, s33, s57
    s_add_u32 s36, s33, s58
    s_add_u32 s37, s33, s59
    buffer_load_dwordx2 v[240:241], v8, s[8:11], s32 offen offset:0 sc1
    buffer_load_dwordx2 v[242:243], v8, s[8:11], s32 offen offset:512 sc1
    buffer_load_dwordx2 v[244:245], v8, s[8:11], s32 offen offset:1024 sc1
    buffer_load_dwordx2 v[246:247], v8, s[8:11], s32 offen offset:1536 sc1
    buffer_load_dwordx2 v[248:249], v8, s[8:11], s32 offen offset:2048 sc1
    buffer_load_dwordx2 v[250:251], v8, s[8:11], s32 offen offset:2560 sc1
    buffer_load_dwordx2 v[252:253], v8, s[8:11], s32 offen offset:3072 sc1
    buffer_load_dwordx4 v[128:131], v1, s[8:11], s34 offen offset:0 sc1
    buffer_load_dwordx4 v[132:135], v1, s[8:11], s34 offen offset:1024 sc1
    buffer_load_dwordx4 v[136:139], v1, s[8:11], s34 offen offset:2048 sc1
    buffer_load_dwordx4 v[140:143], v1, s[8:11], s34 offen offset:3072 sc1
    ds_read_b128 v[96:99], v3 offset:0
    ds_read_b128 v[100:103], v3 offset:28672
    ds_read_b128 v[104:107], v3 offset:1024
    ds_read_b128 v[108:111], v3 offset:29696
    s_branch gk_65
gl_66:
    buffer_load_dwordx2 v[240:241], v8, s[8:11], s32 offen offset:0 sc1
    buffer_load_dwordx2 v[242:243], v8, s[8:11], s32 offen offset:512 sc1
    buffer_load_dwordx2 v[244:245], v8, s[8:11], s32 offen offset:1024 sc1
    buffer_load_dwordx2 v[246:247], v8, s[8:11], s32 offen offset:1536 sc1
    buffer_load_dwordx2 v[248:249], v8, s[8:11], s32 offen offset:2048 sc1
    buffer_load_dwordx2 v[250:251], v8, s[8:11], s32 offen offset:2560 sc1
    buffer_load_dwordx2 v[252:253], v8, s[8:11], s32 offen offset:3072 sc1
    buffer_load_dwordx4 v[128:131], v1, s[8:11], s34 offen offset:0 sc1
    buffer_load_dwordx4 v[132:135], v1, s[8:11], s34 offen offset:1024 sc1
    buffer_load_dwordx4 v[136:139], v1, s[8:11], s34 offen offset:2048 sc1
    buffer_load_dwordx4 v[140:143], v1, s[8:11], s34 offen offset:3072 sc1
    s_add_u32 s60, s60, 1
    s_cmp_gt_u32 s60, 100000
    s_cbranch_scc1 L_exit
    s_waitcnt vmcnt(4)
gk_65:
    s_waitcnt vmcnt(4)
    v_or3_b32 v120, v240, v241, v242
    v_or3_b32 v120, v120, v243, v244
    v_or3_b32 v120, v120, v245, v246
    v_or3_b32 v120, v120, v247, v248
    v_or3_b32 v120, v120, v249, v250
    v_or3_b32 v120, v120, v251, v252
    v_or3_b32 v120, v120, v253, v240
    v_and_b32 v120, 1, v120
    v_cmp_ne_u32 vcc, 0, v120
    s_nop 0
    s_cbranch_vccnz gl_66
    s_add_u32 s38, s34, 4096
    buffer_load_dwordx4 v[144:147], v1, s[8:11], s38 offen offset:0 sc1
    buffer_load_dwordx4 v[148:151], v1, s[8:11], s38 offen offset:1024 sc1
    buffer_load_dwordx4 v[152:155], v1, s[8:11], s38 offen offset:2048 sc1
    buffer_load_dwordx4 v[156:159], v1, s[8:11], s35 offen offset:0 sc1
    buffer_load_dwordx4 v[160:163], v1, s[8:11], s35 offen offset:1024 sc1
    buffer_load_dwordx4 v[164:167], v1, s[8:11], s35 offen offset:2048 sc1
    buffer_load_dwordx4 v[168:171], v1, s[8:11], s35 offen offset:3072 sc1
    s_add_u32 s38, s35, 4096
    buffer_load_dwordx4 v[172:175], v1, s[8:11], s38 offen offset:0 sc1
    v_pk_add_f32 v[240:241], v[240:241], v[242:243]
    v_pk_add_f32 v[240:241], v[240:241], v[244:245]
    v_pk_add_f32 v[240:241], v[240:241], v[246:247]
    v_pk_add_f32 v[240:241], v[240:241], v[248:249]
    v_pk_add_f32 v[240:241], v[240:241], v[250:251]
    v_pk_add_f32 v[240:241], v[240:241], v[252:253]
    ds_read_b128 v[248:251], v3 offset:2048
    ds_read_b128 v[252:255], v3 offset:30720
    v_mov_b32 v242, v240
    v_mov_b32 v243, v241
    s_nop 0
    v_permlane32_swap_b32 v240, v242
    v_permlane32_swap_b32 v241, v243
    v_add_f32 v240, v240, v242
    v_add_f32 v241, v241, v243
    v_mul_f32 v240, 0x3b124925, v240
    v_mul_f32 v241, 0x3b124925, v241
    v_fma_f32 v241, -v240, v240, v241
    v_max_f32 v241, 0, v241
    v_add_f32 v241, 0x3727c5ac, v241
    v_rsq_f32 v116, v241
    s_nop 0
    v_mul_f32 v118, -v240, v116
    v_cndmask_b32 v242, v116, v118, s[44:45]
    ds_write_b32 v121, v242
    s_waitcnt vmcnt(8)
L_b1_c:
    v_or3_b32 v120, v128, v132, v136
    v_or3_b32 v120, v120, v140, v128
    v_or3_b32 v120, v120, v128, v128
    v_and_b32 v120, 1, v120
    v_cmp_ne_u32 vcc, 0, v120
    s_nop 0
    s_cbranch_vccnz L_b1_r
    v_mov_b32 v120, 0
    ds_read_b128 v[240:243], v3 offset:3072
    ds_read_b128 v[244:247], v3 offset:31744
    s_waitcnt vmcnt(11) lgkmcnt(6)
    v_mfma_f32_32x32x16_bf16 v[16:31], v[96:99], v[128:131], 0
    buffer_load_dwordx4 v[176:179], v1, s[8:11], s38 offen offset:1024 sc1
    v_mfma_f32_32x32x16_bf16 v[32:47], v[128:131], v[100:103], 0
    ds_read_b128 v[96:99], v3 offset:4096
    ds_read_b128 v[100:103], v3 offset:32768
    s_waitcnt vmcnt(11) lgkmcnt(6)
    v_mfma_f32_32x32x16_bf16 v[16:31], v[104:107], v[132:135], v[16:31]
    buffer_load_dwordx4 v[180:183], v1, s[8:11], s38 offen offset:2048 sc1
    v_or3_b32 v120, v120, v132, v128
    v_mfma_f32_32x32x16_bf16 v[32:47], v[132:135], v[108:111], v[32:47]
    ds_read_b128 v[104:107], v3 offset:5120
    ds_read_b128 v[108:111], v3 offset:33792
    s_waitcnt vmcnt(11) lgkmcnt(6)
    v_mfma_f32_32x32x16_bf16 v[16:31], v[248:251], v[136:139], v[16:31]
    buffer_load_dwordx4 v[184:187], v1, s[8:11], s36 offen offset:0 sc1
    v_mfma_f32_32x32x16_bf16 v[32:47], v[136:139], v[252:255], v[32:47]
    ds_read_b128 v[248:251], v3 offset:6144
    ds_read_b128 v[252:255], v3 offset:34816
    s_waitcnt vmcnt(11) lgkmcnt(6)
    v_mfma_f32_32x32x16_bf16 v[16:31], v[240:243], v[140:143], v[16:31]
    buffer_load_dwordx4 v[188:191], v1, s[8:11], s36 offen offset:1024 sc1
    v_or3_b32 v120, v120, v140, v136
    v_mfma_f32_32x32x16_bf16 v[32:47], v[140:143], v[244:247], v[32:47]
    ds_read_b128 v[240:243], v4 offset:0
    ds_read_b128 v[244:247], v4 offset:28672
    s_waitcnt vmcnt(11) lgkmcnt(6)
    v_mfma_f32_32x32x16_bf16 v[16:31], v[96:99], v[144:147], v[16:31]
    buffer_load_dwordx4 v[192:195], v1, s[8:11], s36 offen offset:2048 sc1
    v_mfma_f32_32x32x16_bf16 v[32:47], v[144:147], v[100:103], v[32:47]
    ds_read_b128 v[96:99], v4 offset:1024
    ds_read_b128 v[100:103], v4 offset:29696
    s_waitcnt vmcnt(11) lgkmcnt(6)
    v_mfma_f32_32x32x16_bf16 v[16:31], v[104:107], v[148:151], v[16:31]
    buffer_load_dwordx4 v[196:199], v1, s[8:11], s36 offen offset:3072 sc1
    v_or3_b32 v120, v120, v148, v144
    v_mfma_f32_32x32x16_bf16 v[32:47], v[148:151], v[108:111], v[32:47]
    ds_read_b128 v[104:107], v4 offset:2048
    ds_read_b128 v[108:111], v4 offset:30720
    s_waitcnt vmcnt(11) lgkmcnt(6)
    v_mfma_f32_32x32x16_bf16 v[16:31], v[248:251], v[152:155], v[16:31]
    s_add_u32 s38, s36, 4096
    buffer_load_dwordx4 v[200:203], v1, s[8:11], s38 offen offset:0 sc1
    v_mfma_f32_32x32x16_bf16 v[32:47], v[152:155], v[252:255], v[32:47]
    ds_read_b128 v[248:251], v4 offset:3072
    ds_read_b128 v[252:255], v4 offset:31744
    s_waitcnt vmcnt(11) lgkmcnt(6)
    v_mfma_f32_32x32x16_bf16 v[16:31], v[240:243], v[156:159], v[16:31]
    buffer_load_dwordx4 v[204:207], v1, s[8:11], s38 offen offset:1024 sc1
    v_or3_b32 v120, v120, v156, v152
    v_mfma_f32_32x32x16_bf16 v[32:47], v[156:159], v[244:247], v[32:47]
    ds_read_b128 v[240:243], v4 offset:4096
    ds_read_b128 v[244:247], v4 offset:32768
    s_waitcnt vmcnt(11) lgkmcnt(6)
    v_mfma_f32_32x32x16_bf16 v[16:31], v[96:99], v[160:163], v[16:31]
    buffer_load_dwordx4 v[208:211], v1, s[8:11], s38 offen offset:2048 sc1
    v_mfma_f32_32x32x16_bf16 v[32:47], v[160:163], v[100:103], v[32:47]
    ds_read_b128 v[96:99], v4 offset:5120
    ds_read_b128 v[100:103], v4 offset:33792
    s_waitcnt vmcnt(11) lgkmcnt(6)
    v_mfma_f32_32x32x16_bf16 v[16:31], v[104:107], v[164:167], v[16:31]
    buffer_load_dwordx4 v[212:215], v1, s[8:11], s37 offen offset:0 sc1
    v_or3_b32 v120, v120, v164, v160
    v_mfma_f32_32x32x16_bf16 v[32:47], v[164:167], v[108:111], v[32:47]
    ds_read_b128 v[64:67], v122 offset:0
    ds_read_b128 v[80:83], v122 offset:128
    ds_read_b128 v[68:71], v122 offset:32
    ds_read_b128 v[84:87], v122 offset:160
    ds_read_b128 v[104:107], v4 offset:6144
    ds_read_b128 v[108:111], v4 offset:34816
    s_waitcnt vmcnt(11) lgkmcnt(6)
    v_mfma_f32_32x32x16_bf16 v[16:31], v[248:251], v[168:171], v[16:31]
    buffer_load_dwordx4 v[216:219], v1, s[8:11], s37 offen offset:1024 sc1
    v_mfma_f32_32x32x16_bf16 v[32:47], v[168:171], v[252:255], v[32:47]
    ds_read_b128 v[72:75], v122 offset:64
    ds_read_b128 v[88:91], v122 offset:192
    ds_read_b128 v[76:79], v122 offset:96
    ds_read_b128 v[92:95], v122 offset:224
    ds_read_b128 v[248:251], v5 offset:0
    ds_read_b128 v[252:255], v5 offset:28672
    s_waitcnt vmcnt(11) lgkmcnt(6)
    v_mfma_f32_32x32x16_bf16 v[16:31], v[240:243], v[172:175], v[16:31]
    buffer_load_dwordx4 v[220:223], v1, s[8:11], s37 offen offset:2048 sc1
    v_or3_b32 v120, v120, v172, v168
    v_mfma_f32_32x32x16_bf16 v[32:47], v[172:175], v[244:247], v[32:47]
    ds_read_b128 v[240:243], v5 offset:1024
    ds_read_b128 v[244:247], v5 offset:29696
    s_waitcnt vmcnt(11) lgkmcnt(6)
    v_mfma_f32_32x32x16_bf16 v[16:31], v[96:99], v[176:179], v[16:31]
    buffer_load_dwordx4 v[224:227], v1, s[8:11], s37 offen offset:3072 sc1
    v_mfma_f32_32x32x16_bf16 v[32:47], v[176:179], v[100:103], v[32:47]
    ds_read_b128 v[96:99], v5 offset:2048
    ds_read_b128 v[100:103], v5 offset:30720
    s_waitcnt vmcnt(11) lgkmcnt(6)
    v_mfma_f32_32x32x16_bf16 v[16:31], v[104:107], v[180:183], v[16:31]
    s_add_u32 s38, s37, 4096
    buffer_load_dwordx4 v[228:231], v1, s[8:11], s38 offen offset:0 sc1
    v_or3_b32 v120, v120, v180, v176
    v_mfma_f32_32x32x16_bf16 v[32:47], v[180:183], v[108:111], v[32:47]
    ds_read_b128 v[104:107], v5 offset:3072
    ds_read_b128 v[108:111], v5 offset:31744
    s_waitcnt vmcnt(11) lgkmcnt(6)
    v_mfma_f32_32x32x16_bf16 v[16:31], v[248:251], v[184:187], v[16:31]
    buffer_load_dwordx4 v[232:235], v1, s[8:11], s38 offen offset:1024 sc1
    v_mfma_f32_32x32x16_bf16 v[32:47], v[184:187], v[252:255], v[32:47]
    v_accvgpr_read_b32 v12, a254
    ds_write_b32 v121, v12 offset:1024
    v_mov_b32 v126, v12
    s_nop 1
    v_permlane32_swap_b32 v12, v126
    ds_read_b128 v[248:251], v5 offset:4096
    ds_read_b128 v[252:255], v5 offset:32768
    s_waitcnt vmcnt(11) lgkmcnt(6)
    v_mfma_f32_32x32x16_bf16 v[16:31], v[240:243], v[188:191], v[16:31]
    buffer_load_dwordx4 v[236:239], v1, s[8:11], s38 offen offset:2048 sc1
    v_or3_b32 v120, v120, v188, v184
    v_mfma_f32_32x32x16_bf16 v[32:47], v[188:191], v[244:247], v[32:47]
    ds_read_b128 v[48:51], v122 offset:1024
    ds_read_b128 v[52:55], v122 offset:1056
    ds_read_b128 v[56:59], v122 offset:1088
    ds_read_b128 v[60:63], v122 offset:1120
    ds_read_b128 v[240:243], v5 offset:5120
    ds_read_b128 v[244:247], v5 offset:33792
    s_waitcnt vmcnt(11) lgkmcnt(6)
    v_mfma_f32_32x32x16_bf16 v[16:31], v[96:99], v[192:195], v[16:31]
    v_mfma_f32_32x32x16_bf16 v[32:47], v[192:195], v[100:103], v[32:47]
    ds_read_b128 v[96:99], v5 offset:6144
    ds_read_b128 v[100:103], v5 offset:34816
    s_waitcnt vmcnt(10) lgkmcnt(6)
    v_mfma_f32_32x32x16_bf16 v[16:31], v[104:107], v[196:199], v[16:31]
    v_or3_b32 v120, v120, v196, v192
    v_mfma_f32_32x32x16_bf16 v[32:47], v[196:199], v[108:111], v[32:47]
    ds_read_b128 v[104:107], v6 offset:0
    ds_read_b128 v[108:111], v6 offset:28672
    s_waitcnt vmcnt(9) lgkmcnt(6)
    v_mfma_f32_32x32x16_bf16 v[16:31], v[248:251], v[200:203], v[16:31]
    v_mfma_f32_32x32x16_bf16 v[32:47], v[200:203], v[252:255], v[32:47]
    ds_read_b128 v[248:251], v6 offset:1024
    ds_read_b128 v[252:255], v6 offset:29696
    s_waitcnt vmcnt(8) lgkmcnt(6)
    v_mfma_f32_32x32x16_bf16 v[16:31], v[240:243], v[204:207], v[16:31]
    v_or3_b32 v120, v120, v204, v200
    v_mfma_f32_32x32x16_bf16 v[32:47], v[204:207], v[244:247], v[32:47]
    v_mul_f32 v80, v80, v126
    v_mul_f32 v48, v48, v118
    v_mul_f32 v81, v81, v126
    v_mul_f32 v49, v49, v118
    ds_read_b128 v[240:243], v6 offset:2048
    ds_read_b128 v[244:247], v6 offset:30720
    s_waitcnt vmcnt(7) lgkmcnt(6)
    v_mfma_f32_32x32x16_bf16 v[16:31], v[96:99], v[208:211], v[16:31]
    v_mfma_f32_32x32x16_bf16 v[32:47], v[208:211], v[100:103], v[32:47]
    v_mul_f32 v82, v82, v126
    v_mul_f32 v50, v50, v118
    v_mul_f32 v83, v83, v126
    v_mul_f32 v51, v51, v118
    ds_read_b128 v[96:99], v6 offset:3072
    ds_read_b128 v[100:103], v6 offset:31744
    s_waitcnt vmcnt(6) lgkmcnt(6)
    v_mfma_f32_32x32x16_bf16 v[16:31], v[104:107], v[212:215], v[16:31]
    v_or3_b32 v120, v120, v212, v208
    v_mfma_f32_32x32x16_bf16 v[32:47], v[212:215], v[108:111], v[32:47]
    v_mul_f32 v84, v84, v126
    v_mul_f32 v52, v52, v118
    v_mul_f32 v85, v85, v126
    v_mul_f32 v53, v53, v118
    ds_read_b128 v[104:107], v6 offset:4096
    ds_read_b128 v[108:111], v6 offset:32768
    s_waitcnt vmcnt(5) lgkmcnt(6)
    v_mfma_f32_32x32x16_bf16 v[16:31], v[248:251], v[216:219], v[16:31]
    v_mfma_f32_32x32x16_bf16 v[32:47], v[216:219], v[252:255], v[32:47]
    v_mul_f32 v86, v86, v126
    v_mul_f32 v54, v54, v118
    v_mul_f32 v87, v87, v126
    v_mul_f32 v55, v55, v118
    ds_read_b128 v[248:251], v6 offset:5120
    ds_read_b128 v[252:255], v6 offset:33792
    s_waitcnt vmcnt(4) lgkmcnt(6)
    v_mfma_f32_32x32x16_bf16 v[16:31], v[240:243], v[220:223], v[16:31]
    v_or3_b32 v120, v120, v220, v216
    v_mfma_f32_32x32x16_bf16 v[32:47], v[220:223], v[244:247], v[32:47]
    v_mul_f32 v88, v88, v126
    v_mul_f32 v56, v56, v118
    v_mul_f32 v89, v89, v126
    v_mul_f32 v57, v57, v118
    ds_read_b128 v[240:243], v6 offset:6144
    ds_read_b128 v[244:247], v6 offset:34816
    s_waitcnt vmcnt(3) lgkmcnt(6)
    v_mfma_f32_32x32x16_bf16 v[16:31], v[96:99], v[224:227], v[16:31]
    v_mfma_f32_32x32x16_bf16 v[32:47], v[224:227], v[100:103], v[32:47]
    v_mul_f32 v90, v90, v126
    v_mul_f32 v58, v58, v118
    v_mul_f32 v91, v91, v126
    v_mul_f32 v59, v59, v118
    s_waitcnt vmcnt(2) lgkmcnt(4)
    v_mfma_f32_32x32x16_bf16 v[16:31], v[104:107], v[228:231], v[16:31]
    v_or3_b32 v120, v120, v228, v224
    v_mfma_f32_32x32x16_bf16 v[32:47], v[228:231], v[108:111], v[32:47]
    v_mul_f32 v92, v92, v126
    v_mul_f32 v60, v60, v118
    v_mul_f32 v93, v93, v126
    v_mul_f32 v61, v61, v118
    s_waitcnt vmcnt(1) lgkmcnt(2)
    v_mfma_f32_32x32x16_bf16 v[16:31], v[248:251], v[232:235], v[16:31]
    v_mfma_f32_32x32x16_bf16 v[32:47], v[232:235], v[252:255], v[32:47]
    v_mul_f32 v94, v94, v126
    v_mul_f32 v62, v62, v118
    v_mul_f32 v95, v95, v126
    v_mul_f32 v63, v63, v118
    s_waitcnt vmcnt(0) lgkmcnt(0)
    v_mfma_f32_32x32x16_bf16 v[16:31], v[240:243], v[236:239], v[16:31]
    v_or3_b32 v120, v120, v236, v232
    v_and_b32 v120, 1, v120
    v_cmp_ne_u32 vcc, 0, v120
    v_mfma_f32_32x32x16_bf16 v[32:47], v[236:239], v[244:247], v[32:47]
    s_cbranch_vccnz L_b1_slow
L_b1_ok:
    s_add_u32 s30, s84, 11812864
    s_add_u32 s31, s84, 16007168
    s_lshl_b32 s32, s3, 11
    s_add_u32 s32, s32, 86016
    v_add_u32 v11, s32, v1
    s_nop 1
    v_pk_fma_f32 v[16:17], v[16:17], v[116:117], v[48:49] op_sel_hi:[1,0,1]
    v_pk_fma_f32 v[18:19], v[18:19], v[116:117], v[50:51] op_sel_hi:[1,0,1]
    v_pk_fma_f32 v[20:21], v[20:21], v[116:117], v[52:53] op_sel_hi:[1,0,1]
    v_pk_fma_f32 v[22:23], v[22:23], v[116:117], v[54:55] op_sel_hi:[1,0,1]
    v_pk_fma_f32 v[24:25], v[24:25], v[116:117], v[56:57] op_sel_hi:[1,0,1]
    v_pk_fma_f32 v[26:27], v[26:27], v[116:117], v[58:59] op_sel_hi:[1,0,1]
    v_pk_fma_f32 v[28:29], v[28:29], v[116:117], v[60:61] op_sel_hi:[1,0,1]
    v_pk_fma_f32 v[30:31], v[30:31], v[116:117], v[62:63] op_sel_hi:[1,0,1]
    v_cvt_pk_bf16_f32 v96, v16, v17
    v_cvt_pk_bf16_f32 v97, v18, v19
    v_cvt_pk_bf16_f32 v98, v20, v21
    v_cvt_pk_bf16_f32 v99, v22, v23
    v_cvt_pk_bf16_f32 v100, v24, v25
    v_cvt_pk_bf16_f32 v101, v26, v27
    v_cvt_pk_bf16_f32 v102, v28, v29
    v_cvt_pk_bf16_f32 v103, v30, v31
    buffer_store_dwordx4 v[96:99], v1, s[8:11], s30 offen offset:0 sc1
    buffer_store_dwordx4 v[100:103], v1, s[8:11], s30 offen offset:1024 sc1
    v_pk_fma_f32 v[32:33], v[32:33], v[64:65], v[80:81]
    v_pk_fma_f32 v[34:35], v[34:35], v[66:67], v[82:83]
    v_pk_fma_f32 v[36:37], v[36:37], v[68:69], v[84:85]
    v_pk_fma_f32 v[38:39], v[38:39], v[70:71], v[86:87]
    v_pk_fma_f32 v[40:41], v[40:41], v[72:73], v[88:89]
    v_pk_fma_f32 v[42:43], v[42:43], v[74:75], v[90:91]
    v_pk_fma_f32 v[44:45], v[44:45], v[76:77], v[92:93]
    v_pk_fma_f32 v[46:47], v[46:47], v[78:79], v[94:95]
    v_cvt_pk_bf16_f32 v72, v32, v33
    v_cvt_pk_bf16_f32 v73, v34, v35
    v_cvt_pk_bf16_f32 v74, v36, v37
    v_cvt_pk_bf16_f32 v75, v38, v39
    v_cvt_pk_bf16_f32 v76, v40, v41
    v_cvt_pk_bf16_f32 v77, v42, v43
    v_cvt_pk_bf16_f32 v78, v44, v45
    v_cvt_pk_bf16_f32 v79, v46, v47
    v_cndmask_b32 v12, 0, v112, s[48:49]
    v_mov_b32 v13, v12
    s_mov_b64 exec, s[46:47]
    v_mov_b64 v[72:73], v[12:13]
    v_mov_b64 v[74:75], v[12:13]
    v_mov_b64 v[76:77], v[12:13]
    v_mov_b64 v[78:79], v[12:13]
    s_mov_b64 exec, -1
    buffer_store_dwordx4 v[72:75], v1, s[8:11], s31 offen offset:0 sc1
    buffer_store_dwordx4 v[76:79], v1, s[8:11], s31 offen offset:1024 sc1
    ds_write_b128 v11, v[96:99] offset:40960
    ds_write_b128 v11, v[100:103] offset:41984
    ds_write_b128 v11, v[72:75] offset:16384
    ds_write_b128 v11, v[76:79] offset:17408
    v_mul_f32 v116, s62, v116
    v_mul_f32 v118, s62, v118
    s_cmp_ge_u32 s4, 2
    s_cselect_b32 s28, 262144, 0
    s_sub_u32 s32, s30, s28
    s_sub_u32 s34, s31, s28
    s_cmp_ge_u32 s4, 1
    s_cselect_b32 s28, 131072, 0
    s_sub_u32 s33, s30, s28
    s_sub_u32 s35, s31, s28
    s_waitcnt vmcnt(4)
    s_barrier
    s_getpc_b64 s[40:41]
cr_67:
    s_sub_u32 s40, s40, 0x90c8
    s_subb_u32 s41, s41, 0
    s_lshr_b32 s42, s2, 3
    s_lshl_b32 s42, s42, 2
    s_add_u32 s42, s42, s3
    s_lshl_b32 s42, s42, 9
    v_lshl_add_u32 v7, v2, 7, s42
    v_min_u32 v7, 0xbb60, v7
    s_mov_b64 exec, 0xf
    global_load_dword a252, v7, s[40:41] sc1
    s_mov_b64 exec, -1
    ds_read_b128 v[88:91], v3 offset:57344
    ds_read_b128 v[92:95], v3 offset:58368
    ds_read_b128 v[96:99], v3 offset:59392
    ds_read_b128 v[100:103], v3 offset:60416
    ds_read_b128 v[104:107], v3 offset:61440
    ds_read_b128 v[108:111], v3 offset:62464
    s_waitcnt lgkmcnt(5)
    v_mfma_f32_32x32x16_bf16 v[48:63], v[88:91], v[128:131], 0
    ds_read_b128 v[88:91], v3 offset:63488
    s_waitcnt lgkmcnt(5)
    v_mfma_f32_32x32x16_bf16 v[48:63], v[92:95], v[132:135], v[48:63]
    ds_read_b128 v[92:95], v4 offset:57344
    s_waitcnt lgkmcnt(5)
    v_mfma_f32_32x32x16_bf16 v[48:63], v[96:99], v[136:139], v[48:63]
    v_accvgpr_read_b32 v72, a240
    v_accvgpr_read_b32 v73, a241
    v_accvgpr_read_b32 v74, a242
    ds_read_b128 v[96:99], v4 offset:58368
    s_waitcnt lgkmcnt(5)
    v_mfma_f32_32x32x16_bf16 v[48:63], v[100:103], v[140:143], v[48:63]
    v_accvgpr_read_b32 v75, a243
    v_accvgpr_read_b32 v76, a244
    v_accvgpr_read_b32 v77, a245
    ds_read_b128 v[100:103], v4 offset:59392
    s_waitcnt lgkmcnt(5)
    v_mfma_f32_32x32x16_bf16 v[48:63], v[104:107], v[144:147], v[48:63]
    v_accvgpr_read_b32 v78, a246
    v_accvgpr_read_b32 v79, a247
    v_mov_b32 v64, 0x3f803f80
    ds_read_b128 v[104:107], v4 offset:60416
    s_waitcnt lgkmcnt(5)
    v_mfma_f32_32x32x16_bf16 v[48:63], v[108:111], v[148:151], v[48:63]
    v_cndmask_b32 v64, v64, 0, s[44:45]
    v_mov_b32 v65, 0
    v_mov_b32 v69, 0
    ds_read_b128 v[108:111], v4 offset:61440
    s_waitcnt lgkmcnt(5)
    v_mfma_f32_32x32x16_bf16 v[48:63], v[88:91], v[152:155], v[48:63]
    v_mov_b32 v66, 0
    v_mov_b32 v70, 0
    v_mov_b32 v67, 0
    ds_read_b128 v[88:91], v4 offset:62464
    s_waitcnt lgkmcnt(5)
    v_mfma_f32_32x32x16_bf16 v[48:63], v[92:95], v[156:159], v[48:63]
    v_mov_b32 v71, 0
    ds_read_b128 v[92:95], v4 offset:63488
    s_waitcnt lgkmcnt(5)
    v_mfma_f32_32x32x16_bf16 v[48:63], v[96:99], v[160:163], v[48:63]
    ds_read_b128 v[96:99], v5 offset:57344
    s_waitcnt lgkmcnt(5)
    v_mfma_f32_32x32x16_bf16 v[48:63], v[100:103], v[164:167], v[48:63]
    ds_read_b128 v[100:103], v5 offset:58368
    s_waitcnt lgkmcnt(5)
    v_mfma_f32_32x32x16_bf16 v[48:63], v[104:107], v[168:171], v[48:63]
    buffer_load_dwordx4 v[240:243], v1, s[8:11], s32 offen offset:0 sc1
    buffer_load_dwordx4 v[244:247], v1, s[8:11], s32 offen offset:1024 sc1
    buffer_load_dwordx4 v[248:251], v1, s[8:11], s33 offen offset:0 sc1
    buffer_load_dwordx4 v[252:255], v1, s[8:11], s33 offen offset:1024 sc1
    ds_read_b128 v[104:107], v5 offset:59392
    s_waitcnt lgkmcnt(5)
    v_mfma_f32_32x32x16_bf16 v[48:63], v[108:111], v[172:175], v[48:63]
    ds_read_b128 v[108:111], v5 offset:60416
    s_waitcnt lgkmcnt(5)
    v_mfma_f32_32x32x16_bf16 v[48:63], v[88:91], v[176:179], v[48:63]
    ds_read_b128 v[88:91], v5 offset:61440
    s_waitcnt lgkmcnt(5)
    v_mfma_f32_32x32x16_bf16 v[48:63], v[92:95], v[180:183], v[48:63]
    ds_read_b128 v[92:95], v5 offset:62464
    s_waitcnt lgkmcnt(5)
    v_mfma_f32_32x32x16_bf16 v[48:63], v[96:99], v[184:187], v[48:63]
    ds_read_b128 v[96:99], v5 offset:63488
    s_waitcnt lgkmcnt(5)
    v_mfma_f32_32x32x16_bf16 v[48:63], v[100:103], v[188:191], v[48:63]
    ds_read_b128 v[100:103], v6 offset:57344
    s_waitcnt lgkmcnt(5)
    v_mfma_f32_32x32x16_bf16 v[48:63], v[104:107], v[192:195], v[48:63]
    ds_read_b128 v[104:107], v6 offset:58368
    s_waitcnt lgkmcnt(5)
    v_mfma_f32_32x32x16_bf16 v[48:63], v[108:111], v[196:199], v[48:63]
    v_accvgpr_read_b32 v12, a255
    ds_write_b32 v121, v12 offset:1024
    ds_read_b128 v[16:19], v122 offset:1152
    ds_read_b128 v[20:23], v122 offset:1184
    ds_read_b128 v[24:27], v122 offset:1216
    ds_read_b128 v[28:31], v122 offset:1248
    ds_read_b128 v[108:111], v6 offset:59392
    s_waitcnt lgkmcnt(5)
    v_mfma_f32_32x32x16_bf16 v[48:63], v[88:91], v[200:203], v[48:63]
    ds_read_b128 v[88:91], v6 offset:60416
    s_waitcnt lgkmcnt(5)
    v_mfma_f32_32x32x16_bf16 v[48:63], v[92:95], v[204:207], v[48:63]
    ds_read_b128 v[92:95], v6 offset:61440
    s_waitcnt lgkmcnt(5)
    v_mfma_f32_32x32x16_bf16 v[48:63], v[96:99], v[208:211], v[48:63]
    ds_read_b128 v[96:99], v6 offset:62464
    s_waitcnt lgkmcnt(5)
    v_mfma_f32_32x32x16_bf16 v[48:63], v[100:103], v[212:215], v[48:63]
    ds_read_b128 v[100:103], v6 offset:63488
    s_waitcnt lgkmcnt(5)
    v_mfma_f32_32x32x16_bf16 v[48:63], v[104:107], v[216:219], v[48:63]
    s_waitcnt lgkmcnt(4)
    v_mfma_f32_32x32x16_bf16 v[48:63], v[108:111], v[220:223], v[48:63]
    s_waitcnt lgkmcnt(3)
    v_mfma_f32_32x32x16_bf16 v[48:63], v[88:91], v[224:227], v[48:63]
    v_mul_f32 v16, v16, v118
    v_mul_f32 v17, v17, v118
    v_mul_f32 v18, v18, v118
    v_mul_f32 v19, v19, v118
    s_waitcnt lgkmcnt(2)
    v_mfma_f32_32x32x16_bf16 v[48:63], v[92:95], v[228:231], v[48:63]
    v_mul_f32 v20, v20, v118
    v_mul_f32 v21, v21, v118
    v_mul_f32 v22, v22, v118
    v_mul_f32 v23, v23, v118
    s_waitcnt lgkmcnt(1)
    v_mfma_f32_32x32x16_bf16 v[48:63], v[96:99], v[232:235], v[48:63]
    v_mul_f32 v24, v24, v118
    v_mul_f32 v25, v25, v118
    v_mul_f32 v26, v26, v118
    v_mul_f32 v27, v27, v118
    s_waitcnt lgkmcnt(0)
    v_mfma_f32_32x32x16_bf16 v[48:63], v[100:103], v[236:239], v[48:63]
    v_mul_f32 v28, v28, v118
    v_mul_f32 v29, v29, v118
    v_mul_f32 v30, v30, v118
    v_mul_f32 v31, v31, v118
    s_branch gk_68
gl_69:
    s_sleep 2
    buffer_load_dwordx4 v[240:243], v1, s[8:11], s32 offen offset:0 sc1
    buffer_load_dwordx4 v[244:247], v1, s[8:11], s32 offen offset:1024 sc1
    buffer_load_dwordx4 v[248:251], v1, s[8:11], s33 offen offset:0 sc1
    buffer_load_dwordx4 v[252:255], v1, s[8:11], s33 offen offset:1024 sc1
    s_add_u32 s60, s60, 1
    s_cmp_gt_u32 s60, 100000
    s_cbranch_scc1 L_exit
    s_waitcnt vmcnt(0)
gk_68:
    s_waitcnt vmcnt(0)
    v_max3_u32 v12, v240, v241, v242
    v_max3_u32 v12, v12, v243, v244
    v_max3_u32 v12, v12, v245, v246
    v_max3_u32 v12, v12, v247, v248
    v_max3_u32 v12, v12, v249, v250
    v_max3_u32 v12, v12, v251, v252
    v_max3_u32 v12, v12, v253, v254
    v_max_u32 v12, v12, v255
    v_cmp_eq_u32 vcc, -1, v12
    s_nop 0
    s_cbranch_vccnz gl_69
    v_mov_b32 v90, 0xf149
    s_cmp_lt_u32 s4, 2
    s_cselect_b32 s29, -1, 0
    s_mov_b32 s28, 0
    v_cndmask_b32 v246, v246, v90, s[28:29]
    s_cmp_lt_u32 s4, 1
    s_cselect_b32 s29, -1, 0
    s_mov_b32 s28, 0
    v_cndmask_b32 v254, v254, v90, s[28:29]
    ds_write_b128 v11, v[240:243] offset:24576
    ds_write_b128 v11, v[244:247] offset:25600
    ds_write_b128 v11, v[248:251] offset:32768
    ds_write_b128 v11, v[252:255] offset:33792
    v_pk_fma_f32 v[48:49], v[48:49], v[116:117], v[16:17] op_sel_hi:[1,0,1]
    v_pk_fma_f32 v[50:51], v[50:51], v[116:117], v[18:19] op_sel_hi:[1,0,1]
    v_pk_fma_f32 v[52:53], v[52:53], v[116:117], v[20:21] op_sel_hi:[1,0,1]
    v_pk_fma_f32 v[54:55], v[54:55], v[116:117], v[22:23] op_sel_hi:[1,0,1]
    v_pk_fma_f32 v[56:57], v[56:57], v[116:117], v[24:25] op_sel_hi:[1,0,1]
    v_pk_fma_f32 v[58:59], v[58:59], v[116:117], v[26:27] op_sel_hi:[1,0,1]
    v_pk_fma_f32 v[60:61], v[60:61], v[116:117], v[28:29] op_sel_hi:[1,0,1]
    v_pk_fma_f32 v[62:63], v[62:63], v[116:117], v[30:31] op_sel_hi:[1,0,1]
    v_cvt_pk_bf16_f32 v80, v48, v49
    v_cvt_pk_bf16_f32 v81, v50, v51
    v_cvt_pk_bf16_f32 v82, v52, v53
    v_cvt_pk_bf16_f32 v83, v54, v55
    v_cvt_pk_bf16_f32 v84, v56, v57
    v_cvt_pk_bf16_f32 v85, v58, v59
    v_cvt_pk_bf16_f32 v86, v60, v61
    v_cvt_pk_bf16_f32 v87, v62, v63
    v_cndmask_b32 v86, v86, 0, s[44:45]
    v_cndmask_b32 v87, v87, 0, s[44:45]
    v_mov_b32 v89, 0x3f80
    v_cndmask_b32 v86, v86, v89, s[44:45]
    s_waitcnt lgkmcnt(0)
    s_barrier
    ds_read_b128 v[16:19], v11 offset:24576
    ds_read_b128 v[20:23], v11 offset:25600
    ds_read_b128 v[24:27], v11 offset:40960
    ds_read_b128 v[28:31], v11 offset:41984
    ds_read_b128 v[32:35], v11 offset:26624
    ds_read_b128 v[36:39], v11 offset:27648
    ds_read_b128 v[40:43], v11 offset:28672
    ds_read_b128 v[44:47], v11 offset:29696
    s_waitcnt lgkmcnt(6)
    v_mfma_f32_32x32x16_bf16 v[96:111], v[16:19], v[80:83], 0
    v_mfma_f32_32x32x16_bf16 v[96:111], v[20:23], v[84:87], v[96:111]
    ds_read_b128 v[16:19], v11 offset:30720
    ds_read_b128 v[20:23], v11 offset:31744
    s_waitcnt lgkmcnt(6)
    v_mfma_f32_32x32x16_bf16 v[224:239], v[24:27], v[80:83], 0
    v_mfma_f32_32x32x16_bf16 v[224:239], v[28:31], v[84:87], v[224:239]
    ds_read_b128 v[24:27], v11 offset:32768
    ds_read_b128 v[28:31], v11 offset:33792
    s_waitcnt lgkmcnt(6)
    v_mfma_f32_32x32x16_bf16 v[112:127], v[32:35], v[80:83], 0
    v_mfma_f32_32x32x16_bf16 v[112:127], v[36:39], v[84:87], v[112:127]
    buffer_load_dwordx4 v[240:243], v1, s[8:11], s34 offen offset:0 sc1
    buffer_load_dwordx4 v[244:247], v1, s[8:11], s34 offen offset:1024 sc1
    buffer_load_dwordx4 v[248:251], v1, s[8:11], s35 offen offset:0 sc1
    buffer_load_dwordx4 v[252:255], v1, s[8:11], s35 offen offset:1024 sc1
    ds_read_b128 v[32:35], v11 offset:34816
    ds_read_b128 v[36:39], v11 offset:35840
    s_waitcnt lgkmcnt(6)
    v_mfma_f32_32x32x16_bf16 v[128:143], v[40:43], v[80:83], 0
    v_cndmask_b32 v96, v224, v96, s[64:65]
    v_cndmask_b32 v97, v225, v97, s[66:67]
    v_cndmask_b32 v98, v226, v98, s[68:69]
    v_cndmask_b32 v99, v227, v99, s[70:71]
    v_cndmask_b32 v100, v228, v100, s[72:73]
    v_cndmask_b32 v101, v229, v101, s[74:75]
    v_mfma_f32_32x32x16_bf16 v[128:143], v[44:47], v[84:87], v[128:143]
    v_cndmask_b32 v102, v230, v102, s[76:77]
    v_cndmask_b32 v103, v231, v103, s[78:79]
    v_cndmask_b32 v104, v232, v104, s[80:81]
    v_cndmask_b32 v105, v233, v105, s[20:21]
    ds_read_b128 v[40:43], v11 offset:36864
    ds_read_b128 v[44:47], v11 offset:37888
    s_waitcnt lgkmcnt(6)
    v_mfma_f32_32x32x16_bf16 v[144:159], v[16:19], v[80:83], 0
    v_cndmask_b32 v106, v234, v106, s[22:23]
    v_cndmask_b32 v107, v235, v107, s[24:25]
    v_cndmask_b32 v108, v236, v108, s[26:27]
    v_cndmask_b32 v109, v237, v109, s[94:95]
    v_cndmask_b32 v110, v238, v110, s[96:97]
    v_cndmask_b32 v111, v239, v111, s[98:99]
    v_mfma_f32_32x32x16_bf16 v[144:159], v[20:23], v[84:87], v[144:159]
    v_max_f32 v91, v96, v97
    v_max3_f32 v91, v91, v98, v99
    v_max3_f32 v91, v91, v100, v101
    v_max3_f32 v91, v91, v102, v103
    ds_read_b128 v[16:19], v11 offset:38912
    ds_read_b128 v[20:23], v11 offset:39936
    s_waitcnt lgkmcnt(6)
    v_mfma_f32_32x32x16_bf16 v[160:175], v[24:27], v[80:83], 0
    v_max3_f32 v91, v91, v104, v105
    v_max3_f32 v91, v91, v106, v107
    v_max3_f32 v91, v91, v108, v109
    v_max3_f32 v91, v91, v110, v111
    v_max3_f32 v91, v91, v112, v113
    v_max3_f32 v91, v91, v114, v115
    v_mfma_f32_32x32x16_bf16 v[160:175], v[28:31], v[84:87], v[160:175]
    v_max3_f32 v91, v91, v116, v117
    v_max3_f32 v91, v91, v118, v119
    v_max3_f32 v91, v91, v120, v121
    v_max3_f32 v91, v91, v122, v123
    s_waitcnt lgkmcnt(4)
    v_mfma_f32_32x32x16_bf16 v[176:191], v[32:35], v[80:83], 0
    v_max3_f32 v91, v91, v124, v125
    v_max3_f32 v91, v91, v126, v127
    v_max3_f32 v91, v91, v128, v129
    v_max3_f32 v91, v91, v130, v131
    v_max3_f32 v91, v91, v132, v133
    v_max3_f32 v91, v91, v134, v135
    v_mfma_f32_32x32x16_bf16 v[176:191], v[36:39], v[84:87], v[176:191]
    v_max3_f32 v91, v91, v136, v137
    v_max3_f32 v91, v91, v138, v139
    v_max3_f32 v91, v91, v140, v141
    v_max3_f32 v91, v91, v142, v143
    s_waitcnt lgkmcnt(2)
    v_mfma_f32_32x32x16_bf16 v[192:207], v[40:43], v[80:83], 0
    v_max3_f32 v91, v91, v144, v145
    v_max3_f32 v91, v91, v146, v147
    v_max3_f32 v91, v91, v148, v149
    v_max3_f32 v91, v91, v150, v151
    v_max3_f32 v91, v91, v152, v153
    v_max3_f32 v91, v91, v154, v155
    v_mfma_f32_32x32x16_bf16 v[192:207], v[44:47], v[84:87], v[192:207]
    v_max3_f32 v91, v91, v156, v157
    v_max3_f32 v91, v91, v158, v159
    v_max3_f32 v91, v91, v160, v161
    v_max3_f32 v91, v91, v162, v163
    s_waitcnt lgkmcnt(0)
    v_mfma_f32_32x32x16_bf16 v[208:223], v[16:19], v[80:83], 0
    v_max3_f32 v91, v91, v164, v165
    v_max3_f32 v91, v91, v166, v167
    v_max3_f32 v91, v91, v168, v169
    v_max3_f32 v91, v91, v170, v171
    v_max3_f32 v91, v91, v172, v173
    v_max3_f32 v91, v91, v174, v175
    v_mfma_f32_32x32x16_bf16 v[208:223], v[20:23], v[84:87], v[208:223]
    v_max3_f32 v91, v91, v176, v177
    v_max3_f32 v91, v91, v178, v179
    v_max3_f32 v91, v91, v180, v181
    v_max3_f32 v91, v91, v182, v183
    v_max3_f32 v91, v91, v184, v185
    v_max3_f32 v91, v91, v186, v187
    v_max3_f32 v91, v91, v188, v189
    v_max3_f32 v91, v91, v190, v191
    v_max3_f32 v91, v91, v192, v193
    v_max3_f32 v91, v91, v194, v195
    v_max3_f32 v91, v91, v196, v197
    v_max3_f32 v91, v91, v198, v199
    v_max3_f32 v91, v91, v200, v201
    v_max3_f32 v91, v91, v202, v203
    v_max3_f32 v91, v91, v204, v205
    v_max3_f32 v91, v91, v206, v207
    v_max3_f32 v91, v91, v208, v209
    v_max3_f32 v91, v91, v210, v211
    v_max3_f32 v91, v91, v212, v213
    v_max3_f32 v91, v91, v214, v215
    v_max3_f32 v91, v91, v216, v217
    v_max3_f32 v91, v91, v218, v219
    v_max3_f32 v91, v91, v220, v221
    v_max3_f32 v91, v91, v222, v223
    v_mov_b32 v92, v91
    s_nop 1
    v_permlane32_swap_b32 v91, v92
    v_max_f32 v91, v91, v92
    v_and_b32 v92, 0xffff0000, v91
    v_sub_f32 v93, v92, v91
    v_cvt_pk_bf16_f32 v68, -v92, v93
    v_and_b32 v94, 0xffff0000, v68
    v_sub_f32 v94, v94, v92
    v_pk_add_f32 v[96:97], v[96:97], v[94:95] op_sel_hi:[1,0]
    v_pk_add_f32 v[98:99], v[98:99], v[94:95] op_sel_hi:[1,0]
    v_pk_add_f32 v[100:101], v[100:101], v[94:95] op_sel_hi:[1,0]
    v_pk_add_f32 v[102:103], v[102:103], v[94:95] op_sel_hi:[1,0]
    v_pk_add_f32 v[104:105], v[104:105], v[94:95] op_sel_hi:[1,0]
    v_pk_add_f32 v[106:107], v[106:107], v[94:95] op_sel_hi:[1,0]
    v_pk_add_f32 v[108:109], v[108:109], v[94:95] op_sel_hi:[1,0]
    v_pk_add_f32 v[110:111], v[110:111], v[94:95] op_sel_hi:[1,0]
    v_mfma_f32_32x32x16_bf16 v[112:127], v[64:67], v[68:71], v[112:127]
    v_exp_f32 v96, v96
    v_exp_f32 v97, v97
    v_exp_f32 v98, v98
    v_exp_f32 v99, v99
    v_mfma_f32_32x32x16_bf16 v[128:143], v[64:67], v[68:71], v[128:143]
    v_exp_f32 v100, v100
    v_exp_f32 v101, v101
    v_exp_f32 v102, v102
    v_exp_f32 v103, v103
    v_exp_f32 v104, v104
    v_cvt_pk_bf16_f32 v96, v96, v97
    v_cvt_pk_bf16_f32 v97, v98, v99
    v_cvt_pk_bf16_f32 v98, v100, v101
    v_cvt_pk_bf16_f32 v99, v102, v103
    v_exp_f32 v105, v105
    v_mfma_f32_32x32x16_bf16 v[144:159], v[64:67], v[68:71], v[144:159]
    v_exp_f32 v106, v106
    v_exp_f32 v107, v107
    v_exp_f32 v108, v108
    v_exp_f32 v109, v109
    v_exp_f32 v110, v110
    v_exp_f32 v111, v111
    v_cvt_pk_bf16_f32 v100, v104, v105
    v_cvt_pk_bf16_f32 v101, v106, v107
    v_cvt_pk_bf16_f32 v102, v108, v109
    v_cvt_pk_bf16_f32 v103, v110, v111
    v_bfi_b32 v224, v72, 0, v96
    v_and_b32 v96, v96, v72
    v_bfi_b32 v225, v73, 0, v97
    v_and_b32 v97, v97, v73
    v_bfi_b32 v226, v74, 0, v98
    v_and_b32 v98, v98, v74
    v_bfi_b32 v227, v75, 0, v99
    v_and_b32 v99, v99, v75
    v_bfi_b32 v228, v76, 0, v100
    v_and_b32 v100, v100, v76
    v_bfi_b32 v229, v77, 0, v101
    v_and_b32 v101, v101, v77
    v_bfi_b32 v230, v78, 0, v102
    v_and_b32 v102, v102, v78
    v_bfi_b32 v231, v79, 0, v103
    v_and_b32 v103, v103, v79
    v_exp_f32 v112, v112
    v_exp_f32 v113, v113
    v_exp_f32 v114, v114
    v_exp_f32 v115, v115
    v_mfma_f32_32x32x16_bf16 v[160:175], v[64:67], v[68:71], v[160:175]
    v_exp_f32 v116, v116
    v_exp_f32 v117, v117
    v_exp_f32 v118, v118
    v_exp_f32 v119, v119
    v_exp_f32 v120, v120
    v_cvt_pk_bf16_f32 v112, v112, v113
    v_cvt_pk_bf16_f32 v113, v114, v115
    v_cvt_pk_bf16_f32 v114, v116, v117
    v_cvt_pk_bf16_f32 v115, v118, v119
    v_exp_f32 v121, v121
    v_mfma_f32_32x32x16_bf16 v[176:191], v[64:67], v[68:71], v[176:191]
    v_exp_f32 v122, v122
    v_exp_f32 v123, v123
    v_exp_f32 v124, v124
    v_exp_f32 v125, v125
    v_exp_f32 v126, v126
    v_exp_f32 v127, v127
    v_cvt_pk_bf16_f32 v116, v120, v121
    v_cvt_pk_bf16_f32 v117, v122, v123
    v_cvt_pk_bf16_f32 v118, v124, v125
    v_cvt_pk_bf16_f32 v119, v126, v127
    s_branch gk_70
gl_71:
    s_sleep 2
    buffer_load_dwordx4 v[240:243], v1, s[8:11], s34 offen offset:0 sc1
    buffer_load_dwordx4 v[244:247], v1, s[8:11], s34 offen offset:1024 sc1
    buffer_load_dwordx4 v[248:251], v1, s[8:11], s35 offen offset:0 sc1
    buffer_load_dwordx4 v[252:255], v1, s[8:11], s35 offen offset:1024 sc1
    s_add_u32 s60, s60, 1
    s_cmp_gt_u32 s60, 100000
    s_cbranch_scc1 L_exit
    s_waitcnt vmcnt(0)
gk_70:
    s_waitcnt vmcnt(0)
    v_max3_u32 v12, v240, v241, v242
    v_max3_u32 v12, v12, v243, v244
    v_max3_u32 v12, v12, v245, v246
    v_max3_u32 v12, v12, v247, v248
    v_max3_u32 v12, v12, v249, v250
    v_max3_u32 v12, v12, v251, v252
    v_max3_u32 v12, v12, v253, v254
    v_max_u32 v12, v12, v255
    v_cmp_eq_u32 vcc, -1, v12
    s_nop 0
    s_cbranch_vccnz gl_71
    ds_write_b128 v11, v[240:243] offset:0
    ds_write_b128 v11, v[244:247] offset:1024
    ds_write_b128 v11, v[248:251] offset:8192
    ds_write_b128 v11, v[252:255] offset:9216
    v_exp_f32 v128, v128
    v_exp_f32 v129, v129
    v_exp_f32 v130, v130
    v_exp_f32 v131, v131
    v_mfma_f32_32x32x16_bf16 v[192:207], v[64:67], v[68:71], v[192:207]
    v_exp_f32 v132, v132
    v_exp_f32 v133, v133
    v_exp_f32 v134, v134
    v_exp_f32 v135, v135
    v_exp_f32 v136, v136
    v_cvt_pk_bf16_f32 v128, v128, v129
    v_cvt_pk_bf16_f32 v129, v130, v131
    v_cvt_pk_bf16_f32 v130, v132, v133
    v_cvt_pk_bf16_f32 v131, v134, v135
    v_exp_f32 v137, v137
    v_mfma_f32_32x32x16_bf16 v[208:223], v[64:67], v[68:71], v[208:223]
    v_exp_f32 v138, v138
    v_exp_f32 v139, v139
    v_exp_f32 v140, v140
    v_exp_f32 v141, v141
    v_exp_f32 v142, v142
    v_exp_f32 v143, v143
    v_cvt_pk_bf16_f32 v132, v136, v137
    v_cvt_pk_bf16_f32 v133, v138, v139
    v_cvt_pk_bf16_f32 v134, v140, v141
    v_cvt_pk_bf16_f32 v135, v142, v143
    s_waitcnt lgkmcnt(0)
    s_barrier
    ds_read_b128 v[16:19], v11 offset:0
    ds_read_b128 v[20:23], v11 offset:1024
    ds_read_b128 v[24:27], v11 offset:16384
    ds_read_b128 v[28:31], v11 offset:17408
    ds_read_b128 v[32:35], v11 offset:2048
    ds_read_b128 v[36:39], v11 offset:3072
    v_exp_f32 v144, v144
    v_exp_f32 v145, v145
    v_exp_f32 v146, v146
    ds_read_b128 v[40:43], v11 offset:4096
    ds_read_b128 v[44:47], v11 offset:5120
    s_waitcnt lgkmcnt(6)
    v_mfma_f32_32x32x16_bf16 v[48:63], v[16:19], v[96:99], 0
    v_exp_f32 v147, v147
    v_exp_f32 v148, v148
    v_exp_f32 v149, v149
    v_mfma_f32_32x32x16_bf16 v[48:63], v[20:23], v[100:103], v[48:63]
    v_exp_f32 v150, v150
    v_exp_f32 v151, v151
    v_exp_f32 v152, v152
    ds_read_b128 v[16:19], v11 offset:6144
    ds_read_b128 v[20:23], v11 offset:7168
    s_waitcnt lgkmcnt(6)
    v_mfma_f32_32x32x16_bf16 v[48:63], v[24:27], v[224:227], v[48:63]
    v_cvt_pk_bf16_f32 v144, v144, v145
    v_cvt_pk_bf16_f32 v145, v146, v147
    v_cvt_pk_bf16_f32 v146, v148, v149
    v_cvt_pk_bf16_f32 v147, v150, v151
    v_exp_f32 v153, v153
    v_exp_f32 v154, v154
    v_exp_f32 v155, v155
    v_mfma_f32_32x32x16_bf16 v[48:63], v[28:31], v[228:231], v[48:63]
    v_exp_f32 v156, v156
    v_exp_f32 v157, v157
    v_exp_f32 v158, v158
    ds_read_b128 v[24:27], v11 offset:8192
    ds_read_b128 v[28:31], v11 offset:9216
    s_waitcnt lgkmcnt(6)
    v_mfma_f32_32x32x16_bf16 v[48:63], v[32:35], v[112:115], v[48:63]
    v_exp_f32 v159, v159
    v_cvt_pk_bf16_f32 v148, v152, v153
    v_cvt_pk_bf16_f32 v149, v154, v155
    v_cvt_pk_bf16_f32 v150, v156, v157
    v_cvt_pk_bf16_f32 v151, v158, v159
    v_exp_f32 v160, v160
    v_exp_f32 v161, v161
    v_exp_f32 v162, v162
    v_mfma_f32_32x32x16_bf16 v[48:63], v[36:39], v[116:119], v[48:63]
    v_exp_f32 v163, v163
    v_exp_f32 v164, v164
    v_exp_f32 v165, v165
    ds_read_b128 v[32:35], v11 offset:10240
    ds_read_b128 v[36:39], v11 offset:11264
    s_waitcnt lgkmcnt(6)
    v_mfma_f32_32x32x16_bf16 v[48:63], v[40:43], v[128:131], v[48:63]
    v_exp_f32 v166, v166
    v_exp_f32 v167, v167
    v_exp_f32 v168, v168
    v_mfma_f32_32x32x16_bf16 v[48:63], v[44:47], v[132:135], v[48:63]
    v_cvt_pk_bf16_f32 v160, v160, v161
    v_cvt_pk_bf16_f32 v161, v162, v163
    v_cvt_pk_bf16_f32 v162, v164, v165
    v_cvt_pk_bf16_f32 v163, v166, v167
    v_exp_f32 v169, v169
    v_exp_f32 v170, v170
    v_exp_f32 v171, v171
    ds_read_b128 v[40:43], v11 offset:12288
    ds_read_b128 v[44:47], v11 offset:13312
    s_waitcnt lgkmcnt(6)
    v_mfma_f32_32x32x16_bf16 v[48:63], v[16:19], v[144:147], v[48:63]
    v_exp_f32 v172, v172
    v_exp_f32 v173, v173
    v_exp_f32 v174, v174
    v_mfma_f32_32x32x16_bf16 v[48:63], v[20:23], v[148:151], v[48:63]
    v_exp_f32 v175, v175
    v_cvt_pk_bf16_f32 v164, v168, v169
    v_cvt_pk_bf16_f32 v165, v170, v171
    v_cvt_pk_bf16_f32 v166, v172, v173
    v_cvt_pk_bf16_f32 v167, v174, v175
    v_exp_f32 v176, v176
    v_exp_f32 v177, v177
    v_exp_f32 v178, v178
    ds_read_b128 v[16:19], v11 offset:14336
    ds_read_b128 v[20:23], v11 offset:15360
    s_waitcnt lgkmcnt(6)
    v_mfma_f32_32x32x16_bf16 v[48:63], v[24:27], v[160:163], v[48:63]
    v_exp_f32 v179, v179
    v_exp_f32 v180, v180
    v_exp_f32 v181, v181
    v_mfma_f32_32x32x16_bf16 v[48:63], v[28:31], v[164:167], v[48:63]
    v_exp_f32 v182, v182
    v_exp_f32 v183, v183
    v_exp_f32 v184, v184
    v_cvt_pk_bf16_f32 v176, v176, v177
    v_cvt_pk_bf16_f32 v177, v178, v179
    v_cvt_pk_bf16_f32 v178, v180, v181
    v_cvt_pk_bf16_f32 v179, v182, v183
    v_exp_f32 v185, v185
    v_exp_f32 v186, v186
    v_exp_f32 v187, v187
    v_exp_f32 v188, v188
    v_exp_f32 v189, v189
    v_exp_f32 v190, v190
    v_exp_f32 v191, v191
    v_cvt_pk_bf16_f32 v180, v184, v185
    v_cvt_pk_bf16_f32 v181, v186, v187
    v_cvt_pk_bf16_f32 v182, v188, v189
    v_cvt_pk_bf16_f32 v183, v190, v191
    v_exp_f32 v192, v192
    v_exp_f32 v193, v193
    v_exp_f32 v194, v194
    s_waitcnt lgkmcnt(4)
    v_mfma_f32_32x32x16_bf16 v[48:63], v[32:35], v[176:179], v[48:63]
    v_exp_f32 v195, v195
    v_exp_f32 v196, v196
    v_exp_f32 v197, v197
    v_mfma_f32_32x32x16_bf16 v[48:63], v[36:39], v[180:183], v[48:63]
    v_exp_f32 v198, v198
    v_exp_f32 v199, v199
    v_exp_f32 v200, v200
    v_cvt_pk_bf16_f32 v192, v192, v193
    v_cvt_pk_bf16_f32 v193, v194, v195
    v_cvt_pk_bf16_f32 v194, v196, v197
    v_cvt_pk_bf16_f32 v195, v198, v199
    v_exp_f32 v201, v201
    v_exp_f32 v202, v202
    v_exp_f32 v203, v203
    v_exp_f32 v204, v204
    v_exp_f32 v205, v205
    v_exp_f32 v206, v206
    v_exp_f32 v207, v207
    v_cvt_pk_bf16_f32 v196, v200, v201
    v_cvt_pk_bf16_f32 v197, v202, v203
    v_cvt_pk_bf16_f32 v198, v204, v205
    v_cvt_pk_bf16_f32 v199, v206, v207
    v_exp_f32 v208, v208
    v_exp_f32 v209, v209
    v_exp_f32 v210, v210
    s_waitcnt lgkmcnt(2)
    v_mfma_f32_32x32x16_bf16 v[48:63], v[40:43], v[192:195], v[48:63]
    v_exp_f32 v211, v211
    v_exp_f32 v212, v212
    v_exp_f32 v213, v213
    v_mfma_f32_32x32x16_bf16 v[48:63], v[44:47], v[196:199], v[48:63]
    v_exp_f32 v214, v214
    v_exp_f32 v215, v215
    v_exp_f32 v216, v216
    v_cvt_pk_bf16_f32 v208, v208, v209
    v_cvt_pk_bf16_f32 v209, v210, v211
    v_cvt_pk_bf16_f32 v210, v212, v213
    v_cvt_pk_bf16_f32 v211, v214, v215
    v_exp_f32 v217, v217
    v_exp_f32 v218, v218
    v_exp_f32 v219, v219
    v_exp_f32 v220, v220
    v_exp_f32 v221, v221
    v_exp_f32 v222, v222
    v_exp_f32 v223, v223
    v_cvt_pk_bf16_f32 v212, v216, v217
    v_cvt_pk_bf16_f32 v213, v218, v219
    v_cvt_pk_bf16_f32 v214, v220, v221
    v_cvt_pk_bf16_f32 v215, v222, v223
    s_waitcnt lgkmcnt(0)
    v_mfma_f32_32x32x16_bf16 v[48:63], v[16:19], v[208:211], v[48:63]
    v_mfma_f32_32x32x16_bf16 v[48:63], v[20:23], v[212:215], v[48:63]
    s_nop 11
    v_mov_b32 v12, v60
    v_mov_b32 v13, v60
    s_mul_i32 s28, s5, 7
    s_lshr_b32 s28, s28, 1
    s_lshl_b32 s28, s28, 9
    s_add_u32 s28, s28, s50
    s_add_u32 s28, s28, 5652480
    v_permlane32_swap_b32 v12, v13
    v_rcp_f32 v12, v13
    s_nop 0
    v_pk_mul_f32 v[48:49], v[48:49], v[12:13] op_sel_hi:[1,0]
    v_pk_mul_f32 v[50:51], v[50:51], v[12:13] op_sel_hi:[1,0]
    v_pk_mul_f32 v[52:53], v[52:53], v[12:13] op_sel_hi:[1,0]
    v_pk_mul_f32 v[54:55], v[54:55], v[12:13] op_sel_hi:[1,0]
    v_pk_mul_f32 v[56:57], v[56:57], v[12:13] op_sel_hi:[1,0]
    v_pk_mul_f32 v[58:59], v[58:59], v[12:13] op_sel_hi:[1,0]
    v_pk_mul_f32 v[60:61], v[60:61], v[12:13] op_sel_hi:[1,0]
    v_pk_mul_f32 v[62:63], v[62:63], v[12:13] op_sel_hi:[1,0]
    v_cvt_pk_bf16_f32 v48, v48, v49
    v_cvt_pk_bf16_f32 v49, v50, v51
    v_cvt_pk_bf16_f32 v50, v52, v53
    v_cvt_pk_bf16_f32 v51, v54, v55
    v_cvt_pk_bf16_f32 v52, v56, v57
    v_cvt_pk_bf16_f32 v53, v58, v59
    v_cvt_pk_bf16_f32 v54, v60, v61
    v_cvt_pk_bf16_f32 v55, v62, v63
    v_or_b32 v48, 1, v48
    v_or_b32 v50, 1, v50
    v_or_b32 v52, 1, v52
    v_or_b32 v54, 1, v54
    s_bitcmp1_b32 s5, 0
    s_cbranch_scc1 oo_72
    v_permlane32_swap_b32 v48, v50
    v_permlane32_swap_b32 v49, v51
    v_permlane32_swap_b32 v52, v54
    v_permlane32_swap_b32 v53, v55
    s_cmp_eq_u32 s6, 0
    s_cbranch_scc1 ls_74
    buffer_store_dwordx4 v[48:51], v1, s[8:11], s28 offen
    s_mov_b32 exec_hi, 0
    buffer_store_dwordx4 v[52:55], v1, s[8:11], s28 offen offset:1024
    s_not_b64 exec, exec
    buffer_store_dwordx2 v[52:53], v1, s[8:11], s28 offen offset:1024
    s_mov_b64 exec, -1
le_75:
    s_branch od_73
oo_72:
    s_nop 1
    v_permlane32_swap_b32 v50, v50
    v_permlane32_swap_b32 v51, v51
    v_permlane32_swap_b32 v54, v54
    v_permlane32_swap_b32 v55, v55
    s_cmp_eq_u32 s6, 0
    s_cbranch_scc1 ls_76
    s_mov_b32 exec_lo, 0
    buffer_store_dwordx4 v[48:51], v1, s[8:11], s28 offen
    buffer_store_dwordx4 v[52:55], v1, s[8:11], s28 offen offset:1024
    s_not_b64 exec, exec
    buffer_store_dwordx4 v[50:53], v1, s[8:11], s28 offen offset:1024
    buffer_store_dwordx2 v[48:49], v1, s[8:11], s28 offen offset:8
    s_mov_b64 exec, -1
le_77:
od_73:
    s_nop 1
    s_add_u32 s28, s52, s56
    s_add_u32 s28, s28, 5652480
    s_add_u32 s29, s28, 4096
    v_add_u32 v112, 135168, v3
    v_add_u32 v113, 135168, v4
    v_add_u32 v114, 135168, v5
    v_add_u32 v115, 135168, v6
    s_mov_b64 s[16:17], s[82:83]
    v_and_b32 v200, 31, v2
    v_mul_u32_u24 v200, 896, v200
    v_lshrrev_b32 v201, 5, v2
    v_lshl_add_u32 v200, v201, 4, v200
    s_lshl_b32 s30, s54, 6
    s_add_u32 s30, s30, s52
    v_accvgpr_read_b32 v192, a224
    v_accvgpr_read_b32 v193, a225
    v_accvgpr_read_b32 v194, a226
    v_accvgpr_read_b32 v195, a227
    v_accvgpr_read_b32 v196, a228
    v_accvgpr_read_b32 v197, a229
    v_accvgpr_read_b32 v198, a230
    v_accvgpr_read_b32 v199, a231
    v_permlane32_swap_b32 v192, v194
    v_permlane32_swap_b32 v193, v195
    v_permlane32_swap_b32 v196, v198
    v_permlane32_swap_b32 v197, v199
    v_lshlrev_b32 v96, 16, v192
    v_and_b32 v97, 0xffff0000, v192
    v_lshlrev_b32 v98, 16, v193
    v_and_b32 v99, 0xffff0000, v193
    v_lshlrev_b32 v100, 16, v194
    v_and_b32 v101, 0xffff0000, v194
    v_lshlrev_b32 v102, 16, v195
    v_and_b32 v103, 0xffff0000, v195
    v_lshlrev_b32 v104, 16, v196
    v_and_b32 v105, 0xffff0000, v196
    v_lshlrev_b32 v106, 16, v197
    v_and_b32 v107, 0xffff0000, v197
    v_lshlrev_b32 v108, 16, v198
    v_and_b32 v109, 0xffff0000, v198
    v_lshlrev_b32 v110, 16, v199
    v_and_b32 v111, 0xffff0000, v199
    buffer_load_dwordx4 v[128:131], v1, s[8:11], s28 offen offset:0 sc1
    buffer_load_dwordx4 v[132:135], v1, s[8:11], s28 offen offset:1024 sc1
    buffer_load_dwordx4 v[136:139], v1, s[8:11], s28 offen offset:2048 sc1
    buffer_load_dwordx4 v[140:143], v1, s[8:11], s28 offen offset:3072 sc1
    buffer_load_dwordx4 v[144:147], v1, s[8:11], s29 offen offset:0 sc1
    buffer_load_dwordx4 v[148:151], v1, s[8:11], s29 offen offset:1024 sc1
    buffer_load_dwordx4 v[152:155], v1, s[8:11], s29 offen offset:2048 sc1
    s_branch L_wob1_w
L_wob1_g:
    s_waitcnt lgkmcnt(0)
    buffer_load_dwordx4 v[128:131], v1, s[8:11], s28 offen offset:0 sc1
    buffer_load_dwordx4 v[132:135], v1, s[8:11], s28 offen offset:1024 sc1
    buffer_load_dwordx4 v[136:139], v1, s[8:11], s28 offen offset:2048 sc1
    buffer_load_dwordx4 v[140:143], v1, s[8:11], s28 offen offset:3072 sc1
    buffer_load_dwordx4 v[144:147], v1, s[8:11], s29 offen offset:0 sc1
    buffer_load_dwordx4 v[148:151], v1, s[8:11], s29 offen offset:1024 sc1
    buffer_load_dwordx4 v[152:155], v1, s[8:11], s29 offen offset:2048 sc1
    s_add_u32 s60, s60, 1
    s_cmp_gt_u32 s60, 100000
    s_cbranch_scc1 L_exit
L_wob1_w:
    s_waitcnt vmcnt(6)
    ds_write_b128 v112, v[128:131] offset:0
    v_bitop3_b32 v120, v128, v128, v130 bitop3:0x80
    s_waitcnt vmcnt(5)
    ds_write_b128 v112, v[132:135] offset:1024
    v_bitop3_b32 v120, v120, v132, v134 bitop3:0x80
    s_waitcnt vmcnt(4)
    ds_write_b128 v112, v[136:139] offset:2048
    v_bitop3_b32 v120, v120, v136, v138 bitop3:0x80
    s_waitcnt vmcnt(3)
    ds_write_b128 v112, v[140:143] offset:3072
    v_bitop3_b32 v120, v120, v140, v142 bitop3:0x80
    s_waitcnt vmcnt(2)
    ds_write_b128 v112, v[144:147] offset:4096
    v_bitop3_b32 v120, v120, v144, v146 bitop3:0x80
    s_waitcnt vmcnt(1)
    ds_write_b128 v112, v[148:151] offset:5120
    v_bitop3_b32 v120, v120, v148, v150 bitop3:0x80
    s_waitcnt vmcnt(0)
    ds_write_b128 v112, v[152:155] offset:6144
    v_bitop3_b32 v120, v120, v152, v154 bitop3:0x80
    v_and_b32 v120, 1, v120
    v_cmp_ne_u32 vcc, 1, v120
    s_nop 0
    s_cbranch_vccnz L_wob1_g
L_wob1_ok:
    v_mfma_f32_32x32x16_bf16 v[96:111], a[112:115], v[128:131], v[96:111]
    s_waitcnt lgkmcnt(0)
    s_barrier
    ds_read_b128 v[188:191], v113 offset:0
    ds_read_b128 v[160:163], v113 offset:1024
    ds_read_b128 v[164:167], v113 offset:2048
    v_mfma_f32_32x32x16_bf16 v[96:111], a[116:119], v[132:135], v[96:111]
    ds_read_b128 v[168:171], v113 offset:3072
    v_mfma_f32_32x32x16_bf16 v[96:111], a[120:123], v[136:139], v[96:111]
    ds_read_b128 v[172:175], v113 offset:4096
    v_mfma_f32_32x32x16_bf16 v[96:111], a[124:127], v[140:143], v[96:111]
    ds_read_b128 v[176:179], v113 offset:5120
    v_mfma_f32_32x32x16_bf16 v[96:111], a[128:131], v[144:147], v[96:111]
    ds_read_b128 v[180:183], v113 offset:6144
    v_mfma_f32_32x32x16_bf16 v[96:111], a[132:135], v[148:151], v[96:111]
    v_mfma_f32_32x32x16_bf16 v[96:111], a[136:139], v[152:155], v[96:111]
    ds_read_b128 v[184:187], v114 offset:0
    s_waitcnt lgkmcnt(7)
    v_mfma_f32_32x32x16_bf16 v[96:111], a[140:143], v[188:191], v[96:111]
    ds_read_b128 v[188:191], v114 offset:1024
    s_waitcnt lgkmcnt(7)
    v_mfma_f32_32x32x16_bf16 v[96:111], a[144:147], v[160:163], v[96:111]
    ds_read_b128 v[160:163], v114 offset:2048
    s_waitcnt lgkmcnt(7)
    v_mfma_f32_32x32x16_bf16 v[96:111], a[148:151], v[164:167], v[96:111]
    ds_read_b128 v[164:167], v114 offset:3072
    s_waitcnt lgkmcnt(7)
    v_mfma_f32_32x32x16_bf16 v[96:111], a[152:155], v[168:171], v[96:111]
    ds_read_b128 v[168:171], v114 offset:4096
    s_waitcnt lgkmcnt(7)
    v_mfma_f32_32x32x16_bf16 v[96:111], a[156:159], v[172:175], v[96:111]
    ds_read_b128 v[172:175], v114 offset:5120
    s_waitcnt lgkmcnt(7)
    v_mfma_f32_32x32x16_bf16 v[96:111], a[160:163], v[176:179], v[96:111]
    ds_read_b128 v[176:179], v114 offset:6144
    s_waitcnt lgkmcnt(7)
    v_mfma_f32_32x32x16_bf16 v[96:111], a[164:167], v[180:183], v[96:111]
    ds_read_b128 v[180:183], v115 offset:0
    s_waitcnt lgkmcnt(7)
    v_mfma_f32_32x32x16_bf16 v[96:111], a[168:171], v[184:187], v[96:111]
    ds_read_b128 v[184:187], v115 offset:1024
    s_waitcnt lgkmcnt(7)
    v_mfma_f32_32x32x16_bf16 v[96:111], a[172:175], v[188:191], v[96:111]
    ds_read_b128 v[188:191], v115 offset:2048
    s_waitcnt lgkmcnt(7)
    v_mfma_f32_32x32x16_bf16 v[96:111], a[176:179], v[160:163], v[96:111]
    ds_read_b128 v[160:163], v115 offset:3072
    s_waitcnt lgkmcnt(7)
    v_mfma_f32_32x32x16_bf16 v[96:111], a[180:183], v[164:167], v[96:111]
    ds_read_b128 v[164:167], v115 offset:4096
    s_waitcnt lgkmcnt(7)
    v_mfma_f32_32x32x16_bf16 v[96:111], a[184:187], v[168:171], v[96:111]
    ds_read_b128 v[168:171], v115 offset:5120
    s_waitcnt lgkmcnt(7)
    v_mfma_f32_32x32x16_bf16 v[96:111], a[188:191], v[172:175], v[96:111]
    ds_read_b128 v[172:175], v115 offset:6144
    s_waitcnt lgkmcnt(7)
    v_mfma_f32_32x32x16_bf16 v[96:111], a[192:195], v[176:179], v[96:111]
    s_waitcnt lgkmcnt(6)
    v_mfma_f32_32x32x16_bf16 v[96:111], a[196:199], v[180:183], v[96:111]
    s_waitcnt lgkmcnt(5)
    v_mfma_f32_32x32x16_bf16 v[96:111], a[200:203], v[184:187], v[96:111]
    s_waitcnt lgkmcnt(4)
    v_mfma_f32_32x32x16_bf16 v[96:111], a[204:207], v[188:191], v[96:111]
    s_waitcnt lgkmcnt(3)
    v_mfma_f32_32x32x16_bf16 v[96:111], a[208:211], v[160:163], v[96:111]
    s_waitcnt lgkmcnt(2)
    v_mfma_f32_32x32x16_bf16 v[96:111], a[212:215], v[164:167], v[96:111]
    s_waitcnt lgkmcnt(1)
    v_mfma_f32_32x32x16_bf16 v[96:111], a[216:219], v[168:171], v[96:111]
    s_waitcnt lgkmcnt(0)
    v_mfma_f32_32x32x16_bf16 v[96:111], a[220:223], v[172:175], v[96:111]
    s_cmp_ge_u32 s54, 14
    s_cbranch_scc1 L_wob1_idle
    s_nop 9
    v_cvt_pk_bf16_f32 v192, v96, v97
    v_cvt_pk_bf16_f32 v193, v98, v99
    v_cvt_pk_bf16_f32 v194, v100, v101
    v_cvt_pk_bf16_f32 v195, v102, v103
    v_cvt_pk_bf16_f32 v196, v104, v105
    v_cvt_pk_bf16_f32 v197, v106, v107
    v_cvt_pk_bf16_f32 v198, v108, v109
    v_cvt_pk_bf16_f32 v199, v110, v111
    v_permlane32_swap_b32 v192, v194
    v_permlane32_swap_b32 v193, v195
    v_permlane32_swap_b32 v196, v198
    v_permlane32_swap_b32 v197, v199
    buffer_store_dwordx4 v[192:195], v200, s[16:19], s30 offen
    buffer_store_dwordx4 v[196:199], v200, s[16:19], s30 offen offset:32
L_wob1_idle:
L_exit:
L_end:
    s_endpgm
ls_6:
    s_nop 4
    buffer_store_dwordx4 a[248:251], v1, s[8:11], s40 offen sc1
    buffer_store_dwordx4 a[248:251], v1, s[8:11], s41 offen sc1
    s_nop 1
    s_branch le_7
ls_8:
    s_nop 4
    buffer_store_dwordx4 a[248:251], v1, s[8:11], s40 offen sc1
    buffer_store_dwordx4 a[248:251], v1, s[8:11], s41 offen sc1
    s_nop 1
    s_branch le_9
ls_12:
    s_nop 4
    s_mov_b64 exec, 1
    buffer_store_dword v2, off, s[8:11], s35 sc1
    s_mov_b64 exec, -1
    s_nop 1
    s_branch le_13
ls_20:
    s_nop 4
    buffer_store_dwordx4 v[16:19], v1, s[8:11], s28 offen sc1
    s_mov_b32 exec_hi, 0
    buffer_store_dwordx4 v[20:23], v1, s[8:11], s28 offen offset:1024 sc1
    s_not_b64 exec, exec
    buffer_store_dwordx2 v[20:21], v1, s[8:11], s28 offen offset:1024 sc1
    s_mov_b64 exec, -1
    s_nop 1
    s_branch le_21
ls_22:
    s_nop 4
    s_mov_b32 exec_lo, 0
    buffer_store_dwordx4 v[16:19], v1, s[8:11], s28 offen sc1
    buffer_store_dwordx4 v[20:23], v1, s[8:11], s28 offen offset:1024 sc1
    s_not_b64 exec, exec
    buffer_store_dwordx4 v[18:21], v1, s[8:11], s28 offen offset:1024 sc1
    buffer_store_dwordx2 v[16:17], v1, s[8:11], s28 offen offset:8 sc1
    s_mov_b64 exec, -1
    s_nop 1
    s_branch le_23
ls_25:
    s_nop 4
    buffer_store_dwordx4 v[192:195], v1, s[8:11], s30 offen sc1
    buffer_store_dwordx4 v[196:199], v1, s[8:11], s30 offen offset:1024 sc1
    s_nop 1
    s_branch le_26
ls_27:
    s_nop 4
    s_mov_b32 exec_hi, 0
    buffer_store_dwordx2 v[200:201], v8, s[8:11], s31 offen sc1
    s_mov_b64 exec, -1
    s_nop 1
    s_branch le_28
L_b0_r:
    buffer_load_dwordx4 v[128:131], v1, s[8:11], s34 offen offset:0 sc1
    buffer_load_dwordx4 v[132:135], v1, s[8:11], s34 offen offset:1024 sc1
    buffer_load_dwordx4 v[136:139], v1, s[8:11], s34 offen offset:2048 sc1
    buffer_load_dwordx4 v[140:143], v1, s[8:11], s34 offen offset:3072 sc1
    s_add_u32 s60, s60, 1
    s_cmp_gt_u32 s60, 100000
    s_cbranch_scc1 L_exit
    s_waitcnt vmcnt(0)
    s_branch L_b0_c
L_b0_slow:
    s_nop 15
    buffer_load_dwordx4 v[128:131], v1, s[8:11], s34 offen offset:0 sc1
    buffer_load_dwordx4 v[132:135], v1, s[8:11], s34 offen offset:1024 sc1
    buffer_load_dwordx4 v[136:139], v1, s[8:11], s34 offen offset:2048 sc1
    buffer_load_dwordx4 v[140:143], v1, s[8:11], s34 offen offset:3072 sc1
    s_add_u32 s38, s34, 4096
    buffer_load_dwordx4 v[144:147], v1, s[8:11], s38 offen offset:0 sc1
    buffer_load_dwordx4 v[148:151], v1, s[8:11], s38 offen offset:1024 sc1
    buffer_load_dwordx4 v[152:155], v1, s[8:11], s38 offen offset:2048 sc1
    buffer_load_dwordx4 v[156:159], v1, s[8:11], s35 offen offset:0 sc1
    buffer_load_dwordx4 v[160:163], v1, s[8:11], s35 offen offset:1024 sc1
    buffer_load_dwordx4 v[164:167], v1, s[8:11], s35 offen offset:2048 sc1
    buffer_load_dwordx4 v[168:171], v1, s[8:11], s35 offen offset:3072 sc1
    s_add_u32 s38, s35, 4096
    buffer_load_dwordx4 v[172:175], v1, s[8:11], s38 offen offset:0 sc1
    buffer_load_dwordx4 v[176:179], v1, s[8:11], s38 offen offset:1024 sc1
    buffer_load_dwordx4 v[180:183], v1, s[8:11], s38 offen offset:2048 sc1
    buffer_load_dwordx4 v[184:187], v1, s[8:11], s36 offen offset:0 sc1
    buffer_load_dwordx4 v[188:191], v1, s[8:11], s36 offen offset:1024 sc1
    buffer_load_dwordx4 v[192:195], v1, s[8:11], s36 offen offset:2048 sc1
    buffer_load_dwordx4 v[196:199], v1, s[8:11], s36 offen offset:3072 sc1
    s_add_u32 s38, s36, 4096
    buffer_load_dwordx4 v[200:203], v1, s[8:11], s38 offen offset:0 sc1
    buffer_load_dwordx4 v[204:207], v1, s[8:11], s38 offen offset:1024 sc1
    buffer_load_dwordx4 v[208:211], v1, s[8:11], s38 offen offset:2048 sc1
    buffer_load_dwordx4 v[212:215], v1, s[8:11], s37 offen offset:0 sc1
    buffer_load_dwordx4 v[216:219], v1, s[8:11], s37 offen offset:1024 sc1
    buffer_load_dwordx4 v[220:223], v1, s[8:11], s37 offen offset:2048 sc1
    buffer_load_dwordx4 v[224:227], v1, s[8:11], s37 offen offset:3072 sc1
    s_add_u32 s38, s37, 4096
    buffer_load_dwordx4 v[228:231], v1, s[8:11], s38 offen offset:0 sc1
    buffer_load_dwordx4 v[232:235], v1, s[8:11], s38 offen offset:1024 sc1
    buffer_load_dwordx4 v[236:239], v1, s[8:11], s38 offen offset:2048 sc1
    s_add_u32 s60, s60, 1
    s_cmp_gt_u32 s60, 100000
    s_cbranch_scc1 L_exit
    s_waitcnt vmcnt(0)
    v_or3_b32 v120, v128, v132, v136
    v_or3_b32 v120, v120, v140, v144
    v_or3_b32 v120, v120, v148, v152
    v_or3_b32 v120, v120, v156, v160
    v_or3_b32 v120, v120, v164, v168
    v_or3_b32 v120, v120, v172, v176
    v_or3_b32 v120, v120, v180, v184
    v_or3_b32 v120, v120, v188, v192
    v_or3_b32 v120, v120, v196, v200
    v_or3_b32 v120, v120, v204, v208
    v_or3_b32 v120, v120, v212, v216
    v_or3_b32 v120, v120, v220, v224
    v_or3_b32 v120, v120, v228, v232
    v_or3_b32 v120, v120, v236, v128
    v_and_b32 v120, 1, v120
    v_cmp_ne_u32 vcc, 0, v120
    s_nop 0
    s_cbranch_vccnz L_b0_slow
    ds_read_b128 v[96:99], v3 offset:0
    ds_read_b128 v[100:103], v3 offset:28672
    s_waitcnt lgkmcnt(0)
    v_mfma_f32_32x32x16_bf16 v[16:31], v[96:99], v[128:131], 0
    v_mfma_f32_32x32x16_bf16 v[32:47], v[128:131], v[100:103], 0
    s_nop 7
    ds_read_b128 v[96:99], v3 offset:1024
    ds_read_b128 v[100:103], v3 offset:29696
    s_waitcnt lgkmcnt(0)
    v_mfma_f32_32x32x16_bf16 v[16:31], v[96:99], v[132:135], v[16:31]
    v_mfma_f32_32x32x16_bf16 v[32:47], v[132:135], v[100:103], v[32:47]
    s_nop 7
    ds_read_b128 v[96:99], v3 offset:2048
    ds_read_b128 v[100:103], v3 offset:30720
    s_waitcnt lgkmcnt(0)
    v_mfma_f32_32x32x16_bf16 v[16:31], v[96:99], v[136:139], v[16:31]
    v_mfma_f32_32x32x16_bf16 v[32:47], v[136:139], v[100:103], v[32:47]
    s_nop 7
    ds_read_b128 v[96:99], v3 offset:3072
    ds_read_b128 v[100:103], v3 offset:31744
    s_waitcnt lgkmcnt(0)
    v_mfma_f32_32x32x16_bf16 v[16:31], v[96:99], v[140:143], v[16:31]
    v_mfma_f32_32x32x16_bf16 v[32:47], v[140:143], v[100:103], v[32:47]
    s_nop 7
    ds_read_b128 v[96:99], v3 offset:4096
    ds_read_b128 v[100:103], v3 offset:32768
    s_waitcnt lgkmcnt(0)
    v_mfma_f32_32x32x16_bf16 v[16:31], v[96:99], v[144:147], v[16:31]
    v_mfma_f32_32x32x16_bf16 v[32:47], v[144:147], v[100:103], v[32:47]
    s_nop 7
    ds_read_b128 v[96:99], v3 offset:5120
    ds_read_b128 v[100:103], v3 offset:33792
    s_waitcnt lgkmcnt(0)
    v_mfma_f32_32x32x16_bf16 v[16:31], v[96:99], v[148:151], v[16:31]
    v_mfma_f32_32x32x16_bf16 v[32:47], v[148:151], v[100:103], v[32:47]
    s_nop 7
    ds_read_b128 v[96:99], v3 offset:6144
    ds_read_b128 v[100:103], v3 offset:34816
    s_waitcnt lgkmcnt(0)
    v_mfma_f32_32x32x16_bf16 v[16:31], v[96:99], v[152:155], v[16:31]
    v_mfma_f32_32x32x16_bf16 v[32:47], v[152:155], v[100:103], v[32:47]
    s_nop 7
    ds_read_b128 v[96:99], v4 offset:0
    ds_read_b128 v[100:103], v4 offset:28672
    s_waitcnt lgkmcnt(0)
    v_mfma_f32_32x32x16_bf16 v[16:31], v[96:99], v[156:159], v[16:31]
    v_mfma_f32_32x32x16_bf16 v[32:47], v[156:159], v[100:103], v[32:47]
    s_nop 7
    ds_read_b128 v[96:99], v4 offset:1024
    ds_read_b128 v[100:103], v4 offset:29696
    s_waitcnt lgkmcnt(0)
    v_mfma_f32_32x32x16_bf16 v[16:31], v[96:99], v[160:163], v[16:31]
    v_mfma_f32_32x32x16_bf16 v[32:47], v[160:163], v[100:103], v[32:47]
    s_nop 7
    ds_read_b128 v[96:99], v4 offset:2048
    ds_read_b128 v[100:103], v4 offset:30720
    s_waitcnt lgkmcnt(0)
    v_mfma_f32_32x32x16_bf16 v[16:31], v[96:99], v[164:167], v[16:31]
    v_mfma_f32_32x32x16_bf16 v[32:47], v[164:167], v[100:103], v[32:47]
    s_nop 7
    ds_read_b128 v[96:99], v4 offset:3072
    ds_read_b128 v[100:103], v4 offset:31744
    s_waitcnt lgkmcnt(0)
    v_mfma_f32_32x32x16_bf16 v[16:31], v[96:99], v[168:171], v[16:31]
    v_mfma_f32_32x32x16_bf16 v[32:47], v[168:171], v[100:103], v[32:47]
    s_nop 7
    ds_read_b128 v[96:99], v4 offset:4096
    ds_read_b128 v[100:103], v4 offset:32768
    s_waitcnt lgkmcnt(0)
    v_mfma_f32_32x32x16_bf16 v[16:31], v[96:99], v[172:175], v[16:31]
    v_mfma_f32_32x32x16_bf16 v[32:47], v[172:175], v[100:103], v[32:47]
    s_nop 7
    ds_read_b128 v[96:99], v4 offset:5120
    ds_read_b128 v[100:103], v4 offset:33792
    s_waitcnt lgkmcnt(0)
    v_mfma_f32_32x32x16_bf16 v[16:31], v[96:99], v[176:179], v[16:31]
    v_mfma_f32_32x32x16_bf16 v[32:47], v[176:179], v[100:103], v[32:47]
    s_nop 7
    ds_read_b128 v[96:99], v4 offset:6144
    ds_read_b128 v[100:103], v4 offset:34816
    s_waitcnt lgkmcnt(0)
    v_mfma_f32_32x32x16_bf16 v[16:31], v[96:99], v[180:183], v[16:31]
    v_mfma_f32_32x32x16_bf16 v[32:47], v[180:183], v[100:103], v[32:47]
    s_nop 7
    ds_read_b128 v[96:99], v5 offset:0
    ds_read_b128 v[100:103], v5 offset:28672
    s_waitcnt lgkmcnt(0)
    v_mfma_f32_32x32x16_bf16 v[16:31], v[96:99], v[184:187], v[16:31]
    v_mfma_f32_32x32x16_bf16 v[32:47], v[184:187], v[100:103], v[32:47]
    s_nop 7
    ds_read_b128 v[96:99], v5 offset:1024
    ds_read_b128 v[100:103], v5 offset:29696
    s_waitcnt lgkmcnt(0)
    v_mfma_f32_32x32x16_bf16 v[16:31], v[96:99], v[188:191], v[16:31]
    v_mfma_f32_32x32x16_bf16 v[32:47], v[188:191], v[100:103], v[32:47]
    s_nop 7
    ds_read_b128 v[96:99], v5 offset:2048
    ds_read_b128 v[100:103], v5 offset:30720
    s_waitcnt lgkmcnt(0)
    v_mfma_f32_32x32x16_bf16 v[16:31], v[96:99], v[192:195], v[16:31]
    v_mfma_f32_32x32x16_bf16 v[32:47], v[192:195], v[100:103], v[32:47]
    s_nop 7
    ds_read_b128 v[96:99], v5 offset:3072
    ds_read_b128 v[100:103], v5 offset:31744
    s_waitcnt lgkmcnt(0)
    v_mfma_f32_32x32x16_bf16 v[16:31], v[96:99], v[196:199], v[16:31]
    v_mfma_f32_32x32x16_bf16 v[32:47], v[196:199], v[100:103], v[32:47]
    s_nop 7
    ds_read_b128 v[96:99], v5 offset:4096
    ds_read_b128 v[100:103], v5 offset:32768
    s_waitcnt lgkmcnt(0)
    v_mfma_f32_32x32x16_bf16 v[16:31], v[96:99], v[200:203], v[16:31]
    v_mfma_f32_32x32x16_bf16 v[32:47], v[200:203], v[100:103], v[32:47]
    s_nop 7
    ds_read_b128 v[96:99], v5 offset:5120
    ds_read_b128 v[100:103], v5 offset:33792
    s_waitcnt lgkmcnt(0)
    v_mfma_f32_32x32x16_bf16 v[16:31], v[96:99], v[204:207], v[16:31]
    v_mfma_f32_32x32x16_bf16 v[32:47], v[204:207], v[100:103], v[32:47]
    s_nop 7
    ds_read_b128 v[96:99], v5 offset:6144
    ds_read_b128 v[100:103], v5 offset:34816
    s_waitcnt lgkmcnt(0)
    v_mfma_f32_32x32x16_bf16 v[16:31], v[96:99], v[208:211], v[16:31]
    v_mfma_f32_32x32x16_bf16 v[32:47], v[208:211], v[100:103], v[32:47]
    s_nop 7
    ds_read_b128 v[96:99], v6 offset:0
    ds_read_b128 v[100:103], v6 offset:28672
    s_waitcnt lgkmcnt(0)
    v_mfma_f32_32x32x16_bf16 v[16:31], v[96:99], v[212:215], v[16:31]
    v_mfma_f32_32x32x16_bf16 v[32:47], v[212:215], v[100:103], v[32:47]
    s_nop 7
    ds_read_b128 v[96:99], v6 offset:1024
    ds_read_b128 v[100:103], v6 offset:29696
    s_waitcnt lgkmcnt(0)
    v_mfma_f32_32x32x16_bf16 v[16:31], v[96:99], v[216:219], v[16:31]
    v_mfma_f32_32x32x16_bf16 v[32:47], v[216:219], v[100:103], v[32:47]
    s_nop 7
    ds_read_b128 v[96:99], v6 offset:2048
    ds_read_b128 v[100:103], v6 offset:30720
    s_waitcnt lgkmcnt(0)
    v_mfma_f32_32x32x16_bf16 v[16:31], v[96:99], v[220:223], v[16:31]
    v_mfma_f32_32x32x16_bf16 v[32:47], v[220:223], v[100:103], v[32:47]
    s_nop 7
    ds_read_b128 v[96:99], v6 offset:3072
    ds_read_b128 v[100:103], v6 offset:31744
    s_waitcnt lgkmcnt(0)
    v_mfma_f32_32x32x16_bf16 v[16:31], v[96:99], v[224:227], v[16:31]
    v_mfma_f32_32x32x16_bf16 v[32:47], v[224:227], v[100:103], v[32:47]
    s_nop 7
    ds_read_b128 v[96:99], v6 offset:4096
    ds_read_b128 v[100:103], v6 offset:32768
    s_waitcnt lgkmcnt(0)
    v_mfma_f32_32x32x16_bf16 v[16:31], v[96:99], v[228:231], v[16:31]
    v_mfma_f32_32x32x16_bf16 v[32:47], v[228:231], v[100:103], v[32:47]
    s_nop 7
    ds_read_b128 v[96:99], v6 offset:5120
    ds_read_b128 v[100:103], v6 offset:33792
    s_waitcnt lgkmcnt(0)
    v_mfma_f32_32x32x16_bf16 v[16:31], v[96:99], v[232:235], v[16:31]
    v_mfma_f32_32x32x16_bf16 v[32:47], v[232:235], v[100:103], v[32:47]
    s_nop 7
    ds_read_b128 v[96:99], v6 offset:6144
    ds_read_b128 v[100:103], v6 offset:34816
    s_waitcnt lgkmcnt(0)
    v_mfma_f32_32x32x16_bf16 v[16:31], v[96:99], v[236:239], v[16:31]
    v_mfma_f32_32x32x16_bf16 v[32:47], v[236:239], v[100:103], v[32:47]
    s_nop 7
    s_nop 15
    s_branch L_b0_ok
ls_39:
    s_nop 4
    buffer_store_dwordx4 v[48:51], v1, s[8:11], s28 offen sc1
    s_mov_b32 exec_hi, 0
    buffer_store_dwordx4 v[52:55], v1, s[8:11], s28 offen offset:1024 sc1
    s_not_b64 exec, exec
    buffer_store_dwordx2 v[52:53], v1, s[8:11], s28 offen offset:1024 sc1
    s_mov_b64 exec, -1
    s_nop 1
    s_branch le_40
ls_41:
    s_nop 4
    s_mov_b32 exec_lo, 0
    buffer_store_dwordx4 v[48:51], v1, s[8:11], s28 offen sc1
    buffer_store_dwordx4 v[52:55], v1, s[8:11], s28 offen offset:1024 sc1
    s_not_b64 exec, exec
    buffer_store_dwordx4 v[50:53], v1, s[8:11], s28 offen offset:1024 sc1
    buffer_store_dwordx2 v[48:49], v1, s[8:11], s28 offen offset:8 sc1
    s_mov_b64 exec, -1
    s_nop 1
    s_branch le_42
ls_44:
    s_nop 4
    buffer_store_dwordx4 v[192:195], v1, s[8:11], s30 offen sc1
    buffer_store_dwordx4 v[196:199], v1, s[8:11], s30 offen offset:1024 sc1
    s_nop 1
    s_branch le_45
ls_46:
    s_nop 4
    s_mov_b32 exec_hi, 0
    buffer_store_dwordx2 v[200:201], v8, s[8:11], s31 offen sc1
    s_mov_b64 exec, -1
    s_nop 1
    s_branch le_47
L_a1_r:
    buffer_load_dwordx4 v[128:131], v1, s[8:11], s34 offen offset:0 sc1
    buffer_load_dwordx4 v[132:135], v1, s[8:11], s34 offen offset:1024 sc1
    buffer_load_dwordx4 v[136:139], v1, s[8:11], s34 offen offset:2048 sc1
    buffer_load_dwordx4 v[140:143], v1, s[8:11], s34 offen offset:3072 sc1
    s_add_u32 s60, s60, 1
    s_cmp_gt_u32 s60, 100000
    s_cbranch_scc1 L_exit
    s_waitcnt vmcnt(0)
    s_branch L_a1_c
L_a1_slow:
    s_nop 15
    buffer_load_dwordx4 v[128:131], v1, s[8:11], s34 offen offset:0 sc1
    buffer_load_dwordx4 v[132:135], v1, s[8:11], s34 offen offset:1024 sc1
    buffer_load_dwordx4 v[136:139], v1, s[8:11], s34 offen offset:2048 sc1
    buffer_load_dwordx4 v[140:143], v1, s[8:11], s34 offen offset:3072 sc1
    s_add_u32 s38, s34, 4096
    buffer_load_dwordx4 v[144:147], v1, s[8:11], s38 offen offset:0 sc1
    buffer_load_dwordx4 v[148:151], v1, s[8:11], s38 offen offset:1024 sc1
    buffer_load_dwordx4 v[152:155], v1, s[8:11], s38 offen offset:2048 sc1
    buffer_load_dwordx4 v[156:159], v1, s[8:11], s35 offen offset:0 sc1
    buffer_load_dwordx4 v[160:163], v1, s[8:11], s35 offen offset:1024 sc1
    buffer_load_dwordx4 v[164:167], v1, s[8:11], s35 offen offset:2048 sc1
    buffer_load_dwordx4 v[168:171], v1, s[8:11], s35 offen offset:3072 sc1
    s_add_u32 s38, s35, 4096
    buffer_load_dwordx4 v[172:175], v1, s[8:11], s38 offen offset:0 sc1
    buffer_load_dwordx4 v[176:179], v1, s[8:11], s38 offen offset:1024 sc1
    buffer_load_dwordx4 v[180:183], v1, s[8:11], s38 offen offset:2048 sc1
    buffer_load_dwordx4 v[184:187], v1, s[8:11], s36 offen offset:0 sc1
    buffer_load_dwordx4 v[188:191], v1, s[8:11], s36 offen offset:1024 sc1
    buffer_load_dwordx4 v[192:195], v1, s[8:11], s36 offen offset:2048 sc1
    buffer_load_dwordx4 v[196:199], v1, s[8:11], s36 offen offset:3072 sc1
    s_add_u32 s38, s36, 4096
    buffer_load_dwordx4 v[200:203], v1, s[8:11], s38 offen offset:0 sc1
    buffer_load_dwordx4 v[204:207], v1, s[8:11], s38 offen offset:1024 sc1
    buffer_load_dwordx4 v[208:211], v1, s[8:11], s38 offen offset:2048 sc1
    buffer_load_dwordx4 v[212:215], v1, s[8:11], s37 offen offset:0 sc1
    buffer_load_dwordx4 v[216:219], v1, s[8:11], s37 offen offset:1024 sc1
    buffer_load_dwordx4 v[220:223], v1, s[8:11], s37 offen offset:2048 sc1
    buffer_load_dwordx4 v[224:227], v1, s[8:11], s37 offen offset:3072 sc1
    s_add_u32 s38, s37, 4096
    buffer_load_dwordx4 v[228:231], v1, s[8:11], s38 offen offset:0 sc1
    buffer_load_dwordx4 v[232:235], v1, s[8:11], s38 offen offset:1024 sc1
    buffer_load_dwordx4 v[236:239], v1, s[8:11], s38 offen offset:2048 sc1
    s_add_u32 s60, s60, 1
    s_cmp_gt_u32 s60, 100000
    s_cbranch_scc1 L_exit
    s_waitcnt vmcnt(0)
    v_bitop3_b32 v120, v128, v132, v136 bitop3:0x80
    v_bitop3_b32 v120, v120, v140, v144 bitop3:0x80
    v_bitop3_b32 v120, v120, v148, v152 bitop3:0x80
    v_bitop3_b32 v120, v120, v156, v160 bitop3:0x80
    v_bitop3_b32 v120, v120, v164, v168 bitop3:0x80
    v_bitop3_b32 v120, v120, v172, v176 bitop3:0x80
    v_bitop3_b32 v120, v120, v180, v184 bitop3:0x80
    v_bitop3_b32 v120, v120, v188, v192 bitop3:0x80
    v_bitop3_b32 v120, v120, v196, v200 bitop3:0x80
    v_bitop3_b32 v120, v120, v204, v208 bitop3:0x80
    v_bitop3_b32 v120, v120, v212, v216 bitop3:0x80
    v_bitop3_b32 v120, v120, v220, v224 bitop3:0x80
    v_bitop3_b32 v120, v120, v228, v232 bitop3:0x80
    v_bitop3_b32 v120, v120, v236, v128 bitop3:0x80
    v_and_b32 v120, 1, v120
    v_cmp_ne_u32 vcc, 1, v120
    s_nop 0
    s_cbranch_vccnz L_a1_slow
    ds_read_b128 v[96:99], v3 offset:0
    ds_read_b128 v[100:103], v3 offset:28672
    s_waitcnt lgkmcnt(0)
    v_mfma_f32_32x32x16_bf16 v[16:31], v[96:99], v[128:131], 0
    v_mfma_f32_32x32x16_bf16 v[32:47], v[128:131], v[100:103], 0
    s_nop 7
    ds_read_b128 v[96:99], v3 offset:1024
    ds_read_b128 v[100:103], v3 offset:29696
    s_waitcnt lgkmcnt(0)
    v_mfma_f32_32x32x16_bf16 v[16:31], v[96:99], v[132:135], v[16:31]
    v_mfma_f32_32x32x16_bf16 v[32:47], v[132:135], v[100:103], v[32:47]
    s_nop 7
    ds_read_b128 v[96:99], v3 offset:2048
    ds_read_b128 v[100:103], v3 offset:30720
    s_waitcnt lgkmcnt(0)
    v_mfma_f32_32x32x16_bf16 v[16:31], v[96:99], v[136:139], v[16:31]
    v_mfma_f32_32x32x16_bf16 v[32:47], v[136:139], v[100:103], v[32:47]
    s_nop 7
    ds_read_b128 v[96:99], v3 offset:3072
    ds_read_b128 v[100:103], v3 offset:31744
    s_waitcnt lgkmcnt(0)
    v_mfma_f32_32x32x16_bf16 v[16:31], v[96:99], v[140:143], v[16:31]
    v_mfma_f32_32x32x16_bf16 v[32:47], v[140:143], v[100:103], v[32:47]
    s_nop 7
    ds_read_b128 v[96:99], v3 offset:4096
    ds_read_b128 v[100:103], v3 offset:32768
    s_waitcnt lgkmcnt(0)
    v_mfma_f32_32x32x16_bf16 v[16:31], v[96:99], v[144:147], v[16:31]
    v_mfma_f32_32x32x16_bf16 v[32:47], v[144:147], v[100:103], v[32:47]
    s_nop 7
    ds_read_b128 v[96:99], v3 offset:5120
    ds_read_b128 v[100:103], v3 offset:33792
    s_waitcnt lgkmcnt(0)
    v_mfma_f32_32x32x16_bf16 v[16:31], v[96:99], v[148:151], v[16:31]
    v_mfma_f32_32x32x16_bf16 v[32:47], v[148:151], v[100:103], v[32:47]
    s_nop 7
    ds_read_b128 v[96:99], v3 offset:6144
    ds_read_b128 v[100:103], v3 offset:34816
    s_waitcnt lgkmcnt(0)
    v_mfma_f32_32x32x16_bf16 v[16:31], v[96:99], v[152:155], v[16:31]
    v_mfma_f32_32x32x16_bf16 v[32:47], v[152:155], v[100:103], v[32:47]
    s_nop 7
    ds_read_b128 v[96:99], v4 offset:0
    ds_read_b128 v[100:103], v4 offset:28672
    s_waitcnt lgkmcnt(0)
    v_mfma_f32_32x32x16_bf16 v[16:31], v[96:99], v[156:159], v[16:31]
    v_mfma_f32_32x32x16_bf16 v[32:47], v[156:159], v[100:103], v[32:47]
    s_nop 7
    ds_read_b128 v[96:99], v4 offset:1024
    ds_read_b128 v[100:103], v4 offset:29696
    s_waitcnt lgkmcnt(0)
    v_mfma_f32_32x32x16_bf16 v[16:31], v[96:99], v[160:163], v[16:31]
    v_mfma_f32_32x32x16_bf16 v[32:47], v[160:163], v[100:103], v[32:47]
    s_nop 7
    ds_read_b128 v[96:99], v4 offset:2048
    ds_read_b128 v[100:103], v4 offset:30720
    s_waitcnt lgkmcnt(0)
    v_mfma_f32_32x32x16_bf16 v[16:31], v[96:99], v[164:167], v[16:31]
    v_mfma_f32_32x32x16_bf16 v[32:47], v[164:167], v[100:103], v[32:47]
    s_nop 7
    ds_read_b128 v[96:99], v4 offset:3072
    ds_read_b128 v[100:103], v4 offset:31744
    s_waitcnt lgkmcnt(0)
    v_mfma_f32_32x32x16_bf16 v[16:31], v[96:99], v[168:171], v[16:31]
    v_mfma_f32_32x32x16_bf16 v[32:47], v[168:171], v[100:103], v[32:47]
    s_nop 7
    ds_read_b128 v[96:99], v4 offset:4096
    ds_read_b128 v[100:103], v4 offset:32768
    s_waitcnt lgkmcnt(0)
    v_mfma_f32_32x32x16_bf16 v[16:31], v[96:99], v[172:175], v[16:31]
    v_mfma_f32_32x32x16_bf16 v[32:47], v[172:175], v[100:103], v[32:47]
    s_nop 7
    ds_read_b128 v[96:99], v4 offset:5120
    ds_read_b128 v[100:103], v4 offset:33792
    s_waitcnt lgkmcnt(0)
    v_mfma_f32_32x32x16_bf16 v[16:31], v[96:99], v[176:179], v[16:31]
    v_mfma_f32_32x32x16_bf16 v[32:47], v[176:179], v[100:103], v[32:47]
    s_nop 7
    ds_read_b128 v[96:99], v4 offset:6144
    ds_read_b128 v[100:103], v4 offset:34816
    s_waitcnt lgkmcnt(0)
    v_mfma_f32_32x32x16_bf16 v[16:31], v[96:99], v[180:183], v[16:31]
    v_mfma_f32_32x32x16_bf16 v[32:47], v[180:183], v[100:103], v[32:47]
    s_nop 7
    ds_read_b128 v[96:99], v5 offset:0
    ds_read_b128 v[100:103], v5 offset:28672
    s_waitcnt lgkmcnt(0)
    v_mfma_f32_32x32x16_bf16 v[16:31], v[96:99], v[184:187], v[16:31]
    v_mfma_f32_32x32x16_bf16 v[32:47], v[184:187], v[100:103], v[32:47]
    s_nop 7
    ds_read_b128 v[96:99], v5 offset:1024
    ds_read_b128 v[100:103], v5 offset:29696
    s_waitcnt lgkmcnt(0)
    v_mfma_f32_32x32x16_bf16 v[16:31], v[96:99], v[188:191], v[16:31]
    v_mfma_f32_32x32x16_bf16 v[32:47], v[188:191], v[100:103], v[32:47]
    s_nop 7
    ds_read_b128 v[96:99], v5 offset:2048
    ds_read_b128 v[100:103], v5 offset:30720
    s_waitcnt lgkmcnt(0)
    v_mfma_f32_32x32x16_bf16 v[16:31], v[96:99], v[192:195], v[16:31]
    v_mfma_f32_32x32x16_bf16 v[32:47], v[192:195], v[100:103], v[32:47]
    s_nop 7
    ds_read_b128 v[96:99], v5 offset:3072
    ds_read_b128 v[100:103], v5 offset:31744
    s_waitcnt lgkmcnt(0)
    v_mfma_f32_32x32x16_bf16 v[16:31], v[96:99], v[196:199], v[16:31]
    v_mfma_f32_32x32x16_bf16 v[32:47], v[196:199], v[100:103], v[32:47]
    s_nop 7
    ds_read_b128 v[96:99], v5 offset:4096
    ds_read_b128 v[100:103], v5 offset:32768
    s_waitcnt lgkmcnt(0)
    v_mfma_f32_32x32x16_bf16 v[16:31], v[96:99], v[200:203], v[16:31]
    v_mfma_f32_32x32x16_bf16 v[32:47], v[200:203], v[100:103], v[32:47]
    s_nop 7
    ds_read_b128 v[96:99], v5 offset:5120
    ds_read_b128 v[100:103], v5 offset:33792
    s_waitcnt lgkmcnt(0)
    v_mfma_f32_32x32x16_bf16 v[16:31], v[96:99], v[204:207], v[16:31]
    v_mfma_f32_32x32x16_bf16 v[32:47], v[204:207], v[100:103], v[32:47]
    s_nop 7
    ds_read_b128 v[96:99], v5 offset:6144
    ds_read_b128 v[100:103], v5 offset:34816
    s_waitcnt lgkmcnt(0)
    v_mfma_f32_32x32x16_bf16 v[16:31], v[96:99], v[208:211], v[16:31]
    v_mfma_f32_32x32x16_bf16 v[32:47], v[208:211], v[100:103], v[32:47]
    s_nop 7
    ds_read_b128 v[96:99], v6 offset:0
    ds_read_b128 v[100:103], v6 offset:28672
    s_waitcnt lgkmcnt(0)
    v_mfma_f32_32x32x16_bf16 v[16:31], v[96:99], v[212:215], v[16:31]
    v_mfma_f32_32x32x16_bf16 v[32:47], v[212:215], v[100:103], v[32:47]
    s_nop 7
    ds_read_b128 v[96:99], v6 offset:1024
    ds_read_b128 v[100:103], v6 offset:29696
    s_waitcnt lgkmcnt(0)
    v_mfma_f32_32x32x16_bf16 v[16:31], v[96:99], v[216:219], v[16:31]
    v_mfma_f32_32x32x16_bf16 v[32:47], v[216:219], v[100:103], v[32:47]
    s_nop 7
    ds_read_b128 v[96:99], v6 offset:2048
    ds_read_b128 v[100:103], v6 offset:30720
    s_waitcnt lgkmcnt(0)
    v_mfma_f32_32x32x16_bf16 v[16:31], v[96:99], v[220:223], v[16:31]
    v_mfma_f32_32x32x16_bf16 v[32:47], v[220:223], v[100:103], v[32:47]
    s_nop 7
    ds_read_b128 v[96:99], v6 offset:3072
    ds_read_b128 v[100:103], v6 offset:31744
    s_waitcnt lgkmcnt(0)
    v_mfma_f32_32x32x16_bf16 v[16:31], v[96:99], v[224:227], v[16:31]
    v_mfma_f32_32x32x16_bf16 v[32:47], v[224:227], v[100:103], v[32:47]
    s_nop 7
    ds_read_b128 v[96:99], v6 offset:4096
    ds_read_b128 v[100:103], v6 offset:32768
    s_waitcnt lgkmcnt(0)
    v_mfma_f32_32x32x16_bf16 v[16:31], v[96:99], v[228:231], v[16:31]
    v_mfma_f32_32x32x16_bf16 v[32:47], v[228:231], v[100:103], v[32:47]
    s_nop 7
    ds_read_b128 v[96:99], v6 offset:5120
    ds_read_b128 v[100:103], v6 offset:33792
    s_waitcnt lgkmcnt(0)
    v_mfma_f32_32x32x16_bf16 v[16:31], v[96:99], v[232:235], v[16:31]
    v_mfma_f32_32x32x16_bf16 v[32:47], v[232:235], v[100:103], v[32:47]
    s_nop 7
    ds_read_b128 v[96:99], v6 offset:6144
    ds_read_b128 v[100:103], v6 offset:34816
    s_waitcnt lgkmcnt(0)
    v_mfma_f32_32x32x16_bf16 v[16:31], v[96:99], v[236:239], v[16:31]
    v_mfma_f32_32x32x16_bf16 v[32:47], v[236:239], v[100:103], v[32:47]
    s_nop 7
    s_nop 15
    s_branch L_a1_ok
ls_56:
    s_nop 4
    buffer_store_dwordx4 v[16:19], v1, s[8:11], s28 offen sc1
    s_mov_b32 exec_hi, 0
    buffer_store_dwordx4 v[20:23], v1, s[8:11], s28 offen offset:1024 sc1
    s_not_b64 exec, exec
    buffer_store_dwordx2 v[20:21], v1, s[8:11], s28 offen offset:1024 sc1
    s_mov_b64 exec, -1
    s_nop 1
    s_branch le_57
ls_58:
    s_nop 4
    s_mov_b32 exec_lo, 0
    buffer_store_dwordx4 v[16:19], v1, s[8:11], s28 offen sc1
    buffer_store_dwordx4 v[20:23], v1, s[8:11], s28 offen offset:1024 sc1
    s_not_b64 exec, exec
    buffer_store_dwordx4 v[18:21], v1, s[8:11], s28 offen offset:1024 sc1
    buffer_store_dwordx2 v[16:17], v1, s[8:11], s28 offen offset:8 sc1
    s_mov_b64 exec, -1
    s_nop 1
    s_branch le_59
ls_61:
    s_nop 4
    buffer_store_dwordx4 v[192:195], v1, s[8:11], s30 offen sc1
    buffer_store_dwordx4 v[196:199], v1, s[8:11], s30 offen offset:1024 sc1
    s_nop 1
    s_branch le_62
ls_63:
    s_nop 4
    s_mov_b32 exec_hi, 0
    buffer_store_dwordx2 v[200:201], v8, s[8:11], s31 offen sc1
    s_mov_b64 exec, -1
    s_nop 1
    s_branch le_64
L_b1_r:
    buffer_load_dwordx4 v[128:131], v1, s[8:11], s34 offen offset:0 sc1
    buffer_load_dwordx4 v[132:135], v1, s[8:11], s34 offen offset:1024 sc1
    buffer_load_dwordx4 v[136:139], v1, s[8:11], s34 offen offset:2048 sc1
    buffer_load_dwordx4 v[140:143], v1, s[8:11], s34 offen offset:3072 sc1
    s_add_u32 s60, s60, 1
    s_cmp_gt_u32 s60, 100000
    s_cbranch_scc1 L_exit
    s_waitcnt vmcnt(0)
    s_branch L_b1_c
L_b1_slow:
    s_nop 15
    buffer_load_dwordx4 v[128:131], v1, s[8:11], s34 offen offset:0 sc1
    buffer_load_dwordx4 v[132:135], v1, s[8:11], s34 offen offset:1024 sc1
    buffer_load_dwordx4 v[136:139], v1, s[8:11], s34 offen offset:2048 sc1
    buffer_load_dwordx4 v[140:143], v1, s[8:11], s34 offen offset:3072 sc1
    s_add_u32 s38, s34, 4096
    buffer_load_dwordx4 v[144:147], v1, s[8:11], s38 offen offset:0 sc1
    buffer_load_dwordx4 v[148:151], v1, s[8:11], s38 offen offset:1024 sc1
    buffer_load_dwordx4 v[152:155], v1, s[8:11], s38 offen offset:2048 sc1
    buffer_load_dwordx4 v[156:159], v1, s[8:11], s35 offen offset:0 sc1
    buffer_load_dwordx4 v[160:163], v1, s[8:11], s35 offen offset:1024 sc1
    buffer_load_dwordx4 v[164:167], v1, s[8:11], s35 offen offset:2048 sc1
    buffer_load_dwordx4 v[168:171], v1, s[8:11], s35 offen offset:3072 sc1
    s_add_u32 s38, s35, 4096
    buffer_load_dwordx4 v[172:175], v1, s[8:11], s38 offen offset:0 sc1
    buffer_load_dwordx4 v[176:179], v1, s[8:11], s38 offen offset:1024 sc1
    buffer_load_dwordx4 v[180:183], v1, s[8:11], s38 offen offset:2048 sc1
    buffer_load_dwordx4 v[184:187], v1, s[8:11], s36 offen offset:0 sc1
    buffer_load_dwordx4 v[188:191], v1, s[8:11], s36 offen offset:1024 sc1
    buffer_load_dwordx4 v[192:195], v1, s[8:11], s36 offen offset:2048 sc1
    buffer_load_dwordx4 v[196:199], v1, s[8:11], s36 offen offset:3072 sc1
    s_add_u32 s38, s36, 4096
    buffer_load_dwordx4 v[200:203], v1, s[8:11], s38 offen offset:0 sc1
    buffer_load_dwordx4 v[204:207], v1, s[8:11], s38 offen offset:1024 sc1
    buffer_load_dwordx4 v[208:211], v1, s[8:11], s38 offen offset:2048 sc1
    buffer_load_dwordx4 v[212:215], v1, s[8:11], s37 offen offset:0 sc1
    buffer_load_dwordx4 v[216:219], v1, s[8:11], s37 offen offset:1024 sc1
    buffer_load_dwordx4 v[220:223], v1, s[8:11], s37 offen offset:2048 sc1
    buffer_load_dwordx4 v[224:227], v1, s[8:11], s37 offen offset:3072 sc1
    s_add_u32 s38, s37, 4096
    buffer_load_dwordx4 v[228:231], v1, s[8:11], s38 offen offset:0 sc1
    buffer_load_dwordx4 v[232:235], v1, s[8:11], s38 offen offset:1024 sc1
    buffer_load_dwordx4 v[236:239], v1, s[8:11], s38 offen offset:2048 sc1
    s_add_u32 s60, s60, 1
    s_cmp_gt_u32 s60, 100000
    s_cbranch_scc1 L_exit
    s_waitcnt vmcnt(0)
    v_or3_b32 v120, v128, v132, v136
    v_or3_b32 v120, v120, v140, v144
    v_or3_b32 v120, v120, v148, v152
    v_or3_b32 v120, v120, v156, v160
    v_or3_b32 v120, v120, v164, v168
    v_or3_b32 v120, v120, v172, v176
    v_or3_b32 v120, v120, v180, v184
    v_or3_b32 v120, v120, v188, v192
    v_or3_b32 v120, v120, v196, v200
    v_or3_b32 v120, v120, v204, v208
    v_or3_b32 v120, v120, v212, v216
    v_or3_b32 v120, v120, v220, v224
    v_or3_b32 v120, v120, v228, v232
    v_or3_b32 v120, v120, v236, v128
    v_and_b32 v120, 1, v120
    v_cmp_ne_u32 vcc, 0, v120
    s_nop 0
    s_cbranch_vccnz L_b1_slow
    ds_read_b128 v[96:99], v3 offset:0
    ds_read_b128 v[100:103], v3 offset:28672
    s_waitcnt lgkmcnt(0)
    v_mfma_f32_32x32x16_bf16 v[16:31], v[96:99], v[128:131], 0
    v_mfma_f32_32x32x16_bf16 v[32:47], v[128:131], v[100:103], 0
    s_nop 7
    ds_read_b128 v[96:99], v3 offset:1024
    ds_read_b128 v[100:103], v3 offset:29696
    s_waitcnt lgkmcnt(0)
    v_mfma_f32_32x32x16_bf16 v[16:31], v[96:99], v[132:135], v[16:31]
    v_mfma_f32_32x32x16_bf16 v[32:47], v[132:135], v[100:103], v[32:47]
    s_nop 7
    ds_read_b128 v[96:99], v3 offset:2048
    ds_read_b128 v[100:103], v3 offset:30720
    s_waitcnt lgkmcnt(0)
    v_mfma_f32_32x32x16_bf16 v[16:31], v[96:99], v[136:139], v[16:31]
    v_mfma_f32_32x32x16_bf16 v[32:47], v[136:139], v[100:103], v[32:47]
    s_nop 7
    ds_read_b128 v[96:99], v3 offset:3072
    ds_read_b128 v[100:103], v3 offset:31744
    s_waitcnt lgkmcnt(0)
    v_mfma_f32_32x32x16_bf16 v[16:31], v[96:99], v[140:143], v[16:31]
    v_mfma_f32_32x32x16_bf16 v[32:47], v[140:143], v[100:103], v[32:47]
    s_nop 7
    ds_read_b128 v[96:99], v3 offset:4096
    ds_read_b128 v[100:103], v3 offset:32768
    s_waitcnt lgkmcnt(0)
    v_mfma_f32_32x32x16_bf16 v[16:31], v[96:99], v[144:147], v[16:31]
    v_mfma_f32_32x32x16_bf16 v[32:47], v[144:147], v[100:103], v[32:47]
    s_nop 7
    ds_read_b128 v[96:99], v3 offset:5120
    ds_read_b128 v[100:103], v3 offset:33792
    s_waitcnt lgkmcnt(0)
    v_mfma_f32_32x32x16_bf16 v[16:31], v[96:99], v[148:151], v[16:31]
    v_mfma_f32_32x32x16_bf16 v[32:47], v[148:151], v[100:103], v[32:47]
    s_nop 7
    ds_read_b128 v[96:99], v3 offset:6144
    ds_read_b128 v[100:103], v3 offset:34816
    s_waitcnt lgkmcnt(0)
    v_mfma_f32_32x32x16_bf16 v[16:31], v[96:99], v[152:155], v[16:31]
    v_mfma_f32_32x32x16_bf16 v[32:47], v[152:155], v[100:103], v[32:47]
    s_nop 7
    ds_read_b128 v[96:99], v4 offset:0
    ds_read_b128 v[100:103], v4 offset:28672
    s_waitcnt lgkmcnt(0)
    v_mfma_f32_32x32x16_bf16 v[16:31], v[96:99], v[156:159], v[16:31]
    v_mfma_f32_32x32x16_bf16 v[32:47], v[156:159], v[100:103], v[32:47]
    s_nop 7
    ds_read_b128 v[96:99], v4 offset:1024
    ds_read_b128 v[100:103], v4 offset:29696
    s_waitcnt lgkmcnt(0)
    v_mfma_f32_32x32x16_bf16 v[16:31], v[96:99], v[160:163], v[16:31]
    v_mfma_f32_32x32x16_bf16 v[32:47], v[160:163], v[100:103], v[32:47]
    s_nop 7
    ds_read_b128 v[96:99], v4 offset:2048
    ds_read_b128 v[100:103], v4 offset:30720
    s_waitcnt lgkmcnt(0)
    v_mfma_f32_32x32x16_bf16 v[16:31], v[96:99], v[164:167], v[16:31]
    v_mfma_f32_32x32x16_bf16 v[32:47], v[164:167], v[100:103], v[32:47]
    s_nop 7
    ds_read_b128 v[96:99], v4 offset:3072
    ds_read_b128 v[100:103], v4 offset:31744
    s_waitcnt lgkmcnt(0)
    v_mfma_f32_32x32x16_bf16 v[16:31], v[96:99], v[168:171], v[16:31]
    v_mfma_f32_32x32x16_bf16 v[32:47], v[168:171], v[100:103], v[32:47]
    s_nop 7
    ds_read_b128 v[96:99], v4 offset:4096
    ds_read_b128 v[100:103], v4 offset:32768
    s_waitcnt lgkmcnt(0)
    v_mfma_f32_32x32x16_bf16 v[16:31], v[96:99], v[172:175], v[16:31]
    v_mfma_f32_32x32x16_bf16 v[32:47], v[172:175], v[100:103], v[32:47]
    s_nop 7
    ds_read_b128 v[96:99], v4 offset:5120
    ds_read_b128 v[100:103], v4 offset:33792
    s_waitcnt lgkmcnt(0)
    v_mfma_f32_32x32x16_bf16 v[16:31], v[96:99], v[176:179], v[16:31]
    v_mfma_f32_32x32x16_bf16 v[32:47], v[176:179], v[100:103], v[32:47]
    s_nop 7
    ds_read_b128 v[96:99], v4 offset:6144
    ds_read_b128 v[100:103], v4 offset:34816
    s_waitcnt lgkmcnt(0)
    v_mfma_f32_32x32x16_bf16 v[16:31], v[96:99], v[180:183], v[16:31]
    v_mfma_f32_32x32x16_bf16 v[32:47], v[180:183], v[100:103], v[32:47]
    s_nop 7
    ds_read_b128 v[96:99], v5 offset:0
    ds_read_b128 v[100:103], v5 offset:28672
    s_waitcnt lgkmcnt(0)
    v_mfma_f32_32x32x16_bf16 v[16:31], v[96:99], v[184:187], v[16:31]
    v_mfma_f32_32x32x16_bf16 v[32:47], v[184:187], v[100:103], v[32:47]
    s_nop 7
    ds_read_b128 v[96:99], v5 offset:1024
    ds_read_b128 v[100:103], v5 offset:29696
    s_waitcnt lgkmcnt(0)
    v_mfma_f32_32x32x16_bf16 v[16:31], v[96:99], v[188:191], v[16:31]
    v_mfma_f32_32x32x16_bf16 v[32:47], v[188:191], v[100:103], v[32:47]
    s_nop 7
    ds_read_b128 v[96:99], v5 offset:2048
    ds_read_b128 v[100:103], v5 offset:30720
    s_waitcnt lgkmcnt(0)
    v_mfma_f32_32x32x16_bf16 v[16:31], v[96:99], v[192:195], v[16:31]
    v_mfma_f32_32x32x16_bf16 v[32:47], v[192:195], v[100:103], v[32:47]
    s_nop 7
    ds_read_b128 v[96:99], v5 offset:3072
    ds_read_b128 v[100:103], v5 offset:31744
    s_waitcnt lgkmcnt(0)
    v_mfma_f32_32x32x16_bf16 v[16:31], v[96:99], v[196:199], v[16:31]
    v_mfma_f32_32x32x16_bf16 v[32:47], v[196:199], v[100:103], v[32:47]
    s_nop 7
    ds_read_b128 v[96:99], v5 offset:4096
    ds_read_b128 v[100:103], v5 offset:32768
    s_waitcnt lgkmcnt(0)
    v_mfma_f32_32x32x16_bf16 v[16:31], v[96:99], v[200:203], v[16:31]
    v_mfma_f32_32x32x16_bf16 v[32:47], v[200:203], v[100:103], v[32:47]
    s_nop 7
    ds_read_b128 v[96:99], v5 offset:5120
    ds_read_b128 v[100:103], v5 offset:33792
    s_waitcnt lgkmcnt(0)
    v_mfma_f32_32x32x16_bf16 v[16:31], v[96:99], v[204:207], v[16:31]
    v_mfma_f32_32x32x16_bf16 v[32:47], v[204:207], v[100:103], v[32:47]
    s_nop 7
    ds_read_b128 v[96:99], v5 offset:6144
    ds_read_b128 v[100:103], v5 offset:34816
    s_waitcnt lgkmcnt(0)
    v_mfma_f32_32x32x16_bf16 v[16:31], v[96:99], v[208:211], v[16:31]
    v_mfma_f32_32x32x16_bf16 v[32:47], v[208:211], v[100:103], v[32:47]
    s_nop 7
    ds_read_b128 v[96:99], v6 offset:0
    ds_read_b128 v[100:103], v6 offset:28672
    s_waitcnt lgkmcnt(0)
    v_mfma_f32_32x32x16_bf16 v[16:31], v[96:99], v[212:215], v[16:31]
    v_mfma_f32_32x32x16_bf16 v[32:47], v[212:215], v[100:103], v[32:47]
    s_nop 7
    ds_read_b128 v[96:99], v6 offset:1024
    ds_read_b128 v[100:103], v6 offset:29696
    s_waitcnt lgkmcnt(0)
    v_mfma_f32_32x32x16_bf16 v[16:31], v[96:99], v[216:219], v[16:31]
    v_mfma_f32_32x32x16_bf16 v[32:47], v[216:219], v[100:103], v[32:47]
    s_nop 7
    ds_read_b128 v[96:99], v6 offset:2048
    ds_read_b128 v[100:103], v6 offset:30720
    s_waitcnt lgkmcnt(0)
    v_mfma_f32_32x32x16_bf16 v[16:31], v[96:99], v[220:223], v[16:31]
    v_mfma_f32_32x32x16_bf16 v[32:47], v[220:223], v[100:103], v[32:47]
    s_nop 7
    ds_read_b128 v[96:99], v6 offset:3072
    ds_read_b128 v[100:103], v6 offset:31744
    s_waitcnt lgkmcnt(0)
    v_mfma_f32_32x32x16_bf16 v[16:31], v[96:99], v[224:227], v[16:31]
    v_mfma_f32_32x32x16_bf16 v[32:47], v[224:227], v[100:103], v[32:47]
    s_nop 7
    ds_read_b128 v[96:99], v6 offset:4096
    ds_read_b128 v[100:103], v6 offset:32768
    s_waitcnt lgkmcnt(0)
    v_mfma_f32_32x32x16_bf16 v[16:31], v[96:99], v[228:231], v[16:31]
    v_mfma_f32_32x32x16_bf16 v[32:47], v[228:231], v[100:103], v[32:47]
    s_nop 7
    ds_read_b128 v[96:99], v6 offset:5120
    ds_read_b128 v[100:103], v6 offset:33792
    s_waitcnt lgkmcnt(0)
    v_mfma_f32_32x32x16_bf16 v[16:31], v[96:99], v[232:235], v[16:31]
    v_mfma_f32_32x32x16_bf16 v[32:47], v[232:235], v[100:103], v[32:47]
    s_nop 7
    ds_read_b128 v[96:99], v6 offset:6144
    ds_read_b128 v[100:103], v6 offset:34816
    s_waitcnt lgkmcnt(0)
    v_mfma_f32_32x32x16_bf16 v[16:31], v[96:99], v[236:239], v[16:31]
    v_mfma_f32_32x32x16_bf16 v[32:47], v[236:239], v[100:103], v[32:47]
    s_nop 7
    s_nop 15
    s_branch L_b1_ok
ls_74:
    s_nop 4
    buffer_store_dwordx4 v[48:51], v1, s[8:11], s28 offen sc1
    s_mov_b32 exec_hi, 0
    buffer_store_dwordx4 v[52:55], v1, s[8:11], s28 offen offset:1024 sc1
    s_not_b64 exec, exec
    buffer_store_dwordx2 v[52:53], v1, s[8:11], s28 offen offset:1024 sc1
    s_mov_b64 exec, -1
    s_nop 1
    s_branch le_75
ls_76:
    s_nop 4
    s_mov_b32 exec_lo, 0
    buffer_store_dwordx4 v[48:51], v1, s[8:11], s28 offen sc1
    buffer_store_dwordx4 v[52:55], v1, s[8:11], s28 offen offset:1024 sc1
    s_not_b64 exec, exec
    buffer_store_dwordx4 v[50:53], v1, s[8:11], s28 offen offset:1024 sc1
    buffer_store_dwordx2 v[48:49], v1, s[8:11], s28 offen offset:8 sc1
    s_mov_b64 exec, -1
    s_nop 1
    s_branch le_77
L_hot_end:
.section .rodata,"a"
.p2align 6
.amdhsa_kernel interleave_layers__linear_kernel_hedgehog__sliding_block__prompt_kernel
  .amdhsa_next_free_vgpr 512
  .amdhsa_next_free_sgpr 102
  .amdhsa_accum_offset 256
  .amdhsa_group_segment_fixed_size 0
  .amdhsa_kernarg_size 80
  .amdhsa_user_sgpr_count 2
  .amdhsa_user_sgpr_kernarg_segment_ptr 1
  .amdhsa_system_sgpr_workgroup_id_x 1
.end_amdhsa_kernel
```
